```python
import torch

def _softmax(x, axis=-1):
    return torch.softmax(x, dim=axis)
def _gelu(x):
    return torch.nn.functional.gelu(x, approximate="tanh")
def _silu(x):
    return torch.nn.functional.silu(x)
def _sigmoid(x):
    return torch.sigmoid(x)
def _layernorm(x, axis=-1, eps=1e-5):
    m = x.mean(dim=axis, keepdim=True)
    v = x.var(dim=axis, keepdim=True, unbiased=False)
    return (x - m) / torch.sqrt(v + eps)
def _scatter_add(tgt, idx, src, axis=0):
    return tgt.clone().index_add_(axis, idx, src)
def _segment_sum(src, seg, n):
    out = torch.zeros((n,) + src.shape[1:], dtype=src.dtype)
    return out.index_add_(0, seg, src)
def _pad(x, pw):
    flat = tuple(v for pair in reversed(pw) for v in pair)
    return torch.nn.functional.pad(x, flat)

kernel_name = 'sequential_preLN__linear_attn_block__dense_activation_relu__prompt'

def setup_inputs():

    _w = (lambda a: (lambda t: t.to(torch.bfloat16) if t.is_floating_point() else t)(torch.as_tensor(a)))
    def _A_setup():
        B, S, D = 1, 2048, 640
        return {
            "x": _w((lambda *s: torch.randn(*s, dtype=torch.bfloat16) * 0.05)(B, S, D)),
            "wqkv": _w((lambda *s: torch.randn(*s, dtype=torch.bfloat16) * 0.05)(D, 3 * D)),
            "wo": _w((lambda *s: torch.randn(*s, dtype=torch.bfloat16) * 0.05)(D, D)),
        }
    _A_in = _A_setup()

    def _B_setup():
        B, S, D, Dff = 1, 2048, 640, 1728
        return {
            "x": _w((lambda *s: torch.randn(*s, dtype=torch.bfloat16) * 0.05)(B, S, D)),
            "w1": _w((lambda *s: torch.randn(*s, dtype=torch.bfloat16) * 0.05)(D, Dff)),
            "w2": _w((lambda *s: torch.randn(*s, dtype=torch.bfloat16) * 0.05)(Dff, D)),
        }
    _B_in = _B_setup()

    return {
        "A_x": _A_in["x"],
        "A_wqkv": _A_in["wqkv"],
        "A_wo": _A_in["wo"],
        "B_x": _B_in["x"],
        "B_w1": _B_in["w1"],
        "B_w2": _B_in["w2"],
    }

def reference(A_x, A_wqkv, A_wo, B_x, B_w1, B_w2):
    def _A_ref(x, wqkv, wo):
        B, S, D = x.shape
        H = 32; Dh = D // H
        qkv = (lambda x, *d: x.permute(*d))((x @ wqkv).reshape(B, S, 3, H, Dh), 2, 0, 3, 1, 4)
        q, k, v = qkv[0], qkv[1], qkv[2]
        phi = lambda t: torch.where(t > 0, t + 1, torch.exp(t)) + 1e-6
        pq, pk = phi(q), phi(k)
        kv = torch.einsum("bhsd,bhse->bhde", pk, v)
        z = torch.einsum("bhsd->bhd", pk)
        num = torch.einsum("bhqd,bhde->bhqe", pq, kv)
        den = torch.einsum("bhqd,bhd->bhq", pq, z)[..., None] + 1e-6
        o = num / den
        return (lambda x, *d: x.permute(*d))(o, 0, 2, 1, 3).reshape(B, S, D) @ wo

    def _B_ref(x, w1, w2):
        h = torch.einsum("bsd,df->bsf", x, w1)
        zero = torch.zeros_like(h)
        h = torch.maximum(h, zero)
        return torch.einsum("bsf,fd->bsd", h, w2)

    x = A_x
    h = x + _A_ref(_layernorm(x, axis=-1), A_wqkv, A_wo)
    h2 = h + _B_ref(_layernorm(h, axis=-1), B_w1, B_w2)
    return h2
```

```asm
; @launch grid=(256,1,1) block=(256,1,1) lds=163840
.amdgcn_target "amdgcn-amd-amdhsa--gfx950"
.text
.globl sequential_preLN__linear_attn_block__dense_activation_relu__prompt_kernel
.p2align 8
.type sequential_preLN__linear_attn_block__dense_activation_relu__prompt_kernel,@function
sequential_preLN__linear_attn_block__dense_activation_relu__prompt_kernel:
    s_cmp_ge_u32 s2, 256
    s_cbranch_scc1 sequential_preLN__linear_attn_block__dense_activation_relu__prompt_kernel_end
    s_load_dwordx16 s[16:31], s[0:1], 0
    s_load_dwordx2 s[32:33], s[0:1], 64
    v_and_b32 v1, 63, v0
    v_lshrrev_b32 v7, 6, v0
    s_nop 0
    v_readfirstlane_b32 s60, v7
    v_lshrrev_b32 v2, 4, v1
    v_and_b32 v3, 15, v1
    s_lshr_b32 s61, s60, 1
    s_and_b32 s62, s60, 1
    s_getpc_b64 s[34:35]
sequential_preLN__linear_attn_block__dense_activation_relu__prompt_kernel_pc:
    s_mov_b64 s[52:53], s[34:35]
    s_lshr_b32 s65, s2, 3
    s_lshl_b32 s65, s65, 2
    s_add_u32 s65, s65, s60
    s_lshl_b32 s65, s65, 10
    s_cmp_ge_u32 s65, sequential_preLN__linear_attn_block__dense_activation_relu__prompt_kernel_tab-sequential_preLN__linear_attn_block__dense_activation_relu__prompt_kernel_pc
    s_cbranch_scc1 Lc_1001
    v_lshl_add_u32 v12, v1, 4, s65
    global_load_dwordx4 a[0:3], v12, s[52:53]
Lc_1001:
    s_lshl_b32 s65, s2, 2
    s_add_u32 s65, s65, s60
    s_lshl_b32 s65, s65, 6
    s_add_u32 s34, s34, sequential_preLN__linear_attn_block__dense_activation_relu__prompt_kernel_tab-sequential_preLN__linear_attn_block__dense_activation_relu__prompt_kernel_pc
    s_addc_u32 s35, s35, 0
    s_add_u32 s34, s34, s65
    s_addc_u32 s35, s35, 0
    s_and_b32 s65, s2, 7
    s_lshr_b32 s66, s2, 3
    s_lshr_b32 s67, s65, 1
    s_lshl_b32 s63, s67, 3
    s_lshr_b32 s68, s66, 2
    s_add_u32 s63, s63, s68
    s_and_b32 s65, s65, 1
    s_lshl_b32 s64, s65, 2
    s_and_b32 s66, s66, 3
    s_add_u32 s64, s64, s66
    s_add_u32 s69, s68, s66
    s_lshl_b32 s69, s69, 1
    s_add_u32 s69, s69, s67
    s_sub_u32 s65, s69, 10
    s_cmp_ge_u32 s69, 10
    s_cselect_b32 s69, s65, s69
    s_sub_u32 s65, s69, 10
    s_cmp_ge_u32 s69, 10
    s_cselect_b32 s69, s65, s69
    s_lshl_b32 s66, s60, 4
    v_lshrrev_b32 v12, 3, v1
    v_add_u32 v12, s66, v12
    v_and_b32 v13, 7, v1
    v_xor_b32 v14, v2, v13
    v_lshlrev_b32 v14, 4, v14
    v_mul_u32_u24 v12, 1280, v12
    v_add_u32 v24, v12, v14
    v_xor_b32 v14, 64, v14
    v_add_u32 v25, v12, v14
    v_add_u32 v25, 9216, v25
    s_lshl_b32 s72, s60, 11
    s_mul_i32 s73, s60, 5120
    s_add_u32 s73, s73, 81920
    s_mul_i32 s65, s63, 81920
    s_mul_i32 s66, s64, 160
    s_waitcnt lgkmcnt(0)
    s_load_dwordx8 s[4:11], s[34:35], 0
    s_load_dwordx4 s[12:15], s[34:35], 32
    s_add_u32 s36, s16, s65
    s_addc_u32 s37, s17, 0
    s_sub_u32 s38, 2621440, s65
    s_mov_b32 s39, 0x20000
    s_add_u32 s40, s18, s66
    s_addc_u32 s41, s19, 0
    s_sub_u32 s42, 2457600, s66
    s_mov_b32 s43, 0x20000
    s_lshl_b32 s70, s69, 7
    s_mul_i32 s71, s69, 245760
    s_add_u32 s71, s71, 1280
    s_add_u32 m0, s72, 0
    s_add_u32 s69, s69, 1
    s_cmp_eq_u32 s69, 10
    s_cselect_b32 s69, 0, s69
    buffer_load_dwordx4 v24, s[36:39], s70 offen offset:0 lds
    buffer_load_dwordx4 v25, s[36:39], s70 offen offset:1024 lds
    s_mul_i32 s68, s60, 61440
    s_movk_i32 s67, 3840
    v_add_u32 v12, 0, v1
    v_mul_u32_u24 v13, 3277, v12
    v_lshrrev_b32 v13, 16, v13
    v_mul_u32_u24 v14, 20, v13
    v_sub_u32 v12, v12, v14
    v_lshrrev_b32 v14, 2, v13
    v_and_b32 v14, 2, v14
    v_xor_b32 v12, v12, v14
    v_mul_u32_u24 v14, 205, v12
    v_lshrrev_b32 v14, 10, v14
    v_and_b32 v15, 1, v14
    v_mul_u32_u24 v15, 1200, v15
    v_lshl_add_u32 v12, v12, 4, v15
    v_lshrrev_b32 v14, 1, v14
    v_mul_u32_u24 v14, 80, v14
    v_sub_u32 v12, v12, v14
    v_mad_u32_u24 v12, v13, s67, v12
    s_sub_u32 s66, s68, 0
    v_add_u32 v26, s66, v12
    s_add_u32 m0, s73, 0
    s_nop 0
    buffer_load_dwordx4 v26, s[40:43], s71 offen offset:0 lds
    v_add_u32 v12, 64, v1
    v_mul_u32_u24 v13, 3277, v12
    v_lshrrev_b32 v13, 16, v13
    v_mul_u32_u24 v14, 20, v13
    v_sub_u32 v12, v12, v14
    v_lshrrev_b32 v14, 2, v13
    v_and_b32 v14, 2, v14
    v_xor_b32 v12, v12, v14
    v_mul_u32_u24 v14, 205, v12
    v_lshrrev_b32 v14, 10, v14
    v_and_b32 v15, 1, v14
    v_mul_u32_u24 v15, 1200, v15
    v_lshl_add_u32 v12, v12, 4, v15
    v_lshrrev_b32 v14, 1, v14
    v_mul_u32_u24 v14, 80, v14
    v_sub_u32 v12, v12, v14
    v_mad_u32_u24 v12, v13, s67, v12
    s_sub_u32 s66, s68, 1024
    v_add_u32 v27, s66, v12
    buffer_load_dwordx4 v27, s[40:43], s71 offen offset:1024 lds
    v_add_u32 v12, 128, v1
    v_mul_u32_u24 v13, 3277, v12
    v_lshrrev_b32 v13, 16, v13
    v_mul_u32_u24 v14, 20, v13
    v_sub_u32 v12, v12, v14
    v_lshrrev_b32 v14, 2, v13
    v_and_b32 v14, 2, v14
    v_xor_b32 v12, v12, v14
    v_mul_u32_u24 v14, 205, v12
    v_lshrrev_b32 v14, 10, v14
    v_and_b32 v15, 1, v14
    v_mul_u32_u24 v15, 1200, v15
    v_lshl_add_u32 v12, v12, 4, v15
    v_lshrrev_b32 v14, 1, v14
    v_mul_u32_u24 v14, 80, v14
    v_sub_u32 v12, v12, v14
    v_mad_u32_u24 v12, v13, s67, v12
    s_sub_u32 s66, s68, 2048
    v_add_u32 v28, s66, v12
    s_add_u32 m0, s73, 0
    s_nop 0
    buffer_load_dwordx4 v28, s[40:43], s71 offen offset:2048 lds
    v_add_u32 v12, 192, v1
    v_mul_u32_u24 v13, 3277, v12
    v_lshrrev_b32 v13, 16, v13
    v_mul_u32_u24 v14, 20, v13
    v_sub_u32 v12, v12, v14
    v_lshrrev_b32 v14, 2, v13
    v_and_b32 v14, 2, v14
    v_xor_b32 v12, v12, v14
    v_mul_u32_u24 v14, 205, v12
    v_lshrrev_b32 v14, 10, v14
    v_and_b32 v15, 1, v14
    v_mul_u32_u24 v15, 1200, v15
    v_lshl_add_u32 v12, v12, 4, v15
    v_lshrrev_b32 v14, 1, v14
    v_mul_u32_u24 v14, 80, v14
    v_sub_u32 v12, v12, v14
    v_mad_u32_u24 v12, v13, s67, v12
    s_sub_u32 s66, s68, 3072
    v_add_u32 v29, s66, v12
    buffer_load_dwordx4 v29, s[40:43], s71 offen offset:3072 lds
    v_add_u32 v12, 256, v1
    v_mul_u32_u24 v13, 3277, v12
    v_lshrrev_b32 v13, 16, v13
    v_mul_u32_u24 v14, 20, v13
    v_sub_u32 v12, v12, v14
    v_lshrrev_b32 v14, 2, v13
    v_and_b32 v14, 2, v14
    v_xor_b32 v12, v12, v14
    v_mul_u32_u24 v14, 205, v12
    v_lshrrev_b32 v14, 10, v14
    v_and_b32 v15, 1, v14
    v_mul_u32_u24 v15, 1200, v15
    v_lshl_add_u32 v12, v12, 4, v15
    v_lshrrev_b32 v14, 1, v14
    v_mul_u32_u24 v14, 80, v14
    v_sub_u32 v12, v12, v14
    v_mad_u32_u24 v12, v13, s67, v12
    s_sub_u32 s66, s68, 0
    v_add_u32 v30, s66, v12
    s_add_u32 m0, s73, 4096
    s_nop 0
    buffer_load_dwordx4 v30, s[40:43], s71 offen offset:0 lds
    s_lshl_b32 s70, s69, 7
    s_mul_i32 s71, s69, 245760
    s_add_u32 s71, s71, 1280
    s_add_u32 m0, s72, 8192
    s_add_u32 s69, s69, 1
    s_cmp_eq_u32 s69, 10
    s_cselect_b32 s69, 0, s69
    buffer_load_dwordx4 v24, s[36:39], s70 offen offset:0 lds
    buffer_load_dwordx4 v25, s[36:39], s70 offen offset:1024 lds
    s_add_u32 m0, s73, 20480
    s_nop 0
    buffer_load_dwordx4 v26, s[40:43], s71 offen offset:0 lds
    buffer_load_dwordx4 v27, s[40:43], s71 offen offset:1024 lds
    s_add_u32 m0, s73, 20480
    s_nop 0
    buffer_load_dwordx4 v28, s[40:43], s71 offen offset:2048 lds
    buffer_load_dwordx4 v29, s[40:43], s71 offen offset:3072 lds
    s_add_u32 m0, s73, 24576
    s_nop 0
    buffer_load_dwordx4 v30, s[40:43], s71 offen offset:0 lds
    s_mov_b32 s44, s32
    s_mov_b32 s45, s33
    s_mov_b32 s46, 18944000
    s_mov_b32 s47, 0x20000
    v_lshlrev_b32 v4, 4, v1
    v_add_u32 v5, 4096, v4
    v_lshlrev_b32 v6, 7, v1
    v_mov_b32 v10, 1
    v_mov_b32 v11, 0
    v_mov_b32 v40, 0x3f803f80
    v_mov_b32 v212, 0
    v_mov_b32 v41, 0x3f803f80
    v_mov_b32 v213, 0
    v_mov_b32 v42, 0x3f803f80
    v_mov_b32 v214, 0
    v_mov_b32 v43, 0x3f803f80
    v_mov_b32 v215, 0
    s_xor_b32 s65, s61, s62
    v_lshrrev_b32 v12, 3, v3
    v_lshlrev_b32 v12, 10, v12
    v_and_b32 v13, 7, v3
    v_lshl_add_u32 v12, v13, 7, v12
    s_lshl_b32 s66, s61, 12
    v_add_u32 v12, s66, v12
    v_lshrrev_b32 v13, 1, v3
    v_xor_b32 v13, v13, v2
    s_lshl_b32 s66, s65, 2
    v_xor_b32 v13, s66, v13
    v_lshl_add_u32 v44, v13, 4, v12
    v_xor_b32 v13, 4, v13
    v_lshl_add_u32 v45, v13, 4, v12
    v_add_u32 v46, 40960, v44
    v_add_u32 v47, 40960, v45
    v_bfe_u32 v12, v1, 2, 2
    v_and_b32 v13, 3, v1
    v_lshl_add_u32 v14, v2, 3, v12
    v_and_b32 v15, 1, v2
    v_mul_u32_u24 v14, 320, v14
    v_lshl_add_u32 v14, v13, 3, v14
    s_mul_i32 s66, s62, 160
    s_add_u32 s66, s66, 81920
    v_add_u32 v14, s66, v14
    v_lshlrev_b32 v16, 5, v15
    v_sub_u32 v17, v14, v16
    v_add_u32 v16, v14, v16
    s_cmp_eq_u32 s62, 0
    s_cselect_b64 vcc, -1, 0
    v_cndmask_b32 v14, v17, v16, vcc
    v_cndmask_b32 v16, v16, v17, vcc
    s_mul_i32 s66, s65, 10240
    s_sub_u32 s67, 10240, s66
    v_add_u32 v48, s66, v14
    v_add_u32 v49, s66, v16
    v_add_u32 v50, s67, v14
    v_add_u32 v51, s67, v16
    s_cmp_lt_u32 s2, 200
    s_cselect_b32 s48, s20, s26
    s_cselect_b32 s49, s21, s27
    s_mov_b32 s50, 2211840
    s_cselect_b32 s50, 819200, s50
    s_mov_b32 s51, 0x20000
    s_movk_i32 s65, 1280
    s_cmp_lt_u32 s2, 135
    s_cselect_b32 s67, 3456, s65
    s_lshl_b32 s66, s60, 3
    v_lshrrev_b32 v12, 3, v1
    v_add_u32 v12, s66, v12
    v_and_b32 v13, 7, v1
    v_lshlrev_b32 v13, 4, v13
    v_mad_u32_u24 v36, v12, s67, v13
    v_mad_u32_u24 v12, v12, s65, v13
    s_lshl_b32 s66, s60, 10
    s_add_u32 m0, s66, 143360
    s_waitcnt lgkmcnt(0)
    buffer_load_dwordx4 v12, s[48:51], s4 offen lds
    v_lshlrev_b32 v37, 10, v2
    v_bfe_u32 v17, v1, 2, 2
    v_lshl_add_u32 v37, v17, 7, v37
    v_and_b32 v17, 3, v1
    v_lshl_add_u32 v37, v17, 4, v37
    s_lshl_b32 s66, s61, 6
    s_lshl_b32 s67, s62, 3
    s_add_u32 s66, s66, s67
    s_add_u32 s66, s66, 81920
    v_add_u32 v37, s66, v37
    s_cmp_lt_u32 s2, 135
    s_cselect_b32 s48, s24, s26
    s_cselect_b32 s49, s25, s27
    s_mov_b32 s50, 2211840
    s_lshl_b32 s66, s64, 2
    s_add_u32 s66, s66, s60
    s_mul_i32 s67, s66, 1792
    s_add_u32 s67, s67, 2686976
    s_lshl_b32 s68, s66, 9
    s_add_u32 s68, s68, 3801088
    s_cmp_eq_u32 s63, 0
    s_cselect_b32 s67, s67, 0x7ff00000
    s_cselect_b32 s68, s68, 0x7ff00000
    v_lshlrev_b32 v12, 3, v1
    buffer_store_dwordx4 v[212:215], v4, s[44:47], s67 offen sc1
    buffer_store_dwordx4 v[212:215], v4, s[44:47], s67 offen offset:768 sc1
    buffer_store_dwordx2 v[212:213], v12, s[44:47], s68 offen sc1
    s_mov_b32 s66, 0
    v_writelane_b32 v12, s66, 0
    s_mov_b32 s66, 4128768
    v_writelane_b32 v12, s66, 1
    s_mov_b32 s66, 4194304
    v_writelane_b32 v12, s66, 2
    s_mov_b32 s66, 6848512
    v_writelane_b32 v12, s66, 3
    s_mov_b32 s66, 9207808
    v_writelane_b32 v12, s66, 4
    s_mov_b32 s66, 11567104
    v_writelane_b32 v12, s66, 5
    s_mov_b32 s66, 12607488
    v_writelane_b32 v12, s66, 6
    s_mov_b32 s66, 14901248
    v_writelane_b32 v12, s66, 7
    s_mov_b32 s66, 16965632
    v_writelane_b32 v12, s66, 8
    s_mov_b32 s66, 18943872
    v_writelane_b32 v12, s66, 9
    s_mov_b64 exec, 1023
    buffer_load_dword a4, v12, s[44:47], 0 offen
    s_mov_b64 exec, 3
    v_mul_u32_u24 v13, 2621436, v1
    global_load_dword a5, v13, s[28:29]
    s_mov_b64 exec, -1
    s_cmp_eq_u32 s60, 0
    s_mov_b32 s74, 0x7ff00000
    s_cselect_b32 s74, 3801088, s74
    s_lshl_b32 s70, s69, 7
    s_mul_i32 s71, s69, 245760
    s_add_u32 s71, s71, 1280
    s_add_u32 m0, s72, 16384
    s_add_u32 s69, s69, 1
    s_cmp_eq_u32 s69, 10
    s_cselect_b32 s69, 0, s69
    buffer_load_dwordx4 v24, s[36:39], s70 offen offset:0 lds
    buffer_load_dwordx4 v25, s[36:39], s70 offen offset:1024 lds
    s_add_u32 m0, s73, 40960
    s_nop 0
    buffer_load_dwordx4 v26, s[40:43], s71 offen offset:0 lds
    buffer_load_dwordx4 v27, s[40:43], s71 offen offset:1024 lds
    s_waitcnt vmcnt(17) lgkmcnt(0)
    s_barrier
    ds_read_b128 v[56:59], v44 offset:0
    ds_read_b128 v[60:63], v44 offset:2048
    ds_read_b64_tr_b16 v[64:65], v48 offset:0
    ds_read_b64_tr_b16 v[66:67], v48 offset:1280
    ds_read_b64_tr_b16 v[68:69], v49 offset:32
    ds_read_b64_tr_b16 v[70:71], v49 offset:1312
    ds_read_b64_tr_b16 v[72:73], v48 offset:64
    ds_read_b64_tr_b16 v[74:75], v48 offset:1344
    ds_read_b64_tr_b16 v[76:77], v49 offset:96
    ds_read_b64_tr_b16 v[78:79], v49 offset:1376
    ds_read_b64_tr_b16 v[80:81], v48 offset:128
    ds_read_b64_tr_b16 v[82:83], v48 offset:1408
    s_waitcnt lgkmcnt(0)
    v_mfma_f32_16x16x32_bf16 v[136:139], v[56:59], v[64:67], 0
    ds_read_b128 v[96:99], v45 offset:0
    ds_read_b128 v[100:103], v45 offset:2048
    v_mfma_f32_16x16x32_bf16 v[156:159], v[60:63], v[64:67], 0
    ds_read_b64_tr_b16 v[104:105], v50 offset:0
    ds_read_b64_tr_b16 v[106:107], v50 offset:1280
    v_mfma_f32_16x16x32_bf16 v[140:143], v[56:59], v[68:71], 0
    ds_read_b64_tr_b16 v[108:109], v51 offset:32
    ds_read_b64_tr_b16 v[110:111], v51 offset:1312
    v_mfma_f32_16x16x32_bf16 v[160:163], v[60:63], v[68:71], 0
    ds_read_b64_tr_b16 v[112:113], v50 offset:64
    ds_read_b64_tr_b16 v[114:115], v50 offset:1344
    v_mfma_f32_16x16x32_bf16 v[144:147], v[56:59], v[72:75], 0
    ds_read_b64_tr_b16 v[116:117], v51 offset:96
    ds_read_b64_tr_b16 v[118:119], v51 offset:1376
    s_add_u32 m0, s73, 40960
    s_nop 0
    buffer_load_dwordx4 v28, s[40:43], s71 offen offset:2048 lds
    buffer_load_dwordx4 v29, s[40:43], s71 offen offset:3072 lds
    v_mfma_f32_16x16x32_bf16 v[164:167], v[60:63], v[72:75], 0
    ds_read_b64_tr_b16 v[120:121], v50 offset:128
    ds_read_b64_tr_b16 v[122:123], v50 offset:1408
    s_add_u32 m0, s73, 45056
    s_nop 0
    buffer_load_dwordx4 v30, s[40:43], s71 offen offset:0 lds
    v_mfma_f32_16x16x32_bf16 v[148:151], v[56:59], v[76:79], 0
    s_mul_i32 s68, s62, 122880
    s_movk_i32 s67, 3840
    v_add_u32 v12, 0, v1
    v_mfma_f32_16x16x32_bf16 v[168:171], v[60:63], v[76:79], 0
    v_mul_u32_u24 v13, 6554, v12
    v_lshrrev_b32 v13, 16, v13
    v_mul_u32_u24 v14, 10, v13
    v_mfma_f32_16x16x32_bf16 v[152:155], v[56:59], v[80:83], 0
    v_sub_u32 v12, v12, v14
    v_and_b32 v14, 0x13, v13
    v_bfe_u32 v15, v13, 2, 1
    v_mfma_f32_16x16x32_bf16 v[172:175], v[60:63], v[80:83], 0
    v_lshl_or_b32 v14, v15, 3, v14
    v_bfe_u32 v15, v13, 3, 1
    v_lshl_or_b32 v14, v15, 2, v14
    v_lshlrev_b32 v12, 4, v12
    v_mad_u32_u24 v12, v14, s67, v12
    s_sub_u32 s66, s68, 0
    v_mfma_f32_16x16x32_bf16 v[176:179], v[56:59], v[40:43], 0
    v_add_u32 v31, s66, v12
    v_add_u32 v12, 64, v1
    v_mul_u32_u24 v13, 6554, v12
    v_mfma_f32_16x16x32_bf16 v[184:187], v[56:59], v[56:59], 0
    v_lshrrev_b32 v13, 16, v13
    v_mul_u32_u24 v14, 10, v13
    v_sub_u32 v12, v12, v14
    v_mfma_f32_16x16x32_bf16 v[180:183], v[60:63], v[40:43], 0
    v_and_b32 v14, 0x13, v13
    v_bfe_u32 v15, v13, 2, 1
    v_lshl_or_b32 v14, v15, 3, v14
    v_mfma_f32_16x16x32_bf16 v[188:191], v[60:63], v[60:63], 0
    v_bfe_u32 v15, v13, 3, 1
    v_lshl_or_b32 v14, v15, 2, v14
    v_lshlrev_b32 v12, 4, v12
    s_waitcnt vmcnt(13) lgkmcnt(0)
    s_barrier
    v_mfma_f32_16x16x32_bf16 v[136:139], v[96:99], v[104:107], v[136:139]
    ds_read_b128 v[56:59], v44 offset:8192
    ds_read_b128 v[60:63], v44 offset:10240
    v_mfma_f32_16x16x32_bf16 v[156:159], v[100:103], v[104:107], v[156:159]
    ds_read_b64_tr_b16 v[64:65], v48 offset:20480
    ds_read_b64_tr_b16 v[66:67], v48 offset:21760
    v_mfma_f32_16x16x32_bf16 v[140:143], v[96:99], v[108:111], v[140:143]
    ds_read_b64_tr_b16 v[68:69], v49 offset:20512
    ds_read_b64_tr_b16 v[70:71], v49 offset:21792
    v_mfma_f32_16x16x32_bf16 v[160:163], v[100:103], v[108:111], v[160:163]
    ds_read_b64_tr_b16 v[72:73], v48 offset:20544
    ds_read_b64_tr_b16 v[74:75], v48 offset:21824
    v_mfma_f32_16x16x32_bf16 v[144:147], v[96:99], v[112:115], v[144:147]
    ds_read_b64_tr_b16 v[76:77], v49 offset:20576
    ds_read_b64_tr_b16 v[78:79], v49 offset:21856
    s_lshl_b32 s70, s69, 7
    s_mul_i32 s71, s69, 245760
    s_add_u32 s71, s71, 1280
    s_add_u32 m0, s72, 24576
    s_add_u32 s69, s69, 1
    s_cmp_eq_u32 s69, 10
    s_cselect_b32 s69, 0, s69
    buffer_load_dwordx4 v24, s[36:39], s70 offen offset:0 lds
    buffer_load_dwordx4 v25, s[36:39], s70 offen offset:1024 lds
    v_mfma_f32_16x16x32_bf16 v[164:167], v[100:103], v[112:115], v[164:167]
    ds_read_b64_tr_b16 v[80:81], v48 offset:20608
    ds_read_b64_tr_b16 v[82:83], v48 offset:21888
    s_add_u32 m0, s73, 0
    s_nop 0
    buffer_load_dwordx4 v26, s[40:43], s71 offen offset:0 lds
    v_mfma_f32_16x16x32_bf16 v[148:151], v[96:99], v[116:119], v[148:151]
    buffer_load_dwordx4 v27, s[40:43], s71 offen offset:1024 lds
    v_mfma_f32_16x16x32_bf16 v[168:171], v[100:103], v[116:119], v[168:171]
    v_mad_u32_u24 v12, v14, s67, v12
    s_sub_u32 s66, s68, 1024
    v_add_u32 v32, s66, v12
    v_mfma_f32_16x16x32_bf16 v[152:155], v[96:99], v[120:123], v[152:155]
    v_add_u32 v12, 128, v1
    v_mul_u32_u24 v13, 6554, v12
    v_lshrrev_b32 v13, 16, v13
    v_mfma_f32_16x16x32_bf16 v[172:175], v[100:103], v[120:123], v[172:175]
    v_mul_u32_u24 v14, 10, v13
    v_sub_u32 v12, v12, v14
    v_and_b32 v14, 0x13, v13
    v_bfe_u32 v15, v13, 2, 1
    v_lshl_or_b32 v14, v15, 3, v14
    v_bfe_u32 v15, v13, 3, 1
    v_mfma_f32_16x16x32_bf16 v[192:195], v[40:43], v[104:107], 0
    v_lshl_or_b32 v14, v15, 2, v14
    v_lshlrev_b32 v12, 4, v12
    v_mad_u32_u24 v12, v14, s67, v12
    v_mfma_f32_16x16x32_bf16 v[196:199], v[40:43], v[108:111], 0
    s_sub_u32 s66, s68, 2048
    v_add_u32 v33, s66, v12
    v_add_u32 v12, 192, v1
    v_mfma_f32_16x16x32_bf16 v[200:203], v[40:43], v[112:115], 0
    v_mul_u32_u24 v13, 6554, v12
    v_lshrrev_b32 v13, 16, v13
    v_mul_u32_u24 v14, 10, v13
    v_mfma_f32_16x16x32_bf16 v[204:207], v[40:43], v[116:119], 0
    v_sub_u32 v12, v12, v14
    v_and_b32 v14, 0x13, v13
    v_bfe_u32 v15, v13, 2, 1
    v_mfma_f32_16x16x32_bf16 v[208:211], v[40:43], v[120:123], 0
    v_lshl_or_b32 v14, v15, 3, v14
    v_bfe_u32 v15, v13, 3, 1
    v_lshl_or_b32 v14, v15, 2, v14
    s_waitcnt lgkmcnt(0)
    v_mfma_f32_16x16x32_bf16 v[136:139], v[56:59], v[64:67], v[136:139]
    ds_read_b128 v[96:99], v45 offset:8192
    ds_read_b128 v[100:103], v45 offset:10240
    v_mfma_f32_16x16x32_bf16 v[156:159], v[60:63], v[64:67], v[156:159]
    ds_read_b64_tr_b16 v[104:105], v50 offset:20480
    ds_read_b64_tr_b16 v[106:107], v50 offset:21760
    v_mfma_f32_16x16x32_bf16 v[140:143], v[56:59], v[68:71], v[140:143]
    ds_read_b64_tr_b16 v[108:109], v51 offset:20512
    ds_read_b64_tr_b16 v[110:111], v51 offset:21792
    v_mfma_f32_16x16x32_bf16 v[160:163], v[60:63], v[68:71], v[160:163]
    ds_read_b64_tr_b16 v[112:113], v50 offset:20544
    ds_read_b64_tr_b16 v[114:115], v50 offset:21824
    v_mfma_f32_16x16x32_bf16 v[144:147], v[56:59], v[72:75], v[144:147]
    ds_read_b64_tr_b16 v[116:117], v51 offset:20576
    ds_read_b64_tr_b16 v[118:119], v51 offset:21856
    s_add_u32 m0, s73, 0
    s_nop 0
    buffer_load_dwordx4 v28, s[40:43], s71 offen offset:2048 lds
    buffer_load_dwordx4 v29, s[40:43], s71 offen offset:3072 lds
    v_mfma_f32_16x16x32_bf16 v[164:167], v[60:63], v[72:75], v[164:167]
    ds_read_b64_tr_b16 v[120:121], v50 offset:20608
    ds_read_b64_tr_b16 v[122:123], v50 offset:21888
    s_add_u32 m0, s73, 4096
    s_nop 0
    buffer_load_dwordx4 v30, s[40:43], s71 offen offset:0 lds
    v_mfma_f32_16x16x32_bf16 v[148:151], v[56:59], v[76:79], v[148:151]
    v_lshlrev_b32 v12, 4, v12
    v_mad_u32_u24 v12, v14, s67, v12
    s_sub_u32 s66, s68, 3072
    v_mfma_f32_16x16x32_bf16 v[168:171], v[60:63], v[76:79], v[168:171]
    v_add_u32 v34, s66, v12
    v_add_u32 v12, 256, v1
    v_mul_u32_u24 v13, 6554, v12
    v_mfma_f32_16x16x32_bf16 v[152:155], v[56:59], v[80:83], v[152:155]
    v_lshrrev_b32 v13, 16, v13
    v_mul_u32_u24 v14, 10, v13
    v_sub_u32 v12, v12, v14
    v_mfma_f32_16x16x32_bf16 v[172:175], v[60:63], v[80:83], v[172:175]
    v_and_b32 v14, 0x13, v13
    v_bfe_u32 v15, v13, 2, 1
    v_lshl_or_b32 v14, v15, 3, v14
    v_bfe_u32 v15, v13, 3, 1
    v_lshl_or_b32 v14, v15, 2, v14
    v_lshlrev_b32 v12, 4, v12
    v_mfma_f32_16x16x32_bf16 v[176:179], v[56:59], v[40:43], v[176:179]
    v_mad_u32_u24 v12, v14, s67, v12
    s_sub_u32 s66, s68, 0
    v_add_u32 v35, s66, v12
    v_mfma_f32_16x16x32_bf16 v[184:187], v[56:59], v[56:59], v[184:187]
    v_bfe_u32 v12, v1, 2, 2
    v_and_b32 v13, 3, v1
    v_and_b32 v15, 1, v2
    v_mfma_f32_16x16x32_bf16 v[180:183], v[60:63], v[40:43], v[180:183]
    s_xor_b32 s65, s61, s62
    v_lshl_add_u32 v12, v15, 2, v12
    v_lshrrev_b32 v15, 1, v2
    v_mfma_f32_16x16x32_bf16 v[188:191], v[60:63], v[60:63], v[188:191]
    v_lshl_add_u32 v12, v15, 4, v12
    v_mul_u32_u24 v12, 160, v12
    v_lshl_add_u32 v12, v13, 3, v12
    s_waitcnt vmcnt(7) lgkmcnt(0)
    s_barrier
    v_mfma_f32_16x16x32_bf16 v[136:139], v[96:99], v[104:107], v[136:139]
    ds_read_b128 v[56:59], v44 offset:16384
    ds_read_b128 v[60:63], v44 offset:18432
    v_mfma_f32_16x16x32_bf16 v[156:159], v[100:103], v[104:107], v[156:159]
    ds_read_b64_tr_b16 v[64:65], v48 offset:40960
    ds_read_b64_tr_b16 v[66:67], v48 offset:42240
    v_mfma_f32_16x16x32_bf16 v[140:143], v[96:99], v[108:111], v[140:143]
    ds_read_b64_tr_b16 v[68:69], v49 offset:40992
    ds_read_b64_tr_b16 v[70:71], v49 offset:42272
    v_mfma_f32_16x16x32_bf16 v[160:163], v[100:103], v[108:111], v[160:163]
    ds_read_b64_tr_b16 v[72:73], v48 offset:41024
    ds_read_b64_tr_b16 v[74:75], v48 offset:42304
    v_mfma_f32_16x16x32_bf16 v[144:147], v[96:99], v[112:115], v[144:147]
    ds_read_b64_tr_b16 v[76:77], v49 offset:41056
    ds_read_b64_tr_b16 v[78:79], v49 offset:42336
    s_lshl_b32 s70, s69, 7
    s_mul_i32 s71, s69, 245760
    s_add_u32 s71, s71, 1280
    s_add_u32 m0, s72, 32768
    s_add_u32 s69, s69, 1
    s_cmp_eq_u32 s69, 10
    s_cselect_b32 s69, 0, s69
    buffer_load_dwordx4 v24, s[36:39], s70 offen offset:0 lds
    v_mfma_f32_16x16x32_bf16 v[164:167], v[100:103], v[112:115], v[164:167]
    ds_read_b64_tr_b16 v[80:81], v48 offset:41088
    ds_read_b64_tr_b16 v[82:83], v48 offset:42368
    buffer_load_dwordx4 v25, s[36:39], s70 offen offset:1024 lds
    v_mfma_f32_16x16x32_bf16 v[148:151], v[96:99], v[116:119], v[148:151]
    s_add_u32 m0, s73, 20480
    s_nop 0
    buffer_load_dwordx4 v26, s[40:43], s71 offen offset:0 lds
    v_mfma_f32_16x16x32_bf16 v[168:171], v[100:103], v[116:119], v[168:171]
    buffer_load_dwordx4 v27, s[40:43], s71 offen offset:1024 lds
    v_mfma_f32_16x16x32_bf16 v[152:155], v[96:99], v[120:123], v[152:155]
    s_mul_i32 s66, s62, 80
    s_add_u32 s66, s66, 81920
    s_mul_i32 s67, s65, 5120
    v_mfma_f32_16x16x32_bf16 v[172:175], v[100:103], v[120:123], v[172:175]
    v_mfma_f32_16x16x32_bf16 v[192:195], v[40:43], v[104:107], v[192:195]
    s_add_u32 s68, s66, s67
    v_add_u32 v52, s68, v12
    s_sub_u32 s68, s66, s67
    v_mfma_f32_16x16x32_bf16 v[196:199], v[40:43], v[108:111], v[196:199]
    s_add_u32 s68, s68, 5120
    v_add_u32 v53, s68, v12
    v_mov_b32 v18, 0x3fb8aa3b
    v_mfma_f32_16x16x32_bf16 v[200:203], v[40:43], v[112:115], v[200:203]
    v_mov_b32 v19, 0x3fb8aa3b
    v_mov_b32 v20, 0x3f800000
    v_mov_b32 v21, 0x3f800000
    v_mfma_f32_16x16x32_bf16 v[204:207], v[40:43], v[116:119], v[204:207]
    v_mov_b32 v22, 0x358637bd
    v_mov_b32 v23, 0x358637bd
    v_mfma_f32_16x16x32_bf16 v[208:211], v[40:43], v[120:123], v[208:211]
    s_waitcnt lgkmcnt(0)
    v_mfma_f32_16x16x32_bf16 v[136:139], v[56:59], v[64:67], v[136:139]
    ds_read_b128 v[96:99], v45 offset:16384
    ds_read_b128 v[100:103], v45 offset:18432
    v_mfma_f32_16x16x32_bf16 v[156:159], v[60:63], v[64:67], v[156:159]
    ds_read_b64_tr_b16 v[104:105], v50 offset:40960
    ds_read_b64_tr_b16 v[106:107], v50 offset:42240
    v_mfma_f32_16x16x32_bf16 v[140:143], v[56:59], v[68:71], v[140:143]
    ds_read_b64_tr_b16 v[108:109], v51 offset:40992
    ds_read_b64_tr_b16 v[110:111], v51 offset:42272
    v_mfma_f32_16x16x32_bf16 v[160:163], v[60:63], v[68:71], v[160:163]
    ds_read_b64_tr_b16 v[112:113], v50 offset:41024
    ds_read_b64_tr_b16 v[114:115], v50 offset:42304
    v_mfma_f32_16x16x32_bf16 v[144:147], v[56:59], v[72:75], v[144:147]
    ds_read_b64_tr_b16 v[116:117], v51 offset:41056
    ds_read_b64_tr_b16 v[118:119], v51 offset:42336
    s_add_u32 m0, s73, 20480
    s_nop 0
    buffer_load_dwordx4 v28, s[40:43], s71 offen offset:2048 lds
    v_mfma_f32_16x16x32_bf16 v[164:167], v[60:63], v[72:75], v[164:167]
    ds_read_b64_tr_b16 v[120:121], v50 offset:41088
    ds_read_b64_tr_b16 v[122:123], v50 offset:42368
    v_mfma_f32_16x16x32_bf16 v[148:151], v[56:59], v[76:79], v[148:151]
    v_mfma_f32_16x16x32_bf16 v[168:171], v[60:63], v[76:79], v[168:171]
    buffer_load_dwordx4 v29, s[40:43], s71 offen offset:3072 lds
    v_mfma_f32_16x16x32_bf16 v[152:155], v[56:59], v[80:83], v[152:155]
    v_mfma_f32_16x16x32_bf16 v[172:175], v[60:63], v[80:83], v[172:175]
    v_mfma_f32_16x16x32_bf16 v[176:179], v[56:59], v[40:43], v[176:179]
    s_add_u32 m0, s73, 24576
    s_nop 0
    buffer_load_dwordx4 v30, s[40:43], s71 offen offset:0 lds
    v_mfma_f32_16x16x32_bf16 v[184:187], v[56:59], v[56:59], v[184:187]
    v_mfma_f32_16x16x32_bf16 v[180:183], v[60:63], v[40:43], v[180:183]
    v_mfma_f32_16x16x32_bf16 v[188:191], v[60:63], v[60:63], v[188:191]
    s_cmp_lg_u32 s63, 0
    s_cbranch_scc1 Lz_1003
    s_lshl_b32 s66, s64, 2
    s_add_u32 s66, s66, s60
    s_lshl_b32 s66, s66, 2
    v_mov_b32 v12, s66
    s_mov_b64 exec, 1
    global_store_dword v12, v10, s[30:31] offset:128 sc1
    s_mov_b64 exec, -1
Lz_1003:
    s_waitcnt vmcnt(7) lgkmcnt(0)
    s_barrier
    v_mfma_f32_16x16x32_bf16 v[136:139], v[96:99], v[104:107], v[136:139]
    ds_read_b128 v[56:59], v44 offset:24576
    ds_read_b128 v[60:63], v44 offset:26624
    v_mfma_f32_16x16x32_bf16 v[156:159], v[100:103], v[104:107], v[156:159]
    ds_read_b64_tr_b16 v[64:65], v48 offset:0
    ds_read_b64_tr_b16 v[66:67], v48 offset:1280
    v_mfma_f32_16x16x32_bf16 v[140:143], v[96:99], v[108:111], v[140:143]
    ds_read_b64_tr_b16 v[68:69], v49 offset:32
    ds_read_b64_tr_b16 v[70:71], v49 offset:1312
    v_mfma_f32_16x16x32_bf16 v[160:163], v[100:103], v[108:111], v[160:163]
    ds_read_b64_tr_b16 v[72:73], v48 offset:64
    ds_read_b64_tr_b16 v[74:75], v48 offset:1344
    v_mfma_f32_16x16x32_bf16 v[144:147], v[96:99], v[112:115], v[144:147]
    ds_read_b64_tr_b16 v[76:77], v49 offset:96
    ds_read_b64_tr_b16 v[78:79], v49 offset:1376
    s_lshl_b32 s70, s69, 7
    s_mul_i32 s71, s69, 245760
    s_add_u32 s71, s71, 1280
    s_add_u32 m0, s72, 40960
    s_add_u32 s69, s69, 1
    s_cmp_eq_u32 s69, 10
    s_cselect_b32 s69, 0, s69
    buffer_load_dwordx4 v24, s[36:39], s70 offen offset:0 lds
    v_mfma_f32_16x16x32_bf16 v[164:167], v[100:103], v[112:115], v[164:167]
    ds_read_b64_tr_b16 v[80:81], v48 offset:128
    ds_read_b64_tr_b16 v[82:83], v48 offset:1408
    v_mfma_f32_16x16x32_bf16 v[148:151], v[96:99], v[116:119], v[148:151]
    buffer_load_dwordx4 v25, s[36:39], s70 offen offset:1024 lds
    v_mfma_f32_16x16x32_bf16 v[168:171], v[100:103], v[116:119], v[168:171]
    v_mfma_f32_16x16x32_bf16 v[152:155], v[96:99], v[120:123], v[152:155]
    s_add_u32 m0, s73, 40960
    s_nop 0
    buffer_load_dwordx4 v26, s[40:43], s71 offen offset:0 lds
    v_mfma_f32_16x16x32_bf16 v[172:175], v[100:103], v[120:123], v[172:175]
    v_mfma_f32_16x16x32_bf16 v[192:195], v[40:43], v[104:107], v[192:195]
    buffer_load_dwordx4 v27, s[40:43], s71 offen offset:1024 lds
    v_mfma_f32_16x16x32_bf16 v[196:199], v[40:43], v[108:111], v[196:199]
    v_mfma_f32_16x16x32_bf16 v[200:203], v[40:43], v[112:115], v[200:203]
    ds_read_b64_tr_b16 v[84:85], v37 offset:61440
    ds_read_b64_tr_b16 v[86:87], v37 offset:61952
    v_mfma_f32_16x16x32_bf16 v[204:207], v[40:43], v[116:119], v[204:207]
    v_mfma_f32_16x16x32_bf16 v[208:211], v[40:43], v[120:123], v[208:211]
    s_waitcnt lgkmcnt(0)
    v_mfma_f32_16x16x32_bf16 v[136:139], v[56:59], v[64:67], v[136:139]
    ds_read_b128 v[96:99], v45 offset:24576
    ds_read_b128 v[100:103], v45 offset:26624
    v_mfma_f32_16x16x32_bf16 v[156:159], v[60:63], v[64:67], v[156:159]
    ds_read_b64_tr_b16 v[104:105], v50 offset:0
    ds_read_b64_tr_b16 v[106:107], v50 offset:1280
    v_mfma_f32_16x16x32_bf16 v[140:143], v[56:59], v[68:71], v[140:143]
    ds_read_b64_tr_b16 v[108:109], v51 offset:32
    ds_read_b64_tr_b16 v[110:111], v51 offset:1312
    v_mfma_f32_16x16x32_bf16 v[160:163], v[60:63], v[68:71], v[160:163]
    ds_read_b64_tr_b16 v[112:113], v50 offset:64
    ds_read_b64_tr_b16 v[114:115], v50 offset:1344
    v_mfma_f32_16x16x32_bf16 v[144:147], v[56:59], v[72:75], v[144:147]
    ds_read_b64_tr_b16 v[116:117], v51 offset:96
    ds_read_b64_tr_b16 v[118:119], v51 offset:1376
    s_add_u32 m0, s73, 40960
    s_nop 0
    buffer_load_dwordx4 v28, s[40:43], s71 offen offset:2048 lds
    v_mfma_f32_16x16x32_bf16 v[164:167], v[60:63], v[72:75], v[164:167]
    ds_read_b64_tr_b16 v[120:121], v50 offset:128
    ds_read_b64_tr_b16 v[122:123], v50 offset:1408
    v_mfma_f32_16x16x32_bf16 v[148:151], v[56:59], v[76:79], v[148:151]
    buffer_load_dwordx4 v29, s[40:43], s71 offen offset:3072 lds
    v_mfma_f32_16x16x32_bf16 v[168:171], v[60:63], v[76:79], v[168:171]
    v_mfma_f32_16x16x32_bf16 v[152:155], v[56:59], v[80:83], v[152:155]
    v_mfma_f32_16x16x32_bf16 v[172:175], v[60:63], v[80:83], v[172:175]
    s_add_u32 m0, s73, 45056
    s_nop 0
    buffer_load_dwordx4 v30, s[40:43], s71 offen offset:0 lds
    v_mfma_f32_16x16x32_bf16 v[176:179], v[56:59], v[40:43], v[176:179]
    v_mfma_f32_16x16x32_bf16 v[184:187], v[56:59], v[56:59], v[184:187]
    buffer_store_dwordx4 v[84:87], v4, s[44:47], s5 offen sc1
    v_mfma_f32_16x16x32_bf16 v[180:183], v[60:63], v[40:43], v[180:183]
    v_mfma_f32_16x16x32_bf16 v[188:191], v[60:63], v[60:63], v[188:191]
    s_waitcnt vmcnt(8) lgkmcnt(0)
    s_barrier
    v_mfma_f32_16x16x32_bf16 v[136:139], v[96:99], v[104:107], v[136:139]
    ds_read_b128 v[56:59], v44 offset:32768
    ds_read_b128 v[60:63], v44 offset:34816
    v_mfma_f32_16x16x32_bf16 v[156:159], v[100:103], v[104:107], v[156:159]
    ds_read_b64_tr_b16 v[64:65], v48 offset:20480
    ds_read_b64_tr_b16 v[66:67], v48 offset:21760
    v_mfma_f32_16x16x32_bf16 v[140:143], v[96:99], v[108:111], v[140:143]
    ds_read_b64_tr_b16 v[68:69], v49 offset:20512
    ds_read_b64_tr_b16 v[70:71], v49 offset:21792
    v_mfma_f32_16x16x32_bf16 v[160:163], v[100:103], v[108:111], v[160:163]
    ds_read_b64_tr_b16 v[72:73], v48 offset:20544
    ds_read_b64_tr_b16 v[74:75], v48 offset:21824
    v_mfma_f32_16x16x32_bf16 v[144:147], v[96:99], v[112:115], v[144:147]
    ds_read_b64_tr_b16 v[76:77], v49 offset:20576
    ds_read_b64_tr_b16 v[78:79], v49 offset:21856
    s_lshl_b32 s70, s69, 7
    s_mul_i32 s71, s69, 245760
    s_add_u32 s71, s71, 1280
    s_add_u32 m0, s72, 49152
    s_add_u32 s69, s69, 1
    s_cmp_eq_u32 s69, 10
    s_cselect_b32 s69, 0, s69
    buffer_load_dwordx4 v24, s[36:39], s70 offen offset:0 lds
    v_mfma_f32_16x16x32_bf16 v[164:167], v[100:103], v[112:115], v[164:167]
    ds_read_b64_tr_b16 v[80:81], v48 offset:20608
    ds_read_b64_tr_b16 v[82:83], v48 offset:21888
    v_mfma_f32_16x16x32_bf16 v[148:151], v[96:99], v[116:119], v[148:151]
    buffer_load_dwordx4 v25, s[36:39], s70 offen offset:1024 lds
    v_mfma_f32_16x16x32_bf16 v[168:171], v[100:103], v[116:119], v[168:171]
    v_mfma_f32_16x16x32_bf16 v[152:155], v[96:99], v[120:123], v[152:155]
    v_mfma_f32_16x16x32_bf16 v[172:175], v[100:103], v[120:123], v[172:175]
    s_add_u32 m0, s73, 0
    s_nop 0
    buffer_load_dwordx4 v26, s[40:43], s71 offen offset:0 lds
    v_mfma_f32_16x16x32_bf16 v[192:195], v[40:43], v[104:107], v[192:195]
    v_mfma_f32_16x16x32_bf16 v[196:199], v[40:43], v[108:111], v[196:199]
    v_mfma_f32_16x16x32_bf16 v[200:203], v[40:43], v[112:115], v[200:203]
    buffer_load_dwordx4 v27, s[40:43], s71 offen offset:1024 lds
    v_mfma_f32_16x16x32_bf16 v[204:207], v[40:43], v[116:119], v[204:207]
    v_mfma_f32_16x16x32_bf16 v[208:211], v[40:43], v[120:123], v[208:211]
    s_waitcnt lgkmcnt(0)
    v_mfma_f32_16x16x32_bf16 v[136:139], v[56:59], v[64:67], v[136:139]
    ds_read_b128 v[96:99], v45 offset:32768
    ds_read_b128 v[100:103], v45 offset:34816
    v_mfma_f32_16x16x32_bf16 v[156:159], v[60:63], v[64:67], v[156:159]
    ds_read_b64_tr_b16 v[104:105], v50 offset:20480
    ds_read_b64_tr_b16 v[106:107], v50 offset:21760
    v_mfma_f32_16x16x32_bf16 v[140:143], v[56:59], v[68:71], v[140:143]
    ds_read_b64_tr_b16 v[108:109], v51 offset:20512
    ds_read_b64_tr_b16 v[110:111], v51 offset:21792
    v_mfma_f32_16x16x32_bf16 v[160:163], v[60:63], v[68:71], v[160:163]
    ds_read_b64_tr_b16 v[112:113], v50 offset:20544
    ds_read_b64_tr_b16 v[114:115], v50 offset:21824
    v_mfma_f32_16x16x32_bf16 v[144:147], v[56:59], v[72:75], v[144:147]
    ds_read_b64_tr_b16 v[116:117], v51 offset:20576
    ds_read_b64_tr_b16 v[118:119], v51 offset:21856
    s_add_u32 m0, s73, 0
    s_nop 0
    buffer_load_dwordx4 v28, s[40:43], s71 offen offset:2048 lds
    v_mfma_f32_16x16x32_bf16 v[164:167], v[60:63], v[72:75], v[164:167]
    ds_read_b64_tr_b16 v[120:121], v50 offset:20608
    ds_read_b64_tr_b16 v[122:123], v50 offset:21888
    v_mfma_f32_16x16x32_bf16 v[148:151], v[56:59], v[76:79], v[148:151]
    v_mfma_f32_16x16x32_bf16 v[168:171], v[60:63], v[76:79], v[168:171]
    buffer_load_dwordx4 v29, s[40:43], s71 offen offset:3072 lds
    v_mfma_f32_16x16x32_bf16 v[152:155], v[56:59], v[80:83], v[152:155]
    v_mfma_f32_16x16x32_bf16 v[172:175], v[60:63], v[80:83], v[172:175]
    v_mfma_f32_16x16x32_bf16 v[176:179], v[56:59], v[40:43], v[176:179]
    s_add_u32 m0, s73, 4096
    s_nop 0
    buffer_load_dwordx4 v30, s[40:43], s71 offen offset:0 lds
    v_mfma_f32_16x16x32_bf16 v[184:187], v[56:59], v[56:59], v[184:187]
    v_mfma_f32_16x16x32_bf16 v[180:183], v[60:63], v[40:43], v[180:183]
    v_mfma_f32_16x16x32_bf16 v[188:191], v[60:63], v[60:63], v[188:191]
    s_waitcnt vmcnt(8) lgkmcnt(0)
    s_barrier
    v_mfma_f32_16x16x32_bf16 v[136:139], v[96:99], v[104:107], v[136:139]
    ds_read_b128 v[56:59], v46 offset:0
    ds_read_b128 v[60:63], v46 offset:2048
    v_mfma_f32_16x16x32_bf16 v[156:159], v[100:103], v[104:107], v[156:159]
    ds_read_b64_tr_b16 v[64:65], v48 offset:40960
    ds_read_b64_tr_b16 v[66:67], v48 offset:42240
    v_mfma_f32_16x16x32_bf16 v[140:143], v[96:99], v[108:111], v[140:143]
    ds_read_b64_tr_b16 v[68:69], v49 offset:40992
    ds_read_b64_tr_b16 v[70:71], v49 offset:42272
    v_mfma_f32_16x16x32_bf16 v[160:163], v[100:103], v[108:111], v[160:163]
    ds_read_b64_tr_b16 v[72:73], v48 offset:41024
    ds_read_b64_tr_b16 v[74:75], v48 offset:42304
    v_mfma_f32_16x16x32_bf16 v[144:147], v[96:99], v[112:115], v[144:147]
    ds_read_b64_tr_b16 v[76:77], v49 offset:41056
    ds_read_b64_tr_b16 v[78:79], v49 offset:42336
    s_lshl_b32 s70, s69, 7
    s_mul_i32 s71, s69, 245760
    s_add_u32 s71, s71, 1280
    s_add_u32 m0, s72, 57344
    s_add_u32 s69, s69, 1
    s_cmp_eq_u32 s69, 10
    s_cselect_b32 s69, 0, s69
    buffer_load_dwordx4 v24, s[36:39], s70 offen offset:0 lds
    v_mfma_f32_16x16x32_bf16 v[164:167], v[100:103], v[112:115], v[164:167]
    ds_read_b64_tr_b16 v[80:81], v48 offset:41088
    ds_read_b64_tr_b16 v[82:83], v48 offset:42368
    v_mfma_f32_16x16x32_bf16 v[148:151], v[96:99], v[116:119], v[148:151]
    buffer_load_dwordx4 v25, s[36:39], s70 offen offset:1024 lds
    v_mfma_f32_16x16x32_bf16 v[168:171], v[100:103], v[116:119], v[168:171]
    v_mfma_f32_16x16x32_bf16 v[152:155], v[96:99], v[120:123], v[152:155]
    v_mfma_f32_16x16x32_bf16 v[172:175], v[100:103], v[120:123], v[172:175]
    s_add_u32 m0, s73, 20480
    s_nop 0
    buffer_load_dwordx4 v26, s[40:43], s71 offen offset:0 lds
    v_mfma_f32_16x16x32_bf16 v[192:195], v[40:43], v[104:107], v[192:195]
    v_mfma_f32_16x16x32_bf16 v[196:199], v[40:43], v[108:111], v[196:199]
    v_mfma_f32_16x16x32_bf16 v[200:203], v[40:43], v[112:115], v[200:203]
    buffer_load_dwordx4 v27, s[40:43], s71 offen offset:1024 lds
    v_mfma_f32_16x16x32_bf16 v[204:207], v[40:43], v[116:119], v[204:207]
    v_mfma_f32_16x16x32_bf16 v[208:211], v[40:43], v[120:123], v[208:211]
    s_waitcnt lgkmcnt(0)
    v_mfma_f32_16x16x32_bf16 v[136:139], v[56:59], v[64:67], v[136:139]
    ds_read_b128 v[96:99], v47 offset:0
    ds_read_b128 v[100:103], v47 offset:2048
    v_mfma_f32_16x16x32_bf16 v[156:159], v[60:63], v[64:67], v[156:159]
    ds_read_b64_tr_b16 v[104:105], v50 offset:40960
    ds_read_b64_tr_b16 v[106:107], v50 offset:42240
    v_mfma_f32_16x16x32_bf16 v[140:143], v[56:59], v[68:71], v[140:143]
    ds_read_b64_tr_b16 v[108:109], v51 offset:40992
    ds_read_b64_tr_b16 v[110:111], v51 offset:42272
    v_mfma_f32_16x16x32_bf16 v[160:163], v[60:63], v[68:71], v[160:163]
    ds_read_b64_tr_b16 v[112:113], v50 offset:41024
    ds_read_b64_tr_b16 v[114:115], v50 offset:42304
    v_mfma_f32_16x16x32_bf16 v[144:147], v[56:59], v[72:75], v[144:147]
    ds_read_b64_tr_b16 v[116:117], v51 offset:41056
    ds_read_b64_tr_b16 v[118:119], v51 offset:42336
    s_add_u32 m0, s73, 20480
    s_nop 0
    buffer_load_dwordx4 v28, s[40:43], s71 offen offset:2048 lds
    v_mfma_f32_16x16x32_bf16 v[164:167], v[60:63], v[72:75], v[164:167]
    ds_read_b64_tr_b16 v[120:121], v50 offset:41088
    ds_read_b64_tr_b16 v[122:123], v50 offset:42368
    v_mfma_f32_16x16x32_bf16 v[148:151], v[56:59], v[76:79], v[148:151]
    v_mfma_f32_16x16x32_bf16 v[168:171], v[60:63], v[76:79], v[168:171]
    buffer_load_dwordx4 v29, s[40:43], s71 offen offset:3072 lds
    v_mfma_f32_16x16x32_bf16 v[152:155], v[56:59], v[80:83], v[152:155]
    v_mfma_f32_16x16x32_bf16 v[172:175], v[60:63], v[80:83], v[172:175]
    v_mfma_f32_16x16x32_bf16 v[176:179], v[56:59], v[40:43], v[176:179]
    s_add_u32 m0, s73, 24576
    s_nop 0
    buffer_load_dwordx4 v30, s[40:43], s71 offen offset:0 lds
    v_mfma_f32_16x16x32_bf16 v[184:187], v[56:59], v[56:59], v[184:187]
    v_mfma_f32_16x16x32_bf16 v[180:183], v[60:63], v[40:43], v[180:183]
    v_mfma_f32_16x16x32_bf16 v[188:191], v[60:63], v[60:63], v[188:191]
    s_waitcnt vmcnt(7) lgkmcnt(0)
    s_barrier
    v_lshlrev_b32 v17, 2, v1
    s_cmp_lg_u32 s60, 0
    s_cbranch_scc1 Lzq_1004
    s_mov_b32 exec_hi, 0
    global_load_dword v9, v17, s[30:31] offset:128 sc1
    s_mov_b64 exec, -1
Lzq_1004:
    v_mfma_f32_16x16x32_bf16 v[136:139], v[96:99], v[104:107], v[136:139]
    ds_read_b128 v[56:59], v46 offset:8192
    ds_read_b128 v[60:63], v46 offset:10240
    v_mfma_f32_16x16x32_bf16 v[156:159], v[100:103], v[104:107], v[156:159]
    ds_read_b64_tr_b16 v[64:65], v48 offset:0
    ds_read_b64_tr_b16 v[66:67], v48 offset:1280
    v_mfma_f32_16x16x32_bf16 v[140:143], v[96:99], v[108:111], v[140:143]
    ds_read_b64_tr_b16 v[68:69], v49 offset:32
    ds_read_b64_tr_b16 v[70:71], v49 offset:1312
    v_mfma_f32_16x16x32_bf16 v[160:163], v[100:103], v[108:111], v[160:163]
    ds_read_b64_tr_b16 v[72:73], v48 offset:64
    ds_read_b64_tr_b16 v[74:75], v48 offset:1344
    v_mfma_f32_16x16x32_bf16 v[144:147], v[96:99], v[112:115], v[144:147]
    ds_read_b64_tr_b16 v[76:77], v49 offset:96
    ds_read_b64_tr_b16 v[78:79], v49 offset:1376
    s_lshl_b32 s70, s69, 7
    s_mul_i32 s71, s69, 245760
    s_add_u32 s71, s71, 1280
    s_add_u32 m0, s72, 65536
    s_add_u32 s69, s69, 1
    s_cmp_eq_u32 s69, 10
    s_cselect_b32 s69, 0, s69
    buffer_load_dwordx4 v24, s[36:39], s70 offen offset:0 lds
    v_mfma_f32_16x16x32_bf16 v[164:167], v[100:103], v[112:115], v[164:167]
    ds_read_b64_tr_b16 v[80:81], v48 offset:128
    ds_read_b64_tr_b16 v[82:83], v48 offset:1408
    v_mfma_f32_16x16x32_bf16 v[148:151], v[96:99], v[116:119], v[148:151]
    buffer_load_dwordx4 v25, s[36:39], s70 offen offset:1024 lds
    v_mfma_f32_16x16x32_bf16 v[168:171], v[100:103], v[116:119], v[168:171]
    v_mfma_f32_16x16x32_bf16 v[152:155], v[96:99], v[120:123], v[152:155]
    v_mfma_f32_16x16x32_bf16 v[172:175], v[100:103], v[120:123], v[172:175]
    s_add_u32 m0, s73, 40960
    s_nop 0
    buffer_load_dwordx4 v26, s[40:43], s71 offen offset:0 lds
    v_mfma_f32_16x16x32_bf16 v[192:195], v[40:43], v[104:107], v[192:195]
    v_mfma_f32_16x16x32_bf16 v[196:199], v[40:43], v[108:111], v[196:199]
    v_mfma_f32_16x16x32_bf16 v[200:203], v[40:43], v[112:115], v[200:203]
    buffer_load_dwordx4 v27, s[40:43], s71 offen offset:1024 lds
    v_mfma_f32_16x16x32_bf16 v[204:207], v[40:43], v[116:119], v[204:207]
    v_mfma_f32_16x16x32_bf16 v[208:211], v[40:43], v[120:123], v[208:211]
    s_waitcnt lgkmcnt(0)
    v_mfma_f32_16x16x32_bf16 v[136:139], v[56:59], v[64:67], v[136:139]
    ds_read_b128 v[96:99], v47 offset:8192
    ds_read_b128 v[100:103], v47 offset:10240
    v_mfma_f32_16x16x32_bf16 v[156:159], v[60:63], v[64:67], v[156:159]
    ds_read_b64_tr_b16 v[104:105], v50 offset:0
    ds_read_b64_tr_b16 v[106:107], v50 offset:1280
    v_mfma_f32_16x16x32_bf16 v[140:143], v[56:59], v[68:71], v[140:143]
    ds_read_b64_tr_b16 v[108:109], v51 offset:32
    ds_read_b64_tr_b16 v[110:111], v51 offset:1312
    v_mfma_f32_16x16x32_bf16 v[160:163], v[60:63], v[68:71], v[160:163]
    ds_read_b64_tr_b16 v[112:113], v50 offset:64
    ds_read_b64_tr_b16 v[114:115], v50 offset:1344
    v_mfma_f32_16x16x32_bf16 v[144:147], v[56:59], v[72:75], v[144:147]
    ds_read_b64_tr_b16 v[116:117], v51 offset:96
    ds_read_b64_tr_b16 v[118:119], v51 offset:1376
    s_add_u32 m0, s73, 40960
    s_nop 0
    buffer_load_dwordx4 v28, s[40:43], s71 offen offset:2048 lds
    v_mfma_f32_16x16x32_bf16 v[164:167], v[60:63], v[72:75], v[164:167]
    ds_read_b64_tr_b16 v[120:121], v50 offset:128
    ds_read_b64_tr_b16 v[122:123], v50 offset:1408
    v_mfma_f32_16x16x32_bf16 v[148:151], v[56:59], v[76:79], v[148:151]
    v_mfma_f32_16x16x32_bf16 v[168:171], v[60:63], v[76:79], v[168:171]
    buffer_load_dwordx4 v29, s[40:43], s71 offen offset:3072 lds
    v_mfma_f32_16x16x32_bf16 v[152:155], v[56:59], v[80:83], v[152:155]
    v_mfma_f32_16x16x32_bf16 v[172:175], v[60:63], v[80:83], v[172:175]
    v_mfma_f32_16x16x32_bf16 v[176:179], v[56:59], v[40:43], v[176:179]
    s_add_u32 m0, s73, 45056
    s_nop 0
    buffer_load_dwordx4 v30, s[40:43], s71 offen offset:0 lds
    v_mfma_f32_16x16x32_bf16 v[184:187], v[56:59], v[56:59], v[184:187]
    v_mfma_f32_16x16x32_bf16 v[180:183], v[60:63], v[40:43], v[180:183]
    v_mfma_f32_16x16x32_bf16 v[188:191], v[60:63], v[60:63], v[188:191]
    s_waitcnt vmcnt(7) lgkmcnt(0)
    s_barrier
    v_mfma_f32_16x16x32_bf16 v[136:139], v[96:99], v[104:107], v[136:139]
    ds_read_b128 v[56:59], v46 offset:16384
    ds_read_b128 v[60:63], v46 offset:18432
    v_mfma_f32_16x16x32_bf16 v[156:159], v[100:103], v[104:107], v[156:159]
    ds_read_b64_tr_b16 v[64:65], v48 offset:20480
    ds_read_b64_tr_b16 v[66:67], v48 offset:21760
    v_mfma_f32_16x16x32_bf16 v[140:143], v[96:99], v[108:111], v[140:143]
    ds_read_b64_tr_b16 v[68:69], v49 offset:20512
    ds_read_b64_tr_b16 v[70:71], v49 offset:21792
    v_mfma_f32_16x16x32_bf16 v[160:163], v[100:103], v[108:111], v[160:163]
    ds_read_b64_tr_b16 v[72:73], v48 offset:20544
    ds_read_b64_tr_b16 v[74:75], v48 offset:21824
    v_mfma_f32_16x16x32_bf16 v[144:147], v[96:99], v[112:115], v[144:147]
    ds_read_b64_tr_b16 v[76:77], v49 offset:20576
    ds_read_b64_tr_b16 v[78:79], v49 offset:21856
    s_lshl_b32 s70, s69, 7
    s_mul_i32 s71, s69, 245760
    s_add_u32 s71, s71, 1280
    s_add_u32 m0, s72, 73728
    s_add_u32 s69, s69, 1
    s_cmp_eq_u32 s69, 10
    s_cselect_b32 s69, 0, s69
    buffer_load_dwordx4 v24, s[36:39], s70 offen offset:0 lds
    v_mfma_f32_16x16x32_bf16 v[164:167], v[100:103], v[112:115], v[164:167]
    ds_read_b64_tr_b16 v[80:81], v48 offset:20608
    ds_read_b64_tr_b16 v[82:83], v48 offset:21888
    buffer_load_dwordx4 v25, s[36:39], s70 offen offset:1024 lds
    v_mfma_f32_16x16x32_bf16 v[148:151], v[96:99], v[116:119], v[148:151]
    s_add_u32 m0, s73, 0
    s_nop 0
    buffer_load_dwordx4 v26, s[40:43], s71 offen offset:0 lds
    v_mfma_f32_16x16x32_bf16 v[168:171], v[100:103], v[116:119], v[168:171]
    buffer_load_dwordx4 v27, s[40:43], s71 offen offset:1024 lds
    v_mfma_f32_16x16x32_bf16 v[152:155], v[96:99], v[120:123], v[152:155]
    s_mul_i32 s68, s60, 3584
    s_add_u32 s68, s68, 147456
    v_add_u32 v14, 0, v2
    v_mfma_f32_16x16x32_bf16 v[172:175], v[100:103], v[120:123], v[172:175]
    v_mul_u32_u24 v14, 336, v14
    v_add_u32 v124, s68, v14
    v_add_u32 v14, 4, v2
    v_mfma_f32_16x16x32_bf16 v[192:195], v[40:43], v[104:107], v[192:195]
    v_mul_u32_u24 v14, 336, v14
    v_add_u32 v125, s68, v14
    v_min_u32 v15, 1, v2
    v_mfma_f32_16x16x32_bf16 v[196:199], v[40:43], v[108:111], v[196:199]
    v_mul_u32_u24 v15, 112, v15
    v_add_u32 v125, v125, v15
    v_add_u32 v14, 8, v2
    v_mfma_f32_16x16x32_bf16 v[200:203], v[40:43], v[112:115], v[200:203]
    v_mul_u32_u24 v14, 336, v14
    v_add_u32 v126, s68, v14
    v_add_u32 v126, 112, v126
    v_mfma_f32_16x16x32_bf16 v[204:207], v[40:43], v[116:119], v[204:207]
    v_add_u32 v88, 4294967288, v3
    v_subrev_u32 v14, 20, v88
    v_min_u32 v88, v88, v14
    v_mfma_f32_16x16x32_bf16 v[208:211], v[40:43], v[120:123], v[208:211]
    v_mul_u32_u24 v14, 205, v88
    v_lshrrev_b32 v14, 10, v14
    v_sub_u32 v88, v88, v14
    s_waitcnt lgkmcnt(0)
    v_mfma_f32_16x16x32_bf16 v[136:139], v[56:59], v[64:67], v[136:139]
    ds_read_b128 v[96:99], v47 offset:16384
    ds_read_b128 v[100:103], v47 offset:18432
    v_mfma_f32_16x16x32_bf16 v[156:159], v[60:63], v[64:67], v[156:159]
    ds_read_b64_tr_b16 v[104:105], v50 offset:20480
    ds_read_b64_tr_b16 v[106:107], v50 offset:21760
    v_mfma_f32_16x16x32_bf16 v[140:143], v[56:59], v[68:71], v[140:143]
    ds_read_b64_tr_b16 v[108:109], v51 offset:20512
    ds_read_b64_tr_b16 v[110:111], v51 offset:21792
    v_mfma_f32_16x16x32_bf16 v[160:163], v[60:63], v[68:71], v[160:163]
    ds_read_b64_tr_b16 v[112:113], v50 offset:20544
    ds_read_b64_tr_b16 v[114:115], v50 offset:21824
    v_mfma_f32_16x16x32_bf16 v[144:147], v[56:59], v[72:75], v[144:147]
    ds_read_b64_tr_b16 v[116:117], v51 offset:20576
    ds_read_b64_tr_b16 v[118:119], v51 offset:21856
    s_add_u32 m0, s73, 0
    s_nop 0
    buffer_load_dwordx4 v28, s[40:43], s71 offen offset:2048 lds
    v_mfma_f32_16x16x32_bf16 v[164:167], v[60:63], v[72:75], v[164:167]
    ds_read_b64_tr_b16 v[120:121], v50 offset:20608
    ds_read_b64_tr_b16 v[122:123], v50 offset:21888
    v_mfma_f32_16x16x32_bf16 v[148:151], v[56:59], v[76:79], v[148:151]
    v_mfma_f32_16x16x32_bf16 v[168:171], v[60:63], v[76:79], v[168:171]
    buffer_load_dwordx4 v29, s[40:43], s71 offen offset:3072 lds
    v_mfma_f32_16x16x32_bf16 v[152:155], v[56:59], v[80:83], v[152:155]
    v_mfma_f32_16x16x32_bf16 v[172:175], v[60:63], v[80:83], v[172:175]
    v_mfma_f32_16x16x32_bf16 v[176:179], v[56:59], v[40:43], v[176:179]
    s_add_u32 m0, s73, 4096
    s_nop 0
    buffer_load_dwordx4 v30, s[40:43], s71 offen offset:0 lds
    v_mfma_f32_16x16x32_bf16 v[184:187], v[56:59], v[56:59], v[184:187]
    v_mfma_f32_16x16x32_bf16 v[180:183], v[60:63], v[40:43], v[180:183]
    v_mfma_f32_16x16x32_bf16 v[188:191], v[60:63], v[60:63], v[188:191]
    s_waitcnt vmcnt(7) lgkmcnt(0)
    s_cmp_lg_u32 s60, 0
    s_cbranch_scc1 Lzok_1006
    s_mov_b32 s75, 0
    s_mov_b32 exec_hi, 0
Lzp_1005:
    v_cmp_ne_u32 vcc, 1, v9
    s_add_u32 s75, s75, 1
    s_cmp_eq_u64 vcc, 0
    s_cbranch_scc1 Lzok_1006
    s_cmp_ge_u32 s75, 200000
    s_cbranch_scc1 Lzok_1006
    s_sleep 2
    global_load_dword v9, v17, s[30:31] offset:128 sc1
    s_waitcnt vmcnt(0)
    s_branch Lzp_1005
Lzok_1006:
    s_mov_b64 exec, -1
    s_barrier
    s_and_b32 s66, s2, 7
    s_lshl_b32 s66, s66, 7
    s_add_u32 s66, s66, 13312
    s_add_u32 s66, s66, s74
    s_mov_b64 exec, 1
    buffer_atomic_add v10, v11, s[44:47], s66 offen offset:0 sc1
    s_mov_b64 exec, -1
    v_mfma_f32_16x16x32_bf16 v[136:139], v[96:99], v[104:107], v[136:139]
    ds_read_b128 v[56:59], v46 offset:24576
    ds_read_b128 v[60:63], v46 offset:26624
    v_mfma_f32_16x16x32_bf16 v[156:159], v[100:103], v[104:107], v[156:159]
    ds_read_b64_tr_b16 v[64:65], v48 offset:40960
    ds_read_b64_tr_b16 v[66:67], v48 offset:42240
    v_mfma_f32_16x16x32_bf16 v[140:143], v[96:99], v[108:111], v[140:143]
    ds_read_b64_tr_b16 v[68:69], v49 offset:40992
    ds_read_b64_tr_b16 v[70:71], v49 offset:42272
    v_mfma_f32_16x16x32_bf16 v[160:163], v[100:103], v[108:111], v[160:163]
    ds_read_b64_tr_b16 v[72:73], v48 offset:41024
    ds_read_b64_tr_b16 v[74:75], v48 offset:42304
    v_mfma_f32_16x16x32_bf16 v[144:147], v[96:99], v[112:115], v[144:147]
    ds_read_b64_tr_b16 v[76:77], v49 offset:41056
    ds_read_b64_tr_b16 v[78:79], v49 offset:42336
    s_add_u32 s71, s69, s61
    s_cmp_eq_u32 s71, 10
    s_cselect_b32 s71, 0, s71
    s_mul_i32 s71, s71, 245760
    s_add_u32 s69, s69, 1
    s_cmp_eq_u32 s69, 10
    s_cselect_b32 s69, 0, s69
    s_add_u32 s69, s69, 1
    s_cmp_eq_u32 s69, 10
    s_cselect_b32 s69, 0, s69
    s_add_u32 m0, s73, 20480
    s_nop 0
    buffer_load_dwordx4 v31, s[40:43], s71 offen offset:0 lds
    v_mfma_f32_16x16x32_bf16 v[164:167], v[100:103], v[112:115], v[164:167]
    ds_read_b64_tr_b16 v[80:81], v48 offset:41088
    ds_read_b64_tr_b16 v[82:83], v48 offset:42368
    buffer_load_dwordx4 v32, s[40:43], s71 offen offset:1024 lds
    v_mfma_f32_16x16x32_bf16 v[148:151], v[96:99], v[116:119], v[148:151]
    s_add_u32 m0, s73, 20480
    s_nop 0
    buffer_load_dwordx4 v33, s[40:43], s71 offen offset:2048 lds
    v_mfma_f32_16x16x32_bf16 v[168:171], v[100:103], v[116:119], v[168:171]
    v_add_u32 v14, 16, v14
    s_mov_b32 s22, 0x10841084
    s_mov_b32 s23, 0x10841084
    v_mfma_f32_16x16x32_bf16 v[152:155], v[96:99], v[120:123], v[152:155]
    v_cndmask_b32 v88, v88, v14, s[22:23]
    v_lshlrev_b32 v88, 4, v88
    v_add_u32 v89, 8, v3
    v_mfma_f32_16x16x32_bf16 v[172:175], v[100:103], v[120:123], v[172:175]
    v_subrev_u32 v14, 20, v89
    v_min_u32 v89, v89, v14
    v_mul_u32_u24 v14, 205, v89
    v_mfma_f32_16x16x32_bf16 v[192:195], v[40:43], v[104:107], v[192:195]
    v_lshrrev_b32 v14, 10, v14
    v_sub_u32 v89, v89, v14
    v_add_u32 v14, 16, v14
    v_mfma_f32_16x16x32_bf16 v[196:199], v[40:43], v[108:111], v[196:199]
    s_mov_b32 s22, 0x8420842
    s_mov_b32 s23, 0x8420842
    v_cndmask_b32 v89, v89, v14, s[22:23]
    v_mfma_f32_16x16x32_bf16 v[200:203], v[40:43], v[112:115], v[200:203]
    v_lshlrev_b32 v89, 4, v89
    v_add_u32 v90, 24, v3
    v_subrev_u32 v14, 20, v90
    v_mfma_f32_16x16x32_bf16 v[204:207], v[40:43], v[116:119], v[204:207]
    v_min_u32 v90, v90, v14
    v_mul_u32_u24 v14, 205, v90
    v_lshrrev_b32 v14, 10, v14
    v_mfma_f32_16x16x32_bf16 v[208:211], v[40:43], v[120:123], v[208:211]
    s_waitcnt lgkmcnt(0)
    v_mfma_f32_16x16x32_bf16 v[136:139], v[56:59], v[64:67], v[136:139]
    ds_read_b128 v[96:99], v47 offset:24576
    ds_read_b128 v[100:103], v47 offset:26624
    v_mfma_f32_16x16x32_bf16 v[156:159], v[60:63], v[64:67], v[156:159]
    ds_read_b64_tr_b16 v[104:105], v50 offset:40960
    ds_read_b64_tr_b16 v[106:107], v50 offset:42240
    v_mfma_f32_16x16x32_bf16 v[140:143], v[56:59], v[68:71], v[140:143]
    ds_read_b64_tr_b16 v[108:109], v51 offset:40992
    ds_read_b64_tr_b16 v[110:111], v51 offset:42272
    v_mfma_f32_16x16x32_bf16 v[160:163], v[60:63], v[68:71], v[160:163]
    ds_read_b64_tr_b16 v[112:113], v50 offset:41024
    ds_read_b64_tr_b16 v[114:115], v50 offset:42304
    v_mfma_f32_16x16x32_bf16 v[144:147], v[56:59], v[72:75], v[144:147]
    ds_read_b64_tr_b16 v[116:117], v51 offset:41056
    ds_read_b64_tr_b16 v[118:119], v51 offset:42336
    buffer_load_dwordx4 v34, s[40:43], s71 offen offset:3072 lds
    v_mfma_f32_16x16x32_bf16 v[164:167], v[60:63], v[72:75], v[164:167]
    ds_read_b64_tr_b16 v[120:121], v50 offset:41088
    ds_read_b64_tr_b16 v[122:123], v50 offset:42368
    v_mfma_f32_16x16x32_bf16 v[148:151], v[56:59], v[76:79], v[148:151]
    v_mfma_f32_16x16x32_bf16 v[168:171], v[60:63], v[76:79], v[168:171]
    v_mfma_f32_16x16x32_bf16 v[152:155], v[56:59], v[80:83], v[152:155]
    v_mfma_f32_16x16x32_bf16 v[172:175], v[60:63], v[80:83], v[172:175]
    s_add_u32 m0, s73, 24576
    s_nop 0
    buffer_load_dwordx4 v35, s[40:43], s71 offen offset:0 lds
    v_mfma_f32_16x16x32_bf16 v[176:179], v[56:59], v[40:43], v[176:179]
    v_mfma_f32_16x16x32_bf16 v[184:187], v[56:59], v[56:59], v[184:187]
    v_mfma_f32_16x16x32_bf16 v[180:183], v[60:63], v[40:43], v[180:183]
    v_mfma_f32_16x16x32_bf16 v[188:191], v[60:63], v[60:63], v[188:191]
    s_waitcnt vmcnt(6) lgkmcnt(0)
    s_barrier
    v_mfma_f32_16x16x32_bf16 v[136:139], v[96:99], v[104:107], v[136:139]
    ds_read_b128 v[56:59], v46 offset:32768
    ds_read_b128 v[60:63], v46 offset:34816
    v_mfma_f32_16x16x32_bf16 v[156:159], v[100:103], v[104:107], v[156:159]
    ds_read_b64_tr_b16 v[64:65], v48 offset:0
    ds_read_b64_tr_b16 v[66:67], v48 offset:1280
    v_mfma_f32_16x16x32_bf16 v[140:143], v[96:99], v[108:111], v[140:143]
    ds_read_b64_tr_b16 v[68:69], v49 offset:32
    ds_read_b64_tr_b16 v[70:71], v49 offset:1312
    v_mfma_f32_16x16x32_bf16 v[160:163], v[100:103], v[108:111], v[160:163]
    ds_read_b64_tr_b16 v[72:73], v48 offset:64
    ds_read_b64_tr_b16 v[74:75], v48 offset:1344
    v_mfma_f32_16x16x32_bf16 v[144:147], v[96:99], v[112:115], v[144:147]
    ds_read_b64_tr_b16 v[76:77], v49 offset:96
    ds_read_b64_tr_b16 v[78:79], v49 offset:1376
    s_add_u32 s71, s69, s61
    s_cmp_eq_u32 s71, 10
    s_cselect_b32 s71, 0, s71
    s_mul_i32 s71, s71, 245760
    s_add_u32 s69, s69, 1
    s_cmp_eq_u32 s69, 10
    s_cselect_b32 s69, 0, s69
    s_add_u32 s69, s69, 1
    s_cmp_eq_u32 s69, 10
    s_cselect_b32 s69, 0, s69
    s_add_u32 m0, s73, 40960
    s_nop 0
    buffer_load_dwordx4 v31, s[40:43], s71 offen offset:0 lds
    v_mfma_f32_16x16x32_bf16 v[164:167], v[100:103], v[112:115], v[164:167]
    ds_read_b64_tr_b16 v[80:81], v48 offset:128
    ds_read_b64_tr_b16 v[82:83], v48 offset:1408
    buffer_load_dwordx4 v32, s[40:43], s71 offen offset:1024 lds
    v_mfma_f32_16x16x32_bf16 v[148:151], v[96:99], v[116:119], v[148:151]
    s_add_u32 m0, s73, 40960
    s_nop 0
    buffer_load_dwordx4 v33, s[40:43], s71 offen offset:2048 lds
    v_mfma_f32_16x16x32_bf16 v[168:171], v[100:103], v[116:119], v[168:171]
    v_sub_u32 v90, v90, v14
    v_add_u32 v14, 16, v14
    s_mov_b32 s22, 0x84218421
    v_mfma_f32_16x16x32_bf16 v[152:155], v[96:99], v[120:123], v[152:155]
    s_mov_b32 s23, 0x84218421
    v_cndmask_b32 v90, v90, v14, s[22:23]
    v_lshlrev_b32 v90, 4, v90
    v_mfma_f32_16x16x32_bf16 v[172:175], v[100:103], v[120:123], v[172:175]
    v_add_u32 v127, v124, v88
    v_add_u32 v128, v124, v89
    v_add_u32 v129, v125, v88
    v_mfma_f32_16x16x32_bf16 v[192:195], v[40:43], v[104:107], v[192:195]
    v_add_u32 v130, v125, v89
    v_add_u32 v131, v125, v90
    v_add_u32 v132, v126, v89
    v_mfma_f32_16x16x32_bf16 v[196:199], v[40:43], v[108:111], v[196:199]
    v_add_u32 v133, v126, v90
    s_lshl_b32 s68, s61, 7
    s_add_u32 s68, s68, 145664
    v_mfma_f32_16x16x32_bf16 v[200:203], v[40:43], v[112:115], v[200:203]
    v_lshl_add_u32 v134, v2, 4, s68
    s_mul_i32 s68, s62, 320
    s_add_u32 s68, s68, 144384
    v_mfma_f32_16x16x32_bf16 v[204:207], v[40:43], v[116:119], v[204:207]
    v_lshl_add_u32 v135, v3, 2, s68
    v_mfma_f32_16x16x32_bf16 v[208:211], v[40:43], v[120:123], v[208:211]
    s_waitcnt lgkmcnt(0)
    v_mfma_f32_16x16x32_bf16 v[176:179], v[56:59], v[40:43], v[176:179]
    ds_read_b128 v[96:99], v47 offset:32768
    v_mfma_f32_16x16x32_bf16 v[184:187], v[56:59], v[56:59], v[184:187]
    ds_read_b128 v[100:103], v47 offset:34816
    buffer_load_dwordx4 v34, s[40:43], s71 offen offset:3072 lds
    v_mfma_f32_16x16x32_bf16 v[180:183], v[60:63], v[40:43], v[180:183]
    ds_read_b64_tr_b16 v[104:105], v50 offset:0
    v_mfma_f32_16x16x32_bf16 v[188:191], v[60:63], v[60:63], v[188:191]
    ds_read_b64_tr_b16 v[106:107], v50 offset:1280
    v_mfma_f32_16x16x32_bf16 v[136:139], v[56:59], v[64:67], v[136:139]
    ds_read_b64_tr_b16 v[108:109], v51 offset:32
    s_add_u32 m0, s73, 45056
    s_nop 0
    buffer_load_dwordx4 v35, s[40:43], s71 offen offset:0 lds
    v_mfma_f32_16x16x32_bf16 v[156:159], v[60:63], v[64:67], v[156:159]
    ds_read_b64_tr_b16 v[110:111], v51 offset:1312
    v_mfma_f32_16x16x32_bf16 v[140:143], v[56:59], v[68:71], v[140:143]
    ds_read_b64_tr_b16 v[112:113], v50 offset:64
    v_mfma_f32_16x16x32_bf16 v[160:163], v[60:63], v[68:71], v[160:163]
    ds_read_b64_tr_b16 v[114:115], v50 offset:1344
    ds_read_b64_tr_b16 v[116:117], v51 offset:96
    ds_read_b64_tr_b16 v[118:119], v51 offset:1376
    ds_read_b64_tr_b16 v[120:121], v50 offset:128
    ds_read_b64_tr_b16 v[122:123], v50 offset:1408
    v_mfma_f32_16x16x32_bf16 v[144:147], v[56:59], v[72:75], v[144:147]
    v_mfma_f32_16x16x32_bf16 v[164:167], v[60:63], v[72:75], v[164:167]
    v_mfma_f32_16x16x32_bf16 v[148:151], v[56:59], v[76:79], v[148:151]
    s_mov_b32 s22, 0x22222222
    s_mov_b32 s23, 0x22222222
    s_mov_b32 s34, 0x44444444
    s_mov_b32 s35, 0x44444444
    s_mov_b32 vcc_lo, 0x88888888
    s_mov_b32 vcc_hi, 0x88888888
    s_lshl_b32 s66, s62, 8
    s_lshl_b32 s67, s61, 7
    s_add_u32 s66, s66, s67
    s_add_u32 s66, s66, 143360
    v_lshl_add_u32 v12, v3, 2, s66
    v_lshl_add_u32 v13, v2, 4, s66
    v_mfma_f32_16x16x32_bf16 v[168:171], v[60:63], v[76:79], v[168:171]
    v_cndmask_b32 v184, v184, v185, s[22:23]
    v_cndmask_b32 v184, v184, v186, s[34:35]
    v_cndmask_b32 v184, v184, v187, vcc
    v_mfma_f32_16x16x32_bf16 v[152:155], v[56:59], v[80:83], v[152:155]
    v_cndmask_b32 v188, v188, v189, s[22:23]
    v_cndmask_b32 v188, v188, v190, s[34:35]
    v_cndmask_b32 v188, v188, v191, vcc
    v_mfma_f32_16x16x32_bf16 v[172:175], v[60:63], v[80:83], v[172:175]
    s_mov_b32 exec_lo, 0x00F0000F
    s_mov_b32 exec_hi, 0xF0000F00
    ds_write_b32 v12, v184 offset:512
    ds_write_b32 v12, v188 offset:576
    s_mov_b32 exec_lo, 0x00010001
    s_mov_b32 exec_hi, 0x00010001
    ds_write_b128 v13, v[176:179] offset:0
    ds_write_b128 v13, v[180:183] offset:64
    s_mov_b64 exec, -1
    s_waitcnt lgkmcnt(0)
    s_barrier
    v_mfma_f32_16x16x32_bf16 v[192:195], v[40:43], v[104:107], v[192:195]
    v_lshlrev_b32 v12, 2, v1
    v_mfma_f32_16x16x32_bf16 v[196:199], v[40:43], v[108:111], v[196:199]
    v_add_u32 v12, 143360, v12
    s_add_u32 s71, s69, s61
    s_cmp_eq_u32 s71, 10
    s_cselect_b32 s71, 0, s71
    s_mul_i32 s71, s71, 245760
    s_add_u32 s69, s69, 1
    s_cmp_eq_u32 s69, 10
    s_cselect_b32 s69, 0, s69
    s_add_u32 s69, s69, 1
    s_cmp_eq_u32 s69, 10
    s_cselect_b32 s69, 0, s69
    s_add_u32 m0, s73, 0
    s_nop 0
    buffer_load_dwordx4 v31, s[40:43], s71 offen offset:0 lds
    v_mfma_f32_16x16x32_bf16 v[200:203], v[40:43], v[112:115], v[200:203]
    ds_read_b32 v56, v12
    v_mfma_f32_16x16x32_bf16 v[204:207], v[40:43], v[116:119], v[204:207]
    ds_read_b32 v57, v12 offset:256
    buffer_load_dwordx4 v32, s[40:43], s71 offen offset:1024 lds
    v_mfma_f32_16x16x32_bf16 v[208:211], v[40:43], v[120:123], v[208:211]
    ds_read_b32 v58, v12 offset:512
    v_mfma_f32_16x16x32_bf16 v[136:139], v[96:99], v[104:107], v[136:139]
    ds_read_b32 v59, v12 offset:768
    s_add_u32 m0, s73, 0
    s_nop 0
    buffer_load_dwordx4 v33, s[40:43], s71 offen offset:2048 lds
    v_mfma_f32_16x16x32_bf16 v[156:159], v[100:103], v[104:107], v[156:159]
    v_mfma_f32_16x16x32_bf16 v[140:143], v[96:99], v[108:111], v[140:143]
    s_waitcnt lgkmcnt(0)
    v_add_f32 v56, v56, v57
    v_add_f32 v58, v58, v59
    v_mul_f32 v56, 0x3acccccd, v56
    v_mfma_f32_16x16x32_bf16 v[160:163], v[100:103], v[108:111], v[160:163]
    v_mul_f32 v58, 0x3acccccd, v58
    v_fma_f32 v58, -v56, v56, v58
    v_max_f32 v58, 0, v58
    v_cvt_pk_bf16_f32 v56, v56, v56
    v_mfma_f32_16x16x32_bf16 v[144:147], v[96:99], v[112:115], v[144:147]
    v_lshlrev_b32 v56, 16, v56
    v_cvt_pk_bf16_f32 v58, v58, v58
    v_lshlrev_b32 v58, 16, v58
    v_add_f32 v58, 0x3727c5ac, v58
    v_mfma_f32_16x16x32_bf16 v[164:167], v[100:103], v[112:115], v[164:167]
    v_cvt_pk_bf16_f32 v58, v58, v58
    v_lshlrev_b32 v58, 16, v58
    v_sqrt_f32 v58, v58
    s_nop 0
    v_cvt_pk_bf16_f32 v58, v58, v58
    v_mfma_f32_16x16x32_bf16 v[148:151], v[96:99], v[116:119], v[148:151]
    v_lshlrev_b32 v58, 16, v58
    v_rcp_f32 v57, v58
    s_nop 0
    v_mul_f32 v56, v56, v57
    v_sub_f32 v56, 0, v56
    v_mfma_f32_16x16x32_bf16 v[168:171], v[100:103], v[116:119], v[168:171]
    s_mul_i32 s66, s61, 640
    s_mul_i32 s67, s62, 320
    s_add_u32 s66, s66, s67
    s_add_u32 s66, s66, 144384
    v_lshl_add_u32 v14, v3, 2, s66
    s_mov_b64 exec, 0xffff
    ds_write_b32 v14, v192 offset:0
    ds_write_b32 v14, v196 offset:64
    ds_write_b32 v14, v200 offset:128
    ds_write_b32 v14, v204 offset:192
    ds_write_b32 v14, v208 offset:256
    s_mov_b64 exec, -1
    v_mfma_f32_16x16x32_bf16 v[152:155], v[96:99], v[120:123], v[152:155]
    ds_write_b32 v12, v57 offset:2304
    ds_write_b32 v12, v56 offset:2560
    v_mfma_f32_16x16x32_bf16 v[172:175], v[100:103], v[120:123], v[172:175]
    s_waitcnt lgkmcnt(0)
    s_barrier
    ds_read_b32 v72, v135 offset:0
    ds_read_b32 v73, v135 offset:640
    ds_read_b32 v74, v135 offset:64
    ds_read_b32 v75, v135 offset:704
    ds_read_b32 v76, v135 offset:128
    ds_read_b32 v77, v135 offset:768
    ds_read_b32 v78, v135 offset:192
    ds_read_b32 v79, v135 offset:832
    ds_read_b32 v80, v135 offset:256
    ds_read_b32 v81, v135 offset:896
    ds_read_b128 v[56:59], v134 offset:0
    ds_read_b128 v[64:67], v134 offset:256
    ds_read_b128 v[60:63], v134 offset:64
    ds_read_b128 v[68:71], v134 offset:320
    buffer_load_dwordx4 v34, s[40:43], s71 offen offset:3072 lds
    s_add_u32 m0, s73, 4096
    s_nop 0
    buffer_load_dwordx4 v35, s[40:43], s71 offen offset:0 lds
    s_mov_b32 s22, 0x00ff00ff
    s_mov_b32 s23, 0x00ff00ff
    s_waitcnt lgkmcnt(0)
    v_add_f32 v72, v72, v73
    v_add_f32 v74, v74, v75
    v_add_f32 v76, v76, v77
    v_add_f32 v78, v78, v79
    v_add_f32 v80, v80, v81
    v_pk_mul_f32 v[96:97], v[64:65], v[72:73] op_sel_hi:[1,0]
    v_pk_mul_f32 v[102:103], v[66:67], v[72:73] op_sel_hi:[1,0]
    v_pk_mul_f32 v[108:109], v[68:69], v[72:73] op_sel_hi:[1,0]
    v_pk_mul_f32 v[114:115], v[70:71], v[72:73] op_sel_hi:[1,0]
    v_pk_fma_f32 v[136:137], v[136:137], v[56:57], v[96:97]
    v_pk_fma_f32 v[138:139], v[138:139], v[58:59], v[102:103]
    v_pk_fma_f32 v[156:157], v[156:157], v[60:61], v[108:109]
    v_pk_fma_f32 v[158:159], v[158:159], v[62:63], v[114:115]
    v_pk_mul_f32 v[98:99], v[136:137], v[18:19]
    v_pk_mul_f32 v[104:105], v[138:139], v[18:19]
    v_pk_mul_f32 v[110:111], v[156:157], v[18:19]
    v_pk_mul_f32 v[116:117], v[158:159], v[18:19]
    v_pk_add_f32 v[100:101], v[136:137], v[20:21]
    v_pk_add_f32 v[106:107], v[138:139], v[20:21]
    v_pk_add_f32 v[112:113], v[156:157], v[20:21]
    v_pk_add_f32 v[118:119], v[158:159], v[20:21]
    s_add_u32 s71, s69, s61
    s_cmp_eq_u32 s71, 10
    s_cselect_b32 s71, 0, s71
    s_mul_i32 s71, s71, 245760
    s_add_u32 s69, s69, 1
    s_cmp_eq_u32 s69, 10
    s_cselect_b32 s69, 0, s69
    s_add_u32 s69, s69, 1
    s_cmp_eq_u32 s69, 10
    s_cselect_b32 s69, 0, s69
    buffer_load_dwordx4 a[200:203], v31, s[40:43], s71 offen offset:0
    v_exp_f32 v98, v98
    v_exp_f32 v104, v104
    v_exp_f32 v110, v110
    v_exp_f32 v116, v116
    v_exp_f32 v99, v99
    v_exp_f32 v105, v105
    v_exp_f32 v111, v111
    v_exp_f32 v117, v117
    v_med3_f32 v98, v98, v100, 1.0
    v_med3_f32 v104, v104, v106, 1.0
    v_med3_f32 v110, v110, v112, 1.0
    v_med3_f32 v116, v116, v118, 1.0
    v_med3_f32 v99, v99, v101, 1.0
    v_med3_f32 v105, v105, v107, 1.0
    v_med3_f32 v111, v111, v113, 1.0
    v_med3_f32 v117, v117, v119, 1.0
    buffer_load_dwordx4 a[204:207], v32, s[40:43], s71 offen offset:1024
    v_pk_add_f32 v[98:99], v[98:99], v[22:23]
    v_pk_add_f32 v[104:105], v[104:105], v[22:23]
    v_pk_add_f32 v[110:111], v[110:111], v[22:23]
    v_pk_add_f32 v[116:117], v[116:117], v[22:23]
    v_cvt_pk_bf16_f32 v192, v98, v99
    v_cvt_pk_bf16_f32 v193, v104, v105
    v_cvt_pk_bf16_f32 v194, v110, v111
    v_cvt_pk_bf16_f32 v195, v116, v117
    v_pk_mul_f32 v[96:97], v[64:65], v[74:75] op_sel_hi:[1,0]
    v_pk_mul_f32 v[102:103], v[66:67], v[74:75] op_sel_hi:[1,0]
    v_pk_mul_f32 v[108:109], v[68:69], v[74:75] op_sel_hi:[1,0]
    v_pk_mul_f32 v[114:115], v[70:71], v[74:75] op_sel_hi:[1,0]
    v_pk_fma_f32 v[140:141], v[140:141], v[56:57], v[96:97]
    v_pk_fma_f32 v[142:143], v[142:143], v[58:59], v[102:103]
    v_pk_fma_f32 v[160:161], v[160:161], v[60:61], v[108:109]
    v_pk_fma_f32 v[162:163], v[162:163], v[62:63], v[114:115]
    v_pk_mul_f32 v[98:99], v[140:141], v[18:19]
    v_pk_mul_f32 v[104:105], v[142:143], v[18:19]
    v_pk_mul_f32 v[110:111], v[160:161], v[18:19]
    v_pk_mul_f32 v[116:117], v[162:163], v[18:19]
    v_pk_add_f32 v[100:101], v[140:141], v[20:21]
    v_pk_add_f32 v[106:107], v[142:143], v[20:21]
    v_pk_add_f32 v[112:113], v[160:161], v[20:21]
    v_pk_add_f32 v[118:119], v[162:163], v[20:21]
    buffer_load_dwordx4 a[208:211], v33, s[40:43], s71 offen offset:2048
    v_exp_f32 v98, v98
    v_exp_f32 v104, v104
    v_exp_f32 v110, v110
    v_exp_f32 v116, v116
    v_exp_f32 v99, v99
    v_exp_f32 v105, v105
    v_exp_f32 v111, v111
    v_exp_f32 v117, v117
    v_med3_f32 v98, v98, v100, 1.0
    v_med3_f32 v104, v104, v106, 1.0
    v_med3_f32 v110, v110, v112, 1.0
    v_med3_f32 v116, v116, v118, 1.0
    v_med3_f32 v99, v99, v101, 1.0
    v_med3_f32 v105, v105, v107, 1.0
    v_med3_f32 v111, v111, v113, 1.0
    v_med3_f32 v117, v117, v119, 1.0
    buffer_load_dwordx4 a[212:215], v34, s[40:43], s71 offen offset:3072
    v_pk_add_f32 v[98:99], v[98:99], v[22:23]
    v_pk_add_f32 v[104:105], v[104:105], v[22:23]
    v_pk_add_f32 v[110:111], v[110:111], v[22:23]
    v_pk_add_f32 v[116:117], v[116:117], v[22:23]
    v_cvt_pk_bf16_f32 v196, v98, v99
    v_cvt_pk_bf16_f32 v197, v104, v105
    v_cvt_pk_bf16_f32 v198, v110, v111
    v_cvt_pk_bf16_f32 v199, v116, v117
    v_pk_mul_f32 v[96:97], v[64:65], v[76:77] op_sel_hi:[1,0]
    v_pk_mul_f32 v[102:103], v[66:67], v[76:77] op_sel_hi:[1,0]
    v_pk_mul_f32 v[108:109], v[68:69], v[76:77] op_sel_hi:[1,0]
    v_pk_mul_f32 v[114:115], v[70:71], v[76:77] op_sel_hi:[1,0]
    v_pk_fma_f32 v[144:145], v[144:145], v[56:57], v[96:97]
    v_pk_fma_f32 v[146:147], v[146:147], v[58:59], v[102:103]
    v_pk_fma_f32 v[164:165], v[164:165], v[60:61], v[108:109]
    v_pk_fma_f32 v[166:167], v[166:167], v[62:63], v[114:115]
    v_pk_mul_f32 v[98:99], v[144:145], v[18:19]
    v_pk_mul_f32 v[104:105], v[146:147], v[18:19]
    v_pk_mul_f32 v[110:111], v[164:165], v[18:19]
    v_pk_mul_f32 v[116:117], v[166:167], v[18:19]
    v_pk_add_f32 v[100:101], v[144:145], v[20:21]
    v_pk_add_f32 v[106:107], v[146:147], v[20:21]
    v_pk_add_f32 v[112:113], v[164:165], v[20:21]
    v_pk_add_f32 v[118:119], v[166:167], v[20:21]
    buffer_load_dwordx4 a[216:219], v35, s[40:43], s71 offen offset:0
    v_exp_f32 v98, v98
    v_exp_f32 v104, v104
    v_exp_f32 v110, v110
    v_exp_f32 v116, v116
    v_exp_f32 v99, v99
    v_exp_f32 v105, v105
    v_exp_f32 v111, v111
    v_exp_f32 v117, v117
    v_med3_f32 v98, v98, v100, 1.0
    v_med3_f32 v104, v104, v106, 1.0
    v_med3_f32 v110, v110, v112, 1.0
    v_med3_f32 v116, v116, v118, 1.0
    v_med3_f32 v99, v99, v101, 1.0
    v_med3_f32 v105, v105, v107, 1.0
    v_med3_f32 v111, v111, v113, 1.0
    v_med3_f32 v117, v117, v119, 1.0
    s_add_u32 s71, s69, s61
    s_cmp_eq_u32 s71, 10
    s_cselect_b32 s71, 0, s71
    s_mul_i32 s71, s71, 245760
    s_add_u32 s69, s69, 1
    s_cmp_eq_u32 s69, 10
    s_cselect_b32 s69, 0, s69
    s_add_u32 s69, s69, 1
    s_cmp_eq_u32 s69, 10
    s_cselect_b32 s69, 0, s69
    buffer_load_dwordx4 a[220:223], v31, s[40:43], s71 offen offset:0
    v_pk_add_f32 v[98:99], v[98:99], v[22:23]
    v_pk_add_f32 v[104:105], v[104:105], v[22:23]
    v_pk_add_f32 v[110:111], v[110:111], v[22:23]
    v_pk_add_f32 v[116:117], v[116:117], v[22:23]
    v_cndmask_b32 v98, v144, v98, s[22:23]
    v_cndmask_b32 v104, v146, v104, s[22:23]
    v_cndmask_b32 v110, v164, v110, s[22:23]
    v_cndmask_b32 v116, v166, v116, s[22:23]
    v_cndmask_b32 v99, v145, v99, s[22:23]
    v_cndmask_b32 v105, v147, v105, s[22:23]
    v_cndmask_b32 v111, v165, v111, s[22:23]
    v_cndmask_b32 v117, v167, v117, s[22:23]
    v_cvt_pk_bf16_f32 v200, v98, v99
    v_cvt_pk_bf16_f32 v201, v104, v105
    v_cvt_pk_bf16_f32 v202, v110, v111
    v_cvt_pk_bf16_f32 v203, v116, v117
    buffer_load_dwordx4 a[224:227], v32, s[40:43], s71 offen offset:1024
    v_pk_mul_f32 v[96:97], v[64:65], v[78:79] op_sel_hi:[1,0]
    v_pk_mul_f32 v[102:103], v[66:67], v[78:79] op_sel_hi:[1,0]
    v_pk_mul_f32 v[108:109], v[68:69], v[78:79] op_sel_hi:[1,0]
    v_pk_mul_f32 v[114:115], v[70:71], v[78:79] op_sel_hi:[1,0]
    v_pk_fma_f32 v[148:149], v[148:149], v[56:57], v[96:97]
    v_pk_fma_f32 v[150:151], v[150:151], v[58:59], v[102:103]
    v_pk_fma_f32 v[168:169], v[168:169], v[60:61], v[108:109]
    v_pk_fma_f32 v[170:171], v[170:171], v[62:63], v[114:115]
    v_cvt_pk_bf16_f32 v204, v148, v149
    v_cvt_pk_bf16_f32 v205, v150, v151
    v_cvt_pk_bf16_f32 v206, v168, v169
    v_cvt_pk_bf16_f32 v207, v170, v171
    v_pk_mul_f32 v[96:97], v[64:65], v[80:81] op_sel_hi:[1,0]
    v_pk_mul_f32 v[102:103], v[66:67], v[80:81] op_sel_hi:[1,0]
    v_pk_mul_f32 v[108:109], v[68:69], v[80:81] op_sel_hi:[1,0]
    v_pk_mul_f32 v[114:115], v[70:71], v[80:81] op_sel_hi:[1,0]
    v_pk_fma_f32 v[152:153], v[152:153], v[56:57], v[96:97]
    v_pk_fma_f32 v[154:155], v[154:155], v[58:59], v[102:103]
    v_pk_fma_f32 v[172:173], v[172:173], v[60:61], v[108:109]
    v_pk_fma_f32 v[174:175], v[174:175], v[62:63], v[114:115]
    v_cvt_pk_bf16_f32 v208, v152, v153
    v_cvt_pk_bf16_f32 v209, v154, v155
    v_cvt_pk_bf16_f32 v210, v172, v173
    v_cvt_pk_bf16_f32 v211, v174, v175
    v_mfma_f32_16x16x32_bf16 v[136:139], v[192:195], v[200:203], 0
    v_mfma_f32_16x16x32_bf16 v[140:143], v[192:195], v[204:207], 0
    v_mfma_f32_16x16x32_bf16 v[144:147], v[196:199], v[200:203], 0
    buffer_load_dwordx4 a[228:231], v33, s[40:43], s71 offen offset:2048
    v_mfma_f32_16x16x32_bf16 v[148:151], v[196:199], v[204:207], 0
    v_mfma_f32_16x16x32_bf16 v[152:155], v[196:199], v[208:211], 0
    v_mfma_f32_16x16x32_bf16 v[156:159], v[200:203], v[204:207], 0
    buffer_load_dwordx4 a[232:235], v34, s[40:43], s71 offen offset:3072
    v_mfma_f32_16x16x32_bf16 v[160:163], v[200:203], v[208:211], 0
    v_mfma_f32_16x16x32_bf16 v[164:167], v[192:195], v[40:43], 0
    v_mfma_f32_16x16x32_bf16 v[168:171], v[196:199], v[40:43], 0
    v_mfma_f32_16x16x32_bf16 v[172:175], v[200:203], v[40:43], 0
    s_mul_i32 s66, s60, 1792
    s_add_u32 s67, s66, 147456
    v_add_u32 v13, s67, v17
    s_mul_i32 s67, s64, 7168
    s_add_u32 s66, s66, s67
    s_add_u32 s66, s66, 2686976
    s_mov_b32 exec_lo, 0xff00ff00
    s_mov_b32 exec_hi, 0xff00ff00
    ds_write_b128 v127, v[136:139]
    s_mov_b32 exec_lo, 0xfff0fff
    s_mov_b32 exec_hi, 0xfff0fff
    ds_write_b128 v128, v[140:143]
    s_mov_b32 exec_lo, 0xff00
    s_mov_b32 exec_hi, 0x0
    ds_write_b128 v129, v[144:147]
    s_mov_b32 exec_lo, 0xf0000fff
    s_mov_b32 exec_hi, 0xf000f000
    ds_write_b128 v130, v[148:151]
    s_mov_b32 exec_lo, 0xffff0000
    s_mov_b32 exec_hi, 0xffffffff
    ds_write_b128 v131, v[152:155]
    s_mov_b32 exec_lo, 0xf000f000
    s_mov_b32 exec_hi, 0x0
    ds_write_b128 v132, v[156:159]
    s_mov_b32 exec_lo, 0xffffffff
    s_mov_b32 exec_hi, 0x0
    ds_write_b128 v133, v[160:163]
    s_mov_b32 exec_lo, 0x10001
    s_mov_b32 exec_hi, 0x10001
    ds_write_b128 v124, v[164:167] offset:320
    ds_write_b128 v125, v[168:171] offset:320
    s_mov_b32 exec_lo, 0x10001
    s_mov_b32 exec_hi, 0x0
    ds_write_b128 v126, v[172:175] offset:320
    s_mov_b64 exec, -1
    buffer_load_dwordx4 a[236:239], v35, s[40:43], s71 offen offset:0
    s_waitcnt vmcnt(20) lgkmcnt(0)
    s_barrier
    ds_read_b32 v136, v13 offset:0
    ds_read_b32 v144, v13 offset:7168
    ds_read_b32 v137, v13 offset:256
    ds_read_b32 v145, v13 offset:7424
    ds_read_b32 v138, v13 offset:512
    ds_read_b32 v146, v13 offset:7680
    ds_read_b32 v139, v13 offset:768
    ds_read_b32 v147, v13 offset:7936
    ds_read_b32 v140, v13 offset:1024
    ds_read_b32 v148, v13 offset:8192
    ds_read_b32 v141, v13 offset:1280
    ds_read_b32 v149, v13 offset:8448
    ds_read_b32 v142, v13 offset:1536
    ds_read_b32 v150, v13 offset:8704
    s_waitcnt lgkmcnt(12)
    v_add_f32 v136, v136, v144
    buffer_atomic_add_f32 v136, v17, s[44:47], s66 offen offset:0
    s_waitcnt lgkmcnt(10)
    v_add_f32 v137, v137, v145
    buffer_atomic_add_f32 v137, v17, s[44:47], s66 offen offset:256
    s_waitcnt lgkmcnt(8)
    v_add_f32 v138, v138, v146
    buffer_atomic_add_f32 v138, v17, s[44:47], s66 offen offset:512
    s_waitcnt lgkmcnt(6)
    v_add_f32 v139, v139, v147
    buffer_atomic_add_f32 v139, v17, s[44:47], s66 offen offset:768
    s_waitcnt lgkmcnt(4)
    v_add_f32 v140, v140, v148
    buffer_atomic_add_f32 v140, v17, s[44:47], s66 offen offset:1024
    s_waitcnt lgkmcnt(2)
    v_add_f32 v141, v141, v149
    buffer_atomic_add_f32 v141, v17, s[44:47], s66 offen offset:1280
    s_waitcnt lgkmcnt(0)
    v_add_f32 v142, v142, v150
    s_mov_b32 exec_hi, 0xf
    buffer_atomic_add_f32 v142, v17, s[44:47], s66 offen offset:1536
    s_mov_b64 exec, -1
    ds_read_b128 v[56:59], v44 offset:0
    ds_read_b128 v[60:63], v44 offset:2048
    ds_read_b64_tr_b16 v[64:65], v52 offset:20480
    ds_read_b64_tr_b16 v[66:67], v52 offset:21760
    ds_read_b64_tr_b16 v[68:69], v52 offset:20512
    ds_read_b64_tr_b16 v[70:71], v52 offset:21792
    ds_read_b64_tr_b16 v[72:73], v52 offset:20528
    ds_read_b64_tr_b16 v[74:75], v52 offset:21808
    ds_read_b128 v[76:79], v45 offset:0
    ds_read_b128 v[80:83], v45 offset:2048
    ds_read_b64_tr_b16 v[84:85], v53 offset:20480
    ds_read_b64_tr_b16 v[86:87], v53 offset:21760
    ds_read_b64_tr_b16 v[88:89], v53 offset:20512
    ds_read_b64_tr_b16 v[90:91], v53 offset:21792
    ds_read_b64_tr_b16 v[92:93], v53 offset:20528
    ds_read_b64_tr_b16 v[94:95], v53 offset:21808
    buffer_load_dwordx4 a[240:243], v36, s[48:51], s6 offen
    buffer_load_dwordx4 a[244:247], v36, s[48:51], s7 offen
    buffer_load_dwordx4 a[248:251], v36, s[48:51], s8 offen
    buffer_load_dwordx4 a[252:255], v36, s[48:51], s9 offen
    s_and_b32 s65, s2, 7
    s_lshr_b32 s66, s2, 3
    s_and_b32 s56, s66, 15
    s_lshr_b32 s66, s66, 4
    s_lshl_b32 s57, s65, 1
    s_add_u32 s57, s57, s66
    s_and_b32 s53, s56, 7
    s_lshr_b32 s66, s56, 3
    s_lshl_b32 s52, s57, 1
    s_add_u32 s52, s52, s66
    s_mul_i32 s65, s53, 5
    s_add_u32 s54, s65, 1
    s_lshr_b32 s54, s54, 1
    s_add_u32 s55, s65, 4
    s_bitcmp1_b32 s53, 0
    s_cselect_b32 s55, s65, s55
    s_lshl_b32 s65, s52, 2
    s_add_u32 s65, s65, s60
    s_mul_i32 s66, s65, 20480
    s_lshl_b32 s58, s54, 6
    s_add_u32 s58, s58, s66
    s_lshr_b32 s67, s55, 1
    s_lshl_b32 s67, s67, 6
    s_and_b32 s68, s55, 1
    s_lshl_b32 s68, s68, 3
    s_add_u32 s67, s67, s68
    s_add_u32 s59, s67, s66
    s_mov_b32 s36, s16
    s_mov_b32 s37, s17
    s_mov_b32 s38, 2621440
    s_mov_b32 s39, 0x20000
    s_mul_i32 s22, s53, 102400
    s_mul_i32 s67, s60, 25600
    s_add_u32 s22, s22, s67
    s_add_u32 s22, s22, 2752512
    s_lshl_b32 s23, s64, 7
    s_add_u32 s23, s23, 12288
    s_add_u32 s23, s23, s74
    s_mul_i32 s35, s53, 286720
    s_mul_i32 s65, s60, 5120
    s_add_u32 s35, s35, s65
    s_add_u32 s35, s35, 9240576
    s_waitcnt lgkmcnt(0)
    v_mfma_f32_16x16x32_bf16 v[240:243], v[64:67], v[40:43], 0
    ds_read_b128 v[96:99], v44 offset:8192
    ds_read_b128 v[100:103], v44 offset:10240
    v_mfma_f32_16x16x32_bf16 v[244:247], v[68:71], v[40:43], 0
    ds_read_b64_tr_b16 v[104:105], v52 offset:30720
    ds_read_b64_tr_b16 v[106:107], v52 offset:32000
    v_mfma_f32_16x16x32_bf16 v[248:251], v[72:75], v[40:43], 0
    ds_read_b64_tr_b16 v[108:109], v52 offset:30752
    ds_read_b64_tr_b16 v[110:111], v52 offset:32032
    v_mfma_f32_16x16x32_bf16 v[216:219], v[64:67], v[56:59], 0
    ds_read_b64_tr_b16 v[112:113], v52 offset:30768
    ds_read_b64_tr_b16 v[114:115], v52 offset:32048
    v_mfma_f32_16x16x32_bf16 v[228:231], v[64:67], v[60:63], 0
    ds_read_b128 v[116:119], v45 offset:8192
    ds_read_b128 v[120:123], v45 offset:10240
    v_mfma_f32_16x16x32_bf16 v[220:223], v[68:71], v[56:59], 0
    ds_read_b64_tr_b16 v[124:125], v53 offset:30720
    ds_read_b64_tr_b16 v[126:127], v53 offset:32000
    v_mfma_f32_16x16x32_bf16 v[232:235], v[68:71], v[60:63], 0
    ds_read_b64_tr_b16 v[128:129], v53 offset:30752
    ds_read_b64_tr_b16 v[130:131], v53 offset:32032
    v_mfma_f32_16x16x32_bf16 v[224:227], v[72:75], v[56:59], 0
    ds_read_b64_tr_b16 v[132:133], v53 offset:30768
    ds_read_b64_tr_b16 v[134:135], v53 offset:32048
    v_mfma_f32_16x16x32_bf16 v[236:239], v[72:75], v[60:63], 0
    v_mfma_f32_16x16x32_bf16 v[216:219], v[84:87], v[76:79], v[216:219]
    v_mfma_f32_16x16x32_bf16 v[228:231], v[84:87], v[80:83], v[228:231]
    v_mfma_f32_16x16x32_bf16 v[220:223], v[88:91], v[76:79], v[220:223]
    v_mfma_f32_16x16x32_bf16 v[232:235], v[88:91], v[80:83], v[232:235]
    v_mfma_f32_16x16x32_bf16 v[224:227], v[92:95], v[76:79], v[224:227]
    v_mfma_f32_16x16x32_bf16 v[236:239], v[92:95], v[80:83], v[236:239]
    s_waitcnt lgkmcnt(0)
    s_waitcnt vmcnt(26)
    s_barrier
    v_mfma_f32_16x16x32_bf16 v[240:243], v[104:107], v[40:43], v[240:243]
    ds_read_b128 v[56:59], v44 offset:16384
    ds_read_b128 v[60:63], v44 offset:18432
    v_mfma_f32_16x16x32_bf16 v[244:247], v[108:111], v[40:43], v[244:247]
    ds_read_b64_tr_b16 v[64:65], v52 offset:40960
    ds_read_b64_tr_b16 v[66:67], v52 offset:42240
    v_mfma_f32_16x16x32_bf16 v[248:251], v[112:115], v[40:43], v[248:251]
    ds_read_b64_tr_b16 v[68:69], v52 offset:40992
    ds_read_b64_tr_b16 v[70:71], v52 offset:42272
    v_mfma_f32_16x16x32_bf16 v[216:219], v[104:107], v[96:99], v[216:219]
    ds_read_b64_tr_b16 v[72:73], v52 offset:41008
    ds_read_b64_tr_b16 v[74:75], v52 offset:42288
    v_mfma_f32_16x16x32_bf16 v[228:231], v[104:107], v[100:103], v[228:231]
    ds_read_b128 v[76:79], v45 offset:16384
    ds_read_b128 v[80:83], v45 offset:18432
    v_mfma_f32_16x16x32_bf16 v[220:223], v[108:111], v[96:99], v[220:223]
    ds_read_b64_tr_b16 v[84:85], v53 offset:40960
    ds_read_b64_tr_b16 v[86:87], v53 offset:42240
    v_mfma_f32_16x16x32_bf16 v[232:235], v[108:111], v[100:103], v[232:235]
    ds_read_b64_tr_b16 v[88:89], v53 offset:40992
    ds_read_b64_tr_b16 v[90:91], v53 offset:42272
    v_mfma_f32_16x16x32_bf16 v[224:227], v[112:115], v[96:99], v[224:227]
    ds_read_b64_tr_b16 v[92:93], v53 offset:41008
    ds_read_b64_tr_b16 v[94:95], v53 offset:42288
    v_mfma_f32_16x16x32_bf16 v[236:239], v[112:115], v[100:103], v[236:239]
    v_mfma_f32_16x16x32_bf16 v[216:219], v[124:127], v[116:119], v[216:219]
    v_mfma_f32_16x16x32_bf16 v[228:231], v[124:127], v[120:123], v[228:231]
    v_mfma_f32_16x16x32_bf16 v[220:223], v[128:131], v[116:119], v[220:223]
    v_mfma_f32_16x16x32_bf16 v[232:235], v[128:131], v[120:123], v[232:235]
    v_mfma_f32_16x16x32_bf16 v[224:227], v[132:135], v[116:119], v[224:227]
    v_mfma_f32_16x16x32_bf16 v[236:239], v[132:135], v[120:123], v[236:239]
    s_waitcnt lgkmcnt(0)
    v_mfma_f32_16x16x32_bf16 v[240:243], v[64:67], v[40:43], v[240:243]
    ds_read_b128 v[96:99], v44 offset:24576
    ds_read_b128 v[100:103], v44 offset:26624
    v_mfma_f32_16x16x32_bf16 v[244:247], v[68:71], v[40:43], v[244:247]
    ds_read_b64_tr_b16 v[104:105], v52 offset:51200
    ds_read_b64_tr_b16 v[106:107], v52 offset:52480
    v_mfma_f32_16x16x32_bf16 v[248:251], v[72:75], v[40:43], v[248:251]
    ds_read_b64_tr_b16 v[108:109], v52 offset:51232
    ds_read_b64_tr_b16 v[110:111], v52 offset:52512
    v_mfma_f32_16x16x32_bf16 v[216:219], v[64:67], v[56:59], v[216:219]
    ds_read_b64_tr_b16 v[112:113], v52 offset:51248
    ds_read_b64_tr_b16 v[114:115], v52 offset:52528
    v_mfma_f32_16x16x32_bf16 v[228:231], v[64:67], v[60:63], v[228:231]
    ds_read_b128 v[116:119], v45 offset:24576
    ds_read_b128 v[120:123], v45 offset:26624
    v_mfma_f32_16x16x32_bf16 v[220:223], v[68:71], v[56:59], v[220:223]
    ds_read_b64_tr_b16 v[124:125], v53 offset:51200
    ds_read_b64_tr_b16 v[126:127], v53 offset:52480
    v_mfma_f32_16x16x32_bf16 v[232:235], v[68:71], v[60:63], v[232:235]
    ds_read_b64_tr_b16 v[128:129], v53 offset:51232
    ds_read_b64_tr_b16 v[130:131], v53 offset:52512
    s_add_u32 s3, s74, 13312
    s_mov_b64 exec, 0xff
    buffer_load_dword v8, v6, s[44:47], s3 offen sc1
    s_mov_b64 exec, -1
    v_mfma_f32_16x16x32_bf16 v[224:227], v[72:75], v[56:59], v[224:227]
    ds_read_b64_tr_b16 v[132:133], v53 offset:51248
    ds_read_b64_tr_b16 v[134:135], v53 offset:52528
    v_mfma_f32_16x16x32_bf16 v[236:239], v[72:75], v[60:63], v[236:239]
    v_mfma_f32_16x16x32_bf16 v[216:219], v[84:87], v[76:79], v[216:219]
    v_mfma_f32_16x16x32_bf16 v[228:231], v[84:87], v[80:83], v[228:231]
    v_mfma_f32_16x16x32_bf16 v[220:223], v[88:91], v[76:79], v[220:223]
    v_mfma_f32_16x16x32_bf16 v[232:235], v[88:91], v[80:83], v[232:235]
    v_mfma_f32_16x16x32_bf16 v[224:227], v[92:95], v[76:79], v[224:227]
    v_mfma_f32_16x16x32_bf16 v[236:239], v[92:95], v[80:83], v[236:239]
    s_waitcnt lgkmcnt(0)
    s_waitcnt vmcnt(22)
    s_barrier
    s_waitcnt vmcnt(17)
    v_mfma_f32_16x16x32_bf16 v[240:243], v[104:107], v[40:43], v[240:243]
    ds_read_b128 v[56:59], v44 offset:32768
    ds_read_b128 v[60:63], v44 offset:34816
    v_mfma_f32_16x16x32_bf16 v[244:247], v[108:111], v[40:43], v[244:247]
    ds_read_b64_tr_b16 v[64:65], v52 offset:0
    ds_read_b64_tr_b16 v[66:67], v52 offset:1280
    v_mfma_f32_16x16x32_bf16 v[248:251], v[112:115], v[40:43], v[248:251]
    ds_read_b64_tr_b16 v[68:69], v52 offset:32
    ds_read_b64_tr_b16 v[70:71], v52 offset:1312
    v_mfma_f32_16x16x32_bf16 v[216:219], v[104:107], v[96:99], v[216:219]
    ds_read_b64_tr_b16 v[72:73], v52 offset:48
    ds_read_b64_tr_b16 v[74:75], v52 offset:1328
    v_mfma_f32_16x16x32_bf16 v[228:231], v[104:107], v[100:103], v[228:231]
    ds_read_b128 v[76:79], v45 offset:32768
    ds_read_b128 v[80:83], v45 offset:34816
    v_mfma_f32_16x16x32_bf16 v[220:223], v[108:111], v[96:99], v[220:223]
    ds_read_b64_tr_b16 v[84:85], v53 offset:0
    ds_read_b64_tr_b16 v[86:87], v53 offset:1280
    v_mfma_f32_16x16x32_bf16 v[232:235], v[108:111], v[100:103], v[232:235]
    ds_read_b64_tr_b16 v[88:89], v53 offset:32
    ds_read_b64_tr_b16 v[90:91], v53 offset:1312
    v_add_u32 v12, s73, v4
    v_mfma_f32_16x16x32_bf16 v[224:227], v[112:115], v[96:99], v[224:227]
    ds_read_b64_tr_b16 v[92:93], v53 offset:48
    ds_read_b64_tr_b16 v[94:95], v53 offset:1328
    v_mfma_f32_16x16x32_bf16 v[236:239], v[112:115], v[100:103], v[236:239]
    ds_write_b128 v12, a[200:203] offset:20480
    v_mfma_f32_16x16x32_bf16 v[216:219], v[124:127], v[116:119], v[216:219]
    v_mfma_f32_16x16x32_bf16 v[228:231], v[124:127], v[120:123], v[228:231]
    ds_write_b128 v12, a[204:207] offset:21504
    v_mfma_f32_16x16x32_bf16 v[220:223], v[128:131], v[116:119], v[220:223]
    v_mfma_f32_16x16x32_bf16 v[232:235], v[128:131], v[120:123], v[232:235]
    ds_write_b128 v12, a[208:211] offset:22528
    v_mfma_f32_16x16x32_bf16 v[224:227], v[132:135], v[116:119], v[224:227]
    v_mfma_f32_16x16x32_bf16 v[236:239], v[132:135], v[120:123], v[236:239]
    s_waitcnt lgkmcnt(0)
    v_mfma_f32_16x16x32_bf16 v[240:243], v[64:67], v[40:43], v[240:243]
    ds_read_b128 v[96:99], v46 offset:0
    ds_read_b128 v[100:103], v46 offset:2048
    v_mfma_f32_16x16x32_bf16 v[244:247], v[68:71], v[40:43], v[244:247]
    ds_read_b64_tr_b16 v[104:105], v52 offset:10240
    ds_read_b64_tr_b16 v[106:107], v52 offset:11520
    v_mfma_f32_16x16x32_bf16 v[248:251], v[72:75], v[40:43], v[248:251]
    ds_read_b64_tr_b16 v[108:109], v52 offset:10272
    ds_read_b64_tr_b16 v[110:111], v52 offset:11552
    v_mfma_f32_16x16x32_bf16 v[216:219], v[64:67], v[56:59], v[216:219]
    ds_read_b64_tr_b16 v[112:113], v52 offset:10288
    ds_read_b64_tr_b16 v[114:115], v52 offset:11568
    v_mfma_f32_16x16x32_bf16 v[228:231], v[64:67], v[60:63], v[228:231]
    ds_read_b128 v[116:119], v47 offset:0
    ds_read_b128 v[120:123], v47 offset:2048
    v_mfma_f32_16x16x32_bf16 v[220:223], v[68:71], v[56:59], v[220:223]
    ds_read_b64_tr_b16 v[124:125], v53 offset:10240
    ds_read_b64_tr_b16 v[126:127], v53 offset:11520
    v_mfma_f32_16x16x32_bf16 v[232:235], v[68:71], v[60:63], v[232:235]
    ds_read_b64_tr_b16 v[128:129], v53 offset:10272
    ds_read_b64_tr_b16 v[130:131], v53 offset:11552
    ds_write_b128 v12, a[212:215] offset:23552
    v_mfma_f32_16x16x32_bf16 v[224:227], v[72:75], v[56:59], v[224:227]
    ds_read_b64_tr_b16 v[132:133], v53 offset:10288
    ds_read_b64_tr_b16 v[134:135], v53 offset:11568
    v_mfma_f32_16x16x32_bf16 v[236:239], v[72:75], v[60:63], v[236:239]
    v_mfma_f32_16x16x32_bf16 v[216:219], v[84:87], v[76:79], v[216:219]
    v_mfma_f32_16x16x32_bf16 v[228:231], v[84:87], v[80:83], v[228:231]
    ds_write_b128 v12, a[216:219] offset:24576
    v_mfma_f32_16x16x32_bf16 v[220:223], v[88:91], v[76:79], v[220:223]
    v_mfma_f32_16x16x32_bf16 v[232:235], v[88:91], v[80:83], v[232:235]
    v_mfma_f32_16x16x32_bf16 v[224:227], v[92:95], v[76:79], v[224:227]
    v_mfma_f32_16x16x32_bf16 v[236:239], v[92:95], v[80:83], v[236:239]
    s_waitcnt lgkmcnt(0)
    s_barrier
    s_waitcnt vmcnt(12)
    v_mfma_f32_16x16x32_bf16 v[240:243], v[104:107], v[40:43], v[240:243]
    ds_read_b128 v[56:59], v46 offset:8192
    ds_read_b128 v[60:63], v46 offset:10240
    v_mfma_f32_16x16x32_bf16 v[244:247], v[108:111], v[40:43], v[244:247]
    ds_read_b64_tr_b16 v[64:65], v52 offset:20480
    ds_read_b64_tr_b16 v[66:67], v52 offset:21760
    v_mfma_f32_16x16x32_bf16 v[248:251], v[112:115], v[40:43], v[248:251]
    ds_read_b64_tr_b16 v[68:69], v52 offset:20512
    ds_read_b64_tr_b16 v[70:71], v52 offset:21792
    v_mfma_f32_16x16x32_bf16 v[216:219], v[104:107], v[96:99], v[216:219]
    ds_read_b64_tr_b16 v[72:73], v52 offset:20528
    ds_read_b64_tr_b16 v[74:75], v52 offset:21808
    v_mfma_f32_16x16x32_bf16 v[228:231], v[104:107], v[100:103], v[228:231]
    ds_read_b128 v[76:79], v47 offset:8192
    ds_read_b128 v[80:83], v47 offset:10240
    v_mfma_f32_16x16x32_bf16 v[220:223], v[108:111], v[96:99], v[220:223]
    ds_read_b64_tr_b16 v[84:85], v53 offset:20480
    ds_read_b64_tr_b16 v[86:87], v53 offset:21760
    v_mfma_f32_16x16x32_bf16 v[232:235], v[108:111], v[100:103], v[232:235]
    ds_read_b64_tr_b16 v[88:89], v53 offset:20512
    ds_read_b64_tr_b16 v[90:91], v53 offset:21792
    v_add_u32 v12, s73, v4
    v_mfma_f32_16x16x32_bf16 v[224:227], v[112:115], v[96:99], v[224:227]
    ds_read_b64_tr_b16 v[92:93], v53 offset:20528
    ds_read_b64_tr_b16 v[94:95], v53 offset:21808
    v_mfma_f32_16x16x32_bf16 v[236:239], v[112:115], v[100:103], v[236:239]
    ds_write_b128 v12, a[220:223] offset:40960
    v_mfma_f32_16x16x32_bf16 v[216:219], v[124:127], v[116:119], v[216:219]
    v_mfma_f32_16x16x32_bf16 v[228:231], v[124:127], v[120:123], v[228:231]
    ds_write_b128 v12, a[224:227] offset:41984
    v_mfma_f32_16x16x32_bf16 v[220:223], v[128:131], v[116:119], v[220:223]
    v_mfma_f32_16x16x32_bf16 v[232:235], v[128:131], v[120:123], v[232:235]
    ds_write_b128 v12, a[228:231] offset:43008
    v_mfma_f32_16x16x32_bf16 v[224:227], v[132:135], v[116:119], v[224:227]
    v_mfma_f32_16x16x32_bf16 v[236:239], v[132:135], v[120:123], v[236:239]
    s_waitcnt lgkmcnt(0)
    v_mfma_f32_16x16x32_bf16 v[240:243], v[64:67], v[40:43], v[240:243]
    ds_read_b128 v[96:99], v46 offset:16384
    ds_read_b128 v[100:103], v46 offset:18432
    v_mfma_f32_16x16x32_bf16 v[244:247], v[68:71], v[40:43], v[244:247]
    ds_read_b64_tr_b16 v[104:105], v52 offset:30720
    ds_read_b64_tr_b16 v[106:107], v52 offset:32000
    v_mfma_f32_16x16x32_bf16 v[248:251], v[72:75], v[40:43], v[248:251]
    ds_read_b64_tr_b16 v[108:109], v52 offset:30752
    ds_read_b64_tr_b16 v[110:111], v52 offset:32032
    v_mfma_f32_16x16x32_bf16 v[216:219], v[64:67], v[56:59], v[216:219]
    ds_read_b64_tr_b16 v[112:113], v52 offset:30768
    ds_read_b64_tr_b16 v[114:115], v52 offset:32048
    v_mfma_f32_16x16x32_bf16 v[228:231], v[64:67], v[60:63], v[228:231]
    ds_read_b128 v[116:119], v47 offset:16384
    ds_read_b128 v[120:123], v47 offset:18432
    v_mfma_f32_16x16x32_bf16 v[220:223], v[68:71], v[56:59], v[220:223]
    ds_read_b64_tr_b16 v[124:125], v53 offset:30720
    ds_read_b64_tr_b16 v[126:127], v53 offset:32000
    v_mfma_f32_16x16x32_bf16 v[232:235], v[68:71], v[60:63], v[232:235]
    ds_read_b64_tr_b16 v[128:129], v53 offset:30752
    ds_read_b64_tr_b16 v[130:131], v53 offset:32032
    ds_write_b128 v12, a[232:235] offset:44032
    v_mfma_f32_16x16x32_bf16 v[224:227], v[72:75], v[56:59], v[224:227]
    ds_read_b64_tr_b16 v[132:133], v53 offset:30768
    ds_read_b64_tr_b16 v[134:135], v53 offset:32048
    v_mfma_f32_16x16x32_bf16 v[236:239], v[72:75], v[60:63], v[236:239]
    v_mfma_f32_16x16x32_bf16 v[216:219], v[84:87], v[76:79], v[216:219]
    v_mfma_f32_16x16x32_bf16 v[228:231], v[84:87], v[80:83], v[228:231]
    ds_write_b128 v12, a[236:239] offset:45056
    v_mfma_f32_16x16x32_bf16 v[220:223], v[88:91], v[76:79], v[220:223]
    v_mfma_f32_16x16x32_bf16 v[232:235], v[88:91], v[80:83], v[232:235]
    v_mfma_f32_16x16x32_bf16 v[224:227], v[92:95], v[76:79], v[224:227]
    v_mfma_f32_16x16x32_bf16 v[236:239], v[92:95], v[80:83], v[236:239]
    s_waitcnt lgkmcnt(0)
    s_waitcnt vmcnt(5)
    s_cmp_lg_u32 s60, 0
    s_cbranch_scc1 Lok_1008
    s_waitcnt vmcnt(0)
    s_mov_b32 s75, 0
    s_mov_b64 exec, 255
Lp_1007:
    v_cmp_gt_u32 vcc, 32, v8
    s_add_u32 s75, s75, 1
    s_cmp_eq_u64 vcc, 0
    s_cbranch_scc1 Lok_1008
    s_cmp_ge_u32 s75, 200000
    s_cbranch_scc1 Lok_1008
    s_sleep 1
    buffer_load_dword v8, v6, s[44:47], s3 offen offset:0 sc1
    s_waitcnt vmcnt(0)
    s_branch Lp_1007
Lok_1008:
    s_mov_b64 exec, -1
    s_barrier
    s_mov_b64 exec, 1
    buffer_atomic_add v10, v11, s[44:47], s23 offen offset:0 sc1
    s_mov_b64 exec, -1
    s_waitcnt vmcnt(2)
    v_mfma_f32_16x16x32_bf16 v[240:243], v[104:107], v[40:43], v[240:243]
    ds_read_b128 v[56:59], v46 offset:24576
    ds_read_b128 v[60:63], v46 offset:26624
    v_mfma_f32_16x16x32_bf16 v[244:247], v[108:111], v[40:43], v[244:247]
    ds_read_b64_tr_b16 v[64:65], v52 offset:40960
    ds_read_b64_tr_b16 v[66:67], v52 offset:42240
    v_mfma_f32_16x16x32_bf16 v[248:251], v[112:115], v[40:43], v[248:251]
    ds_read_b64_tr_b16 v[68:69], v52 offset:40992
    ds_read_b64_tr_b16 v[70:71], v52 offset:42272
    v_mfma_f32_16x16x32_bf16 v[216:219], v[104:107], v[96:99], v[216:219]
    ds_read_b64_tr_b16 v[72:73], v52 offset:41008
    ds_read_b64_tr_b16 v[74:75], v52 offset:42288
    v_mfma_f32_16x16x32_bf16 v[228:231], v[104:107], v[100:103], v[228:231]
    ds_read_b128 v[76:79], v47 offset:24576
    ds_read_b128 v[80:83], v47 offset:26624
    v_mfma_f32_16x16x32_bf16 v[220:223], v[108:111], v[96:99], v[220:223]
    ds_read_b64_tr_b16 v[84:85], v53 offset:40960
    ds_read_b64_tr_b16 v[86:87], v53 offset:42240
    v_mfma_f32_16x16x32_bf16 v[232:235], v[108:111], v[100:103], v[232:235]
    ds_read_b64_tr_b16 v[88:89], v53 offset:40992
    ds_read_b64_tr_b16 v[90:91], v53 offset:42272
    s_lshl_b32 s66, s60, 10
    s_add_u32 s66, s66, 147456
    v_add_u32 v15, s66, v4
    v_mfma_f32_16x16x32_bf16 v[224:227], v[112:115], v[96:99], v[224:227]
    ds_read_b64_tr_b16 v[92:93], v53 offset:41008
    ds_read_b64_tr_b16 v[94:95], v53 offset:42288
    ds_write_b128 v15, a[240:243] offset:0
    v_mfma_f32_16x16x32_bf16 v[236:239], v[112:115], v[100:103], v[236:239]
    ds_write_b128 v15, a[244:247] offset:4096
    v_mfma_f32_16x16x32_bf16 v[216:219], v[124:127], v[116:119], v[216:219]
    buffer_load_dwordx4 a[0:3], v4, s[44:47], s22 offen offset:0 sc1
    v_mfma_f32_16x16x32_bf16 v[228:231], v[124:127], v[120:123], v[228:231]
    buffer_load_dwordx4 a[4:7], v4, s[44:47], s22 offen offset:1024 sc1
    v_mfma_f32_16x16x32_bf16 v[220:223], v[128:131], v[116:119], v[220:223]
    buffer_load_dwordx4 a[8:11], v4, s[44:47], s22 offen offset:2048 sc1
    v_mfma_f32_16x16x32_bf16 v[232:235], v[128:131], v[120:123], v[232:235]
    buffer_load_dwordx4 a[12:15], v4, s[44:47], s22 offen offset:3072 sc1
    v_mfma_f32_16x16x32_bf16 v[224:227], v[132:135], v[116:119], v[224:227]
    s_add_u32 s22, s22, 4096
    buffer_load_dwordx4 a[16:19], v4, s[44:47], s22 offen offset:0 sc1
    v_mfma_f32_16x16x32_bf16 v[236:239], v[132:135], v[120:123], v[236:239]
    s_waitcnt lgkmcnt(0)
    v_mfma_f32_16x16x32_bf16 v[240:243], v[64:67], v[40:43], v[240:243]
    ds_read_b128 v[96:99], v46 offset:32768
    ds_read_b128 v[100:103], v46 offset:34816
    v_mfma_f32_16x16x32_bf16 v[244:247], v[68:71], v[40:43], v[244:247]
    ds_read_b64_tr_b16 v[104:105], v52 offset:51200
    ds_read_b64_tr_b16 v[106:107], v52 offset:52480
    v_mfma_f32_16x16x32_bf16 v[248:251], v[72:75], v[40:43], v[248:251]
    ds_read_b64_tr_b16 v[108:109], v52 offset:51232
    ds_read_b64_tr_b16 v[110:111], v52 offset:52512
    v_mfma_f32_16x16x32_bf16 v[216:219], v[64:67], v[56:59], v[216:219]
    ds_read_b64_tr_b16 v[112:113], v52 offset:51248
    ds_read_b64_tr_b16 v[114:115], v52 offset:52528
    v_mfma_f32_16x16x32_bf16 v[228:231], v[64:67], v[60:63], v[228:231]
    ds_read_b128 v[116:119], v47 offset:32768
    ds_read_b128 v[120:123], v47 offset:34816
    v_mfma_f32_16x16x32_bf16 v[220:223], v[68:71], v[56:59], v[220:223]
    ds_read_b64_tr_b16 v[124:125], v53 offset:51200
    ds_read_b64_tr_b16 v[126:127], v53 offset:52480
    v_mfma_f32_16x16x32_bf16 v[232:235], v[68:71], v[60:63], v[232:235]
    ds_read_b64_tr_b16 v[128:129], v53 offset:51232
    ds_read_b64_tr_b16 v[130:131], v53 offset:52512
    ds_write_b128 v15, a[248:251] offset:8192
    v_mfma_f32_16x16x32_bf16 v[224:227], v[72:75], v[56:59], v[224:227]
    ds_read_b64_tr_b16 v[132:133], v53 offset:51248
    ds_read_b64_tr_b16 v[134:135], v53 offset:52528
    ds_write_b128 v15, a[252:255] offset:12288
    v_mfma_f32_16x16x32_bf16 v[236:239], v[72:75], v[60:63], v[236:239]
    buffer_load_dwordx4 a[20:23], v4, s[44:47], s22 offen offset:1024 sc1
    v_mfma_f32_16x16x32_bf16 v[216:219], v[84:87], v[76:79], v[216:219]
    buffer_load_dwordx4 a[24:27], v4, s[44:47], s22 offen offset:2048 sc1
    v_mfma_f32_16x16x32_bf16 v[228:231], v[84:87], v[80:83], v[228:231]
    v_mfma_f32_16x16x32_bf16 v[220:223], v[88:91], v[76:79], v[220:223]
    buffer_load_dwordx4 a[28:31], v4, s[44:47], s22 offen offset:3072 sc1
    v_mfma_f32_16x16x32_bf16 v[232:235], v[88:91], v[80:83], v[232:235]
    s_add_u32 s22, s22, 4096
    buffer_load_dwordx4 a[32:35], v4, s[44:47], s22 offen offset:0 sc1
    v_mfma_f32_16x16x32_bf16 v[224:227], v[92:95], v[76:79], v[224:227]
    buffer_load_dwordx4 a[36:39], v4, s[44:47], s22 offen offset:1024 sc1
    v_mfma_f32_16x16x32_bf16 v[236:239], v[92:95], v[80:83], v[236:239]
    s_waitcnt lgkmcnt(0)
    s_barrier
    v_mfma_f32_16x16x32_bf16 v[240:243], v[104:107], v[40:43], v[240:243]
    v_mfma_f32_16x16x32_bf16 v[244:247], v[108:111], v[40:43], v[244:247]
    v_add_u32 v15, 65536, v37
    v_mfma_f32_16x16x32_bf16 v[248:251], v[112:115], v[40:43], v[248:251]
    ds_read_b64_tr_b16 v[152:153], v15 offset:0
    ds_read_b64_tr_b16 v[154:155], v15 offset:512
    v_mfma_f32_16x16x32_bf16 v[216:219], v[104:107], v[96:99], v[216:219]
    v_mfma_f32_16x16x32_bf16 v[228:231], v[104:107], v[100:103], v[228:231]
    ds_read_b64_tr_b16 v[156:157], v15 offset:4096
    ds_read_b64_tr_b16 v[158:159], v15 offset:4608
    v_mfma_f32_16x16x32_bf16 v[220:223], v[108:111], v[96:99], v[220:223]
    ds_read_b64_tr_b16 v[160:161], v15 offset:8192
    ds_read_b64_tr_b16 v[162:163], v15 offset:8704
    v_mfma_f32_16x16x32_bf16 v[232:235], v[108:111], v[100:103], v[232:235]
    v_mfma_f32_16x16x32_bf16 v[224:227], v[112:115], v[96:99], v[224:227]
    ds_read_b64_tr_b16 v[164:165], v15 offset:12288
    ds_read_b64_tr_b16 v[166:167], v15 offset:12800
    v_mfma_f32_16x16x32_bf16 v[236:239], v[112:115], v[100:103], v[236:239]
    v_mfma_f32_16x16x32_bf16 v[216:219], v[124:127], v[116:119], v[216:219]
    v_mfma_f32_16x16x32_bf16 v[228:231], v[124:127], v[120:123], v[228:231]
    v_mfma_f32_16x16x32_bf16 v[220:223], v[128:131], v[116:119], v[220:223]
    s_mul_i32 s66, s61, 384
    s_mul_i32 s67, s62, 192
    s_add_u32 s66, s66, s67
    s_add_u32 s66, s66, 146176
    v_lshl_add_u32 v14, v2, 4, s66
    s_mov_b32 exec_lo, 0x00010001
    s_mov_b32 exec_hi, 0x00010001
    ds_write_b128 v14, v[240:243] offset:0
    ds_write_b128 v14, v[244:247] offset:64
    ds_write_b128 v14, v[248:251] offset:128
    s_mov_b64 exec, -1
    v_mfma_f32_16x16x32_bf16 v[232:235], v[128:131], v[120:123], v[232:235]
    v_mfma_f32_16x16x32_bf16 v[224:227], v[132:135], v[116:119], v[224:227]
    v_mfma_f32_16x16x32_bf16 v[236:239], v[132:135], v[120:123], v[236:239]
    s_mov_b32 s48, s28
    s_mov_b32 s49, s29
    s_mov_b32 s50, 2621440
    s_mov_b32 s51, 0x20000
    s_waitcnt lgkmcnt(0)
    s_barrier
    buffer_store_dwordx4 v[152:155], v4, s[44:47], s10 offen sc1
    v_mfma_f32_16x16x32_bf16 v[168:171], v[152:155], v[40:43], 0
    buffer_store_dwordx4 v[156:159], v4, s[44:47], s11 offen sc1
    v_mfma_f32_16x16x32_bf16 v[168:171], v[156:159], v[40:43], v[168:171]
    buffer_store_dwordx4 v[160:163], v4, s[44:47], s12 offen sc1
    v_mfma_f32_16x16x32_bf16 v[168:171], v[160:163], v[40:43], v[168:171]
    buffer_store_dwordx4 v[164:167], v4, s[44:47], s13 offen sc1
    v_mfma_f32_16x16x32_bf16 v[168:171], v[164:167], v[40:43], v[168:171]
    s_lshl_b32 s66, s61, 7
    s_add_u32 s66, s66, 145664
    v_lshl_add_u32 v12, v3, 2, s66
    s_mul_i32 s66, s62, 192
    s_add_u32 s66, s66, 146176
    v_lshl_add_u32 v13, v2, 4, s66
    ds_read_b32 v56, v12 offset:0
    ds_read_b32 v60, v12 offset:256
    ds_read_b32 v58, v12 offset:64
    ds_read_b32 v62, v12 offset:320
    ds_read_b128 v[64:67], v13 offset:0
    ds_read_b128 v[76:79], v13 offset:384
    ds_read_b128 v[68:71], v13 offset:64
    ds_read_b128 v[80:83], v13 offset:448
    ds_read_b128 v[72:75], v13 offset:128
    ds_read_b128 v[84:87], v13 offset:512
    v_lshrrev_b32 v12, 2, v3
    v_and_b32 v13, 3, v3
    v_lshlrev_b32 v14, 4, v3
    v_add_u32 v15, 16, v12
    v_mov_b32 v16, 20
    v_cmp_eq_u32 vcc, 1, v13
    s_nop 1
    v_cndmask_b32 v15, v15, v16, vcc
    v_lshlrev_b32 v15, 4, v15
    v_mul_u32_u24 v12, 336, v2
    v_mov_b32 v16, 0x7ff00000
    s_lshl_b32 s71, s64, 2
    s_lshl_b32 s66, s62, 1
    s_add_u32 s71, s71, s66
    s_mul_i32 s71, s71, 1792
    s_add_u32 s71, s71, 2686976
    v_add_u32 v176, v12, v14
    s_mov_b32 vcc_lo, 0xffffffff
    s_mov_b32 vcc_hi, 0xffffffff
    v_cndmask_b32 v176, v16, v176, vcc
    s_mov_b32 vcc_lo, 0xffff
    s_mov_b32 vcc_hi, 0x0
    v_cndmask_b32 v177, v16, v14, vcc
    s_mov_b32 vcc_lo, 0xffff0000
    s_mov_b32 vcc_hi, 0x0
    v_cndmask_b32 v178, v16, v14, vcc
    v_add_u32 v180, v12, v15
    s_mov_b32 vcc_lo, 0x33333333
    s_mov_b32 vcc_hi, 0x33333333
    v_cndmask_b32 v180, v16, v180, vcc
    s_mov_b32 vcc_lo, 0x3333
    s_mov_b32 vcc_hi, 0x0
    v_cndmask_b32 v181, v16, v15, vcc
    s_mov_b32 vcc_lo, 0x33330000
    s_mov_b32 vcc_hi, 0x0
    v_cndmask_b32 v182, v16, v15, vcc
    s_waitcnt lgkmcnt(0)
    v_pk_add_f32 v[64:65], v[64:65], v[76:77]
    v_pk_add_f32 v[66:67], v[66:67], v[78:79]
    v_pk_add_f32 v[68:69], v[68:69], v[80:81]
    v_pk_add_f32 v[70:71], v[70:71], v[82:83]
    v_pk_add_f32 v[72:73], v[72:73], v[84:85]
    v_pk_add_f32 v[74:75], v[74:75], v[86:87]
    v_lshlrev_b32 v16, 4, v2
    v_lshl_add_u32 v16, v3, 6, v16
    s_mov_b32 exec_lo, 0x00030003
    s_mov_b32 exec_hi, 0x00030003
    buffer_store_dwordx4 v[168:171], v16, s[44:47], s14 offen sc1
    s_mov_b64 exec, -1
    v_pk_mul_f32 v[96:97], v[64:65], v[60:61] op_sel_hi:[1,0]
    v_pk_mul_f32 v[102:103], v[66:67], v[60:61] op_sel_hi:[1,0]
    v_pk_mul_f32 v[108:109], v[68:69], v[60:61] op_sel_hi:[1,0]
    v_pk_mul_f32 v[114:115], v[70:71], v[60:61] op_sel_hi:[1,0]
    v_pk_fma_f32 v[216:217], v[216:217], v[56:57], v[96:97] op_sel_hi:[1,0,1]
    v_pk_fma_f32 v[218:219], v[218:219], v[56:57], v[102:103] op_sel_hi:[1,0,1]
    v_pk_fma_f32 v[220:221], v[220:221], v[56:57], v[108:109] op_sel_hi:[1,0,1]
    v_pk_fma_f32 v[222:223], v[222:223], v[56:57], v[114:115] op_sel_hi:[1,0,1]
    v_pk_mul_f32 v[98:99], v[216:217], v[18:19]
    v_pk_mul_f32 v[104:105], v[218:219], v[18:19]
    v_pk_mul_f32 v[110:111], v[220:221], v[18:19]
    v_pk_mul_f32 v[116:117], v[222:223], v[18:19]
    v_pk_add_f32 v[100:101], v[216:217], v[20:21]
    v_pk_add_f32 v[106:107], v[218:219], v[20:21]
    v_pk_add_f32 v[112:113], v[220:221], v[20:21]
    v_pk_add_f32 v[118:119], v[222:223], v[20:21]
    v_exp_f32 v98, v98
    v_exp_f32 v104, v104
    v_exp_f32 v110, v110
    v_exp_f32 v116, v116
    v_exp_f32 v99, v99
    v_exp_f32 v105, v105
    v_exp_f32 v111, v111
    v_exp_f32 v117, v117
    v_med3_f32 v98, v98, v100, 1.0
    v_med3_f32 v104, v104, v106, 1.0
    v_med3_f32 v110, v110, v112, 1.0
    v_med3_f32 v116, v116, v118, 1.0
    v_med3_f32 v99, v99, v101, 1.0
    v_med3_f32 v105, v105, v107, 1.0
    v_med3_f32 v111, v111, v113, 1.0
    v_med3_f32 v117, v117, v119, 1.0
    v_pk_add_f32 v[98:99], v[98:99], v[22:23]
    v_pk_add_f32 v[104:105], v[104:105], v[22:23]
    v_pk_add_f32 v[110:111], v[110:111], v[22:23]
    v_pk_add_f32 v[116:117], v[116:117], v[22:23]
    v_cvt_pk_bf16_f32 v192, v98, v99
    v_cvt_pk_bf16_f32 v193, v104, v105
    v_cvt_pk_bf16_f32 v194, v110, v111
    v_cvt_pk_bf16_f32 v195, v116, v117
    v_pk_mul_f32 v[96:97], v[72:73], v[60:61] op_sel_hi:[1,0]
    v_pk_mul_f32 v[102:103], v[74:75], v[60:61] op_sel_hi:[1,0]
    v_pk_mul_f32 v[108:109], v[64:65], v[62:63] op_sel_hi:[1,0]
    v_pk_mul_f32 v[114:115], v[66:67], v[62:63] op_sel_hi:[1,0]
    v_pk_fma_f32 v[224:225], v[224:225], v[56:57], v[96:97] op_sel_hi:[1,0,1]
    v_pk_fma_f32 v[226:227], v[226:227], v[56:57], v[102:103] op_sel_hi:[1,0,1]
    v_pk_fma_f32 v[228:229], v[228:229], v[58:59], v[108:109] op_sel_hi:[1,0,1]
    v_pk_fma_f32 v[230:231], v[230:231], v[58:59], v[114:115] op_sel_hi:[1,0,1]
    v_pk_mul_f32 v[98:99], v[224:225], v[18:19]
    v_pk_mul_f32 v[104:105], v[226:227], v[18:19]
    v_pk_mul_f32 v[110:111], v[228:229], v[18:19]
    v_pk_mul_f32 v[116:117], v[230:231], v[18:19]
    v_pk_add_f32 v[100:101], v[224:225], v[20:21]
    v_pk_add_f32 v[106:107], v[226:227], v[20:21]
    v_pk_add_f32 v[112:113], v[228:229], v[20:21]
    v_pk_add_f32 v[118:119], v[230:231], v[20:21]
    v_exp_f32 v98, v98
    v_exp_f32 v104, v104
    v_exp_f32 v110, v110
    v_exp_f32 v116, v116
    v_exp_f32 v99, v99
    v_exp_f32 v105, v105
    v_exp_f32 v111, v111
    v_exp_f32 v117, v117
    v_med3_f32 v98, v98, v100, 1.0
    v_med3_f32 v104, v104, v106, 1.0
    v_med3_f32 v110, v110, v112, 1.0
    v_med3_f32 v116, v116, v118, 1.0
    v_med3_f32 v99, v99, v101, 1.0
    v_med3_f32 v105, v105, v107, 1.0
    v_med3_f32 v111, v111, v113, 1.0
    v_med3_f32 v117, v117, v119, 1.0
    v_pk_add_f32 v[98:99], v[98:99], v[22:23]
    v_pk_add_f32 v[104:105], v[104:105], v[22:23]
    v_pk_add_f32 v[110:111], v[110:111], v[22:23]
    v_pk_add_f32 v[116:117], v[116:117], v[22:23]
    v_cvt_pk_bf16_f32 v196, v98, v99
    v_cvt_pk_bf16_f32 v197, v104, v105
    v_cvt_pk_bf16_f32 v200, v110, v111
    v_cvt_pk_bf16_f32 v201, v116, v117
    s_mov_b64 exec, 1
    buffer_load_dword v8, v6, s[44:47], s23 offen offset:0 sc1
    s_mov_b64 exec, -1
    v_pk_mul_f32 v[96:97], v[68:69], v[62:63] op_sel_hi:[1,0]
    v_pk_mul_f32 v[102:103], v[70:71], v[62:63] op_sel_hi:[1,0]
    v_pk_mul_f32 v[108:109], v[72:73], v[62:63] op_sel_hi:[1,0]
    v_pk_mul_f32 v[114:115], v[74:75], v[62:63] op_sel_hi:[1,0]
    v_pk_fma_f32 v[232:233], v[232:233], v[58:59], v[96:97] op_sel_hi:[1,0,1]
    v_pk_fma_f32 v[234:235], v[234:235], v[58:59], v[102:103] op_sel_hi:[1,0,1]
    v_pk_fma_f32 v[236:237], v[236:237], v[58:59], v[108:109] op_sel_hi:[1,0,1]
    v_pk_fma_f32 v[238:239], v[238:239], v[58:59], v[114:115] op_sel_hi:[1,0,1]
    v_pk_mul_f32 v[98:99], v[232:233], v[18:19]
    v_pk_mul_f32 v[104:105], v[234:235], v[18:19]
    v_pk_mul_f32 v[110:111], v[236:237], v[18:19]
    v_pk_mul_f32 v[116:117], v[238:239], v[18:19]
    v_pk_add_f32 v[100:101], v[232:233], v[20:21]
    v_pk_add_f32 v[106:107], v[234:235], v[20:21]
    v_pk_add_f32 v[112:113], v[236:237], v[20:21]
    v_pk_add_f32 v[118:119], v[238:239], v[20:21]
    v_exp_f32 v98, v98
    v_exp_f32 v104, v104
    v_exp_f32 v110, v110
    v_exp_f32 v116, v116
    v_exp_f32 v99, v99
    v_exp_f32 v105, v105
    v_exp_f32 v111, v111
    v_exp_f32 v117, v117
    v_med3_f32 v98, v98, v100, 1.0
    v_med3_f32 v104, v104, v106, 1.0
    v_med3_f32 v110, v110, v112, 1.0
    v_med3_f32 v116, v116, v118, 1.0
    v_med3_f32 v99, v99, v101, 1.0
    v_med3_f32 v105, v105, v107, 1.0
    v_med3_f32 v111, v111, v113, 1.0
    v_med3_f32 v117, v117, v119, 1.0
    v_pk_add_f32 v[98:99], v[98:99], v[22:23]
    v_pk_add_f32 v[104:105], v[104:105], v[22:23]
    v_pk_add_f32 v[110:111], v[110:111], v[22:23]
    v_pk_add_f32 v[116:117], v[116:117], v[22:23]
    v_cvt_pk_bf16_f32 v202, v98, v99
    v_cvt_pk_bf16_f32 v203, v104, v105
    v_cvt_pk_bf16_f32 v204, v110, v111
    v_cvt_pk_bf16_f32 v205, v116, v117
    s_waitcnt vmcnt(1)
    s_cmp_lg_u32 s60, 0
    s_cbranch_scc1 Lok_1010
    s_waitcnt vmcnt(0)
    s_mov_b32 s75, 0
    s_mov_b64 exec, 1
Lp_1009:
    v_cmp_gt_u32 vcc, 32, v8
    s_add_u32 s75, s75, 1
    s_cmp_eq_u64 vcc, 0
    s_cbranch_scc1 Lok_1010
    s_cmp_ge_u32 s75, 200000
    s_cbranch_scc1 Lok_1010
    s_sleep 1
    buffer_load_dword v8, v6, s[44:47], s23 offen offset:0 sc1
    s_waitcnt vmcnt(0)
    s_branch Lp_1009
Lok_1010:
    s_mov_b64 exec, -1
    s_barrier
    buffer_load_dwordx4 v[136:139], v176, s[44:47], s71 offen sc1
    buffer_load_dwordx4 v[140:143], v177, s[44:47], s71 offen offset:1344 sc1
    buffer_load_dwordx4 v[152:155], v178, s[44:47], s71 offen offset:1792 sc1
    buffer_load_dwordx4 v[156:159], v176, s[44:47], s71 offen offset:2128 sc1
    buffer_load_dwordx4 v[144:147], v180, s[44:47], s71 offen sc1
    buffer_load_dwordx4 v[148:151], v181, s[44:47], s71 offen offset:1344 sc1
    buffer_load_dwordx4 v[160:163], v182, s[44:47], s71 offen offset:1792 sc1
    buffer_load_dwordx4 v[164:167], v180, s[44:47], s71 offen offset:2128 sc1
    s_and_b32 s66, s2, 7
    s_lshl_b32 s66, s66, 7
    s_add_u32 s66, s66, s3
    s_mov_b64 exec, 1
    buffer_atomic_add v10, v11, s[44:47], s66 offen offset:1024 sc1
    s_mov_b64 exec, -1
    s_and_b32 s66, s2, 7
    s_lshr_b32 s67, s2, 3
    s_lshr_b32 s4, s66, 1
    s_lshl_b32 s4, s4, 2
    s_lshr_b32 s68, s67, 3
    s_add_u32 s4, s4, s68
    s_and_b32 s66, s66, 1
    s_lshl_b32 s66, s66, 3
    s_and_b32 s67, s67, 7
    s_add_u32 s56, s66, s67
    s_lshl_b32 s5, s4, 9
    s_add_u32 s5, s5, s74
    s_lshl_b32 s70, s60, 12
    s_mul_i32 s69, s56, 143360
    s_add_u32 s69, s69, s70
    s_add_u32 s69, s69, 6881280
    s_and_b32 s66, s56, 7
    s_cmp_ge_u32 s66, 6
    s_cselect_b32 s6, 0x7ff00000, s69
    s_and_b32 s7, s56, 0
    s_mul_i32 s7, s7, 20480
    s_mul_i32 s66, s61, 5120
    s_mul_i32 s67, s62, 80
    s_add_u32 s66, s66, s67
    s_add_u32 s66, s66, 147456
    v_mul_u32_u24 v14, 160, v3
    v_mad_u32_u24 v15, v2, 10, v14
    v_add_u32 v15, s66, v15
    s_mul_i32 s66, s60, 2560
    s_add_u32 s66, s66, 147456
    v_lshl_add_u32 v14, v2, 4, v14
    v_add_u32 v14, s66, v14
    s_mul_i32 s66, s64, 10
    s_add_u32 s67, s66, 0
    v_add_u32 v17, s67, v2
    v_lshrrev_b32 v184, 2, v17
    v_lshlrev_b32 v184, 12, v184
    v_and_b32 v17, 3, v17
    v_lshl_add_u32 v184, v17, 8, v184
    v_lshl_add_u32 v184, v3, 4, v184
    s_add_u32 s67, s66, 4
    v_add_u32 v17, s67, v2
    v_lshrrev_b32 v185, 2, v17
    v_lshlrev_b32 v185, 12, v185
    v_and_b32 v17, 3, v17
    v_lshl_add_u32 v185, v17, 8, v185
    v_lshl_add_u32 v185, v3, 4, v185
    s_add_u32 s67, s66, 8
    v_add_u32 v17, s67, v2
    v_lshrrev_b32 v186, 2, v17
    v_lshlrev_b32 v186, 12, v186
    v_and_b32 v17, 3, v17
    v_lshl_add_u32 v186, v17, 8, v186
    v_lshl_add_u32 v186, v3, 4, v186
    s_mul_i32 s65, s63, 81920
    s_lshl_b32 s66, s60, 10
    s_add_u32 s65, s65, s66
    s_add_u32 s65, s65, 4096
    s_waitcnt vmcnt(1)
    v_cvt_pk_bf16_f32 v56, v136, v137
    v_cvt_pk_bf16_f32 v57, v138, v139
    v_cvt_pk_bf16_f32 v58, v140, v141
    v_cvt_pk_bf16_f32 v59, v142, v143
    v_cvt_pk_bf16_f32 v60, v144, v145
    v_cvt_pk_bf16_f32 v61, v146, v147
    v_cvt_pk_bf16_f32 v62, v148, v149
    v_cvt_pk_bf16_f32 v63, v150, v151
    v_cvt_pk_bf16_f32 v64, v152, v153
    v_cvt_pk_bf16_f32 v65, v154, v155
    v_cvt_pk_bf16_f32 v66, v156, v157
    v_cvt_pk_bf16_f32 v67, v158, v159
    v_cvt_pk_bf16_f32 v68, v160, v161
    v_cvt_pk_bf16_f32 v69, v162, v163
    v_cvt_pk_bf16_f32 v70, v164, v165
    v_cvt_pk_bf16_f32 v71, v166, v167
    v_mfma_f32_16x16x32_bf16 v[136:139], v[56:59], v[192:195], 0
    v_mfma_f32_16x16x32_bf16 v[140:143], v[60:63], v[192:195], 0
    v_mfma_f32_16x16x32_bf16 v[144:147], v[64:67], v[194:197], 0
    v_mfma_f32_16x16x32_bf16 v[148:151], v[68:71], v[194:197], 0
    v_mfma_f32_16x16x32_bf16 v[152:155], v[56:59], v[200:203], 0
    v_mfma_f32_16x16x32_bf16 v[156:159], v[60:63], v[200:203], 0
    v_mfma_f32_16x16x32_bf16 v[160:163], v[64:67], v[202:205], 0
    v_mfma_f32_16x16x32_bf16 v[164:167], v[68:71], v[202:205], 0
    s_nop 1
    v_add_f32 v142, 0x358637bd, v141
    s_nop 0
    v_add_f32 v150, 0x358637bd, v149
    s_nop 0
    v_add_f32 v158, 0x358637bd, v157
    s_nop 0
    v_add_f32 v166, 0x358637bd, v165
    v_rcp_f32 v142, v142
    v_rcp_f32 v150, v150
    v_rcp_f32 v158, v158
    v_rcp_f32 v166, v166
    v_mul_f32 v136, v136, v142
    v_mul_f32 v144, v144, v150
    v_mul_f32 v152, v152, v158
    v_mul_f32 v160, v160, v166
    v_mul_f32 v137, v137, v142
    v_mul_f32 v145, v145, v150
    v_mul_f32 v153, v153, v158
    v_mul_f32 v161, v161, v166
    v_mul_f32 v138, v138, v142
    v_mul_f32 v146, v146, v150
    v_mul_f32 v154, v154, v158
    v_mul_f32 v162, v162, v166
    v_mul_f32 v139, v139, v142
    v_mul_f32 v147, v147, v150
    v_mul_f32 v155, v155, v158
    v_mul_f32 v163, v163, v166
    v_mul_f32 v140, v140, v142
    v_mul_f32 v148, v148, v150
    v_mul_f32 v156, v156, v158
    v_mul_f32 v164, v164, v166
    v_cvt_pk_bf16_f32 v136, v136, v137
    v_cvt_pk_bf16_f32 v144, v144, v145
    v_cvt_pk_bf16_f32 v152, v152, v153
    v_cvt_pk_bf16_f32 v160, v160, v161
    v_cvt_pk_bf16_f32 v138, v138, v139
    v_cvt_pk_bf16_f32 v146, v146, v147
    v_cvt_pk_bf16_f32 v154, v154, v155
    v_cvt_pk_bf16_f32 v162, v162, v163
    v_cvt_pk_bf16_f32 v140, v140, v140
    v_cvt_pk_bf16_f32 v148, v148, v148
    v_cvt_pk_bf16_f32 v156, v156, v156
    v_cvt_pk_bf16_f32 v164, v164, v164
    ds_write_b16 v15, v136 offset:0
    ds_write_b16 v15, v144 offset:40
    ds_write_b16 v15, v152 offset:2560
    ds_write_b16 v15, v160 offset:2600
    ds_write_b16_d16_hi v15, v136 offset:2
    ds_write_b16_d16_hi v15, v144 offset:42
    ds_write_b16_d16_hi v15, v152 offset:2562
    ds_write_b16_d16_hi v15, v160 offset:2602
    ds_write_b16 v15, v138 offset:4
    ds_write_b16 v15, v146 offset:44
    ds_write_b16 v15, v154 offset:2564
    ds_write_b16 v15, v162 offset:2604
    ds_write_b16_d16_hi v15, v138 offset:6
    ds_write_b16_d16_hi v15, v146 offset:46
    ds_write_b16_d16_hi v15, v154 offset:2566
    ds_write_b16_d16_hi v15, v162 offset:2606
    ds_write_b16 v15, v140 offset:8
    ds_write_b16 v15, v148 offset:48
    ds_write_b16 v15, v156 offset:2568
    ds_write_b16 v15, v164 offset:2608
    s_waitcnt lgkmcnt(0)
    s_barrier
    ds_read_b128 v[96:99], v14 offset:0
    ds_read_b128 v[100:103], v14 offset:64
    ds_read_b128 v[104:107], v14 offset:128
    s_waitcnt lgkmcnt(0)
    buffer_store_dwordx4 v[96:99], v184, s[44:47], s65 offen sc1
    buffer_store_dwordx4 v[100:103], v185, s[44:47], s65 offen sc1
    s_mov_b32 exec_hi, 0
    buffer_store_dwordx4 v[104:107], v186, s[44:47], s65 offen sc1
    s_mov_b64 exec, -1
    v_lshlrev_b32 v23, 3, v1
    v_mul_u32_u24 v22, 1280, v3
    v_lshl_add_u32 v22, v2, 4, v22
    buffer_load_dwordx4 v[12:15], v22, s[36:39], s58 offen
    buffer_load_dwordx4 v[16:19], v22, s[36:39], s58 offen offset:64
    buffer_load_dwordx2 v[20:21], v22, s[36:39], s59 offen
    buffer_load_dwordx4 a[40:43], v4, s[44:47], s22 offen offset:2048 sc1
    buffer_load_dwordx4 a[44:47], v4, s[44:47], s22 offen offset:3072 sc1
    s_add_u32 s22, s22, 4096
    buffer_load_dwordx4 a[48:51], v4, s[44:47], s22 offen offset:0 sc1
    buffer_load_dwordx4 a[52:55], v4, s[44:47], s22 offen offset:1024 sc1
    buffer_load_dwordx4 a[56:59], v4, s[44:47], s22 offen offset:2048 sc1
    s_lshl_b32 s66, s63, 7
    s_add_u32 s66, s66, 8192
    s_add_u32 s66, s66, s74
    s_mov_b64 exec, 255
    buffer_load_dword v8, v6, s[44:47], s3 offen offset:1024 sc1
    s_mov_b64 exec, -1
    s_waitcnt vmcnt(9)
    s_barrier
    s_mov_b64 exec, 1
    buffer_atomic_add v10, v11, s[44:47], s66 offen offset:0 sc1
    s_mov_b64 exec, -1
    buffer_load_dwordx4 a[60:63], v4, s[44:47], s22 offen offset:3072 sc1
    s_add_u32 s22, s22, 4096
    buffer_load_dwordx4 a[64:67], v4, s[44:47], s22 offen offset:0 sc1
    buffer_load_dwordx4 a[68:71], v4, s[44:47], s22 offen offset:1024 sc1
    buffer_load_dwordx4 a[72:75], v4, s[44:47], s22 offen offset:2048 sc1
    buffer_load_dwordx4 a[76:79], v4, s[44:47], s22 offen offset:3072 sc1
    s_add_u32 s22, s22, 4096
    buffer_load_dwordx4 a[80:83], v4, s[44:47], s22 offen offset:0 sc1
    buffer_load_dwordx4 a[84:87], v4, s[44:47], s22 offen offset:1024 sc1
    buffer_load_dwordx4 a[88:91], v4, s[44:47], s22 offen offset:2048 sc1
    buffer_load_dwordx4 a[92:95], v4, s[44:47], s22 offen offset:3072 sc1
    s_add_u32 s22, s22, 4096
    buffer_load_dwordx4 a[96:99], v4, s[44:47], s22 offen offset:0 sc1
    s_cmp_lg_u32 s60, 0
    s_cbranch_scc1 Lok_1012
    s_waitcnt vmcnt(11)
    s_mov_b32 s75, 0
    s_mov_b64 exec, 255
Lp_1011:
    v_cmp_gt_u32 vcc, 32, v8
    s_add_u32 s75, s75, 1
    s_cmp_eq_u64 vcc, 0
    s_cbranch_scc1 Lok_1012
    s_cmp_ge_u32 s75, 200000
    s_cbranch_scc1 Lok_1012
    s_sleep 1
    buffer_load_dword v8, v6, s[44:47], s3 offen offset:1024 sc1
    s_waitcnt vmcnt(0)
    s_branch Lp_1011
Lok_1012:
    s_mov_b64 exec, -1
    s_barrier
    s_add_u32 m0, s70, 0
    s_add_u32 s29, s69, 0
    s_add_u32 s29, s29, s7
    buffer_load_dwordx4 v4, s[44:47], s29 offen offset:0 sc1 lds
    buffer_load_dwordx4 v4, s[44:47], s29 offen offset:1024 sc1 lds
    buffer_load_dwordx4 v4, s[44:47], s29 offen offset:2048 sc1 lds
    buffer_load_dwordx4 v4, s[44:47], s29 offen offset:3072 sc1 lds
    s_lshl_b32 s75, s60, 10
    s_add_u32 m0, s75, 16384
    s_sub_u32 s29, s69, s70
    s_add_u32 s29, s29, s75
    s_add_u32 s29, s29, 16384
    s_add_u32 s29, s29, s7
    buffer_load_dwordx4 v4, s[44:47], s29 offen sc1 lds
    s_add_u32 m0, s70, 20480
    s_add_u32 s29, s69, 20480
    s_sub_u32 s29, s29, s7
    buffer_load_dwordx4 v4, s[44:47], s29 offen offset:0 sc1 lds
    buffer_load_dwordx4 v4, s[44:47], s29 offen offset:1024 sc1 lds
    buffer_load_dwordx4 v4, s[44:47], s29 offen offset:2048 sc1 lds
    buffer_load_dwordx4 v4, s[44:47], s29 offen offset:3072 sc1 lds
    s_lshl_b32 s75, s60, 10
    s_add_u32 m0, s75, 36864
    s_sub_u32 s29, s69, s70
    s_add_u32 s29, s29, s75
    s_add_u32 s29, s29, 36864
    s_sub_u32 s29, s29, s7
    buffer_load_dwordx4 v4, s[44:47], s29 offen sc1 lds
    s_lshl_b32 s66, s52, 7
    s_add_u32 s66, s66, 8192
    s_add_u32 s66, s66, s74
    s_mov_b64 exec, 1
    buffer_load_dword v8, v6, s[44:47], s66 offen offset:0 sc1
    s_mov_b64 exec, -1
    s_lshl_b32 s64, s57, 9
    s_add_u32 s64, s64, s74
    s_add_u32 s67, s60, 1
    s_and_b32 s67, s67, 3
    s_lshl_b32 s68, s67, 10
    v_add_u32 v172, s68, v4
    s_mul_i32 s67, s67, 15360
    s_add_u32 s67, s67, 102400
    v_add_u32 v164, s67, v4
    s_add_u32 s67, s60, 2
    s_and_b32 s67, s67, 3
    s_lshl_b32 s68, s67, 10
    v_add_u32 v173, s68, v4
    s_mul_i32 s67, s67, 15360
    s_add_u32 s67, s67, 107520
    v_add_u32 v165, s67, v4
    s_add_u32 s67, s60, 3
    s_and_b32 s67, s67, 3
    s_lshl_b32 s68, s67, 10
    v_add_u32 v174, s68, v4
    s_mul_i32 s67, s67, 15360
    s_add_u32 s67, s67, 112640
    v_add_u32 v166, s67, v4
    s_add_u32 s67, s60, 4
    s_and_b32 s67, s67, 3
    s_lshl_b32 s68, s67, 10
    v_add_u32 v175, s68, v4
    s_mul_i32 s72, s52, 81920
    s_mul_i32 s67, s60, 20480
    s_add_u32 s72, s72, s67
    s_add_u32 s72, s72, 4096
    s_cmp_lg_u32 s60, 0
    s_cbranch_scc1 Lok_1014
    s_waitcnt vmcnt(0)
    s_mov_b32 s75, 0
    s_mov_b64 exec, 1
Lp_1013:
    v_cmp_gt_u32 vcc, 8, v8
    s_add_u32 s75, s75, 1
    s_cmp_eq_u64 vcc, 0
    s_cbranch_scc1 Lok_1014
    s_cmp_ge_u32 s75, 200000
    s_cbranch_scc1 Lok_1014
    s_sleep 1
    buffer_load_dword v8, v6, s[44:47], s66 offen offset:0 sc1
    s_waitcnt vmcnt(0)
    s_branch Lp_1013
Lok_1014:
    s_mov_b64 exec, -1
    s_barrier
    s_add_u32 s67, s72, 0
    buffer_load_dwordx4 v[176:179], v172, s[44:47], s67 offen sc1
    s_add_u32 s67, s72, 4096
    buffer_load_dwordx4 v[180:183], v172, s[44:47], s67 offen sc1
    s_add_u32 s67, s72, 8192
    buffer_load_dwordx4 v[184:187], v172, s[44:47], s67 offen sc1
    s_add_u32 s67, s72, 12288
    buffer_load_dwordx4 v[188:191], v172, s[44:47], s67 offen sc1
    s_add_u32 s67, s72, 16384
    buffer_load_dwordx4 v[192:195], v172, s[44:47], s67 offen sc1
    s_add_u32 s67, s72, 0
    buffer_load_dwordx4 v[196:199], v173, s[44:47], s67 offen sc1
    s_add_u32 s67, s72, 4096
    buffer_load_dwordx4 v[200:203], v173, s[44:47], s67 offen sc1
    s_add_u32 s67, s72, 8192
    buffer_load_dwordx4 v[204:207], v173, s[44:47], s67 offen sc1
    s_add_u32 s67, s72, 12288
    buffer_load_dwordx4 v[208:211], v173, s[44:47], s67 offen sc1
    s_add_u32 s67, s72, 16384
    buffer_load_dwordx4 v[212:215], v173, s[44:47], s67 offen sc1
    s_add_u32 s67, s72, 0
    buffer_load_dwordx4 v[216:219], v174, s[44:47], s67 offen sc1
    s_add_u32 s67, s72, 4096
    buffer_load_dwordx4 v[220:223], v174, s[44:47], s67 offen sc1
    s_add_u32 s67, s72, 8192
    buffer_load_dwordx4 v[224:227], v174, s[44:47], s67 offen sc1
    s_add_u32 s67, s72, 12288
    buffer_load_dwordx4 v[228:231], v174, s[44:47], s67 offen sc1
    s_add_u32 s67, s72, 16384
    buffer_load_dwordx4 v[232:235], v174, s[44:47], s67 offen sc1
    s_add_u32 s67, s72, 0
    buffer_load_dwordx4 v[236:239], v175, s[44:47], s67 offen sc1
    s_add_u32 s67, s72, 4096
    buffer_load_dwordx4 v[240:243], v175, s[44:47], s67 offen sc1
    s_add_u32 s67, s72, 8192
    buffer_load_dwordx4 v[244:247], v175, s[44:47], s67 offen sc1
    s_add_u32 s67, s72, 12288
    buffer_load_dwordx4 v[248:251], v175, s[44:47], s67 offen sc1
    s_add_u32 s67, s72, 16384
    buffer_load_dwordx4 v[252:255], v175, s[44:47], s67 offen sc1
    s_waitcnt vmcnt(19)
    v_mfma_f32_16x16x32_bf16 v[24:27], a[0:3], v[176:179], 0
    v_mfma_f32_16x16x32_bf16 v[28:31], a[4:7], v[176:179], 0
    s_lshl_b32 s75, s60, 10
    s_add_u32 m0, s75, 40960
    s_sub_u32 s29, s6, s70
    s_add_u32 s29, s29, s75
    s_add_u32 s29, s29, 40960
    s_lshr_b32 s75, s7, 1
    s_add_u32 s29, s29, s75
    buffer_load_dwordx4 v4, s[44:47], s29 offen sc1 lds
    v_mfma_f32_16x16x32_bf16 v[32:35], a[8:11], v[176:179], 0
    v_mfma_f32_16x16x32_bf16 v[36:39], a[12:15], v[176:179], 0
    v_mfma_f32_16x16x32_bf16 v[40:43], a[16:19], v[176:179], 0
    s_waitcnt vmcnt(19)
    v_mfma_f32_16x16x32_bf16 v[24:27], a[20:23], v[180:183], v[24:27]
    s_lshl_b32 s75, s60, 10
    s_add_u32 m0, s75, 45056
    s_sub_u32 s29, s6, s70
    s_add_u32 s29, s29, s75
    s_add_u32 s29, s29, 45056
    s_lshr_b32 s75, s7, 1
    s_add_u32 s29, s29, s75
    buffer_load_dwordx4 v4, s[44:47], s29 offen sc1 lds
    v_mfma_f32_16x16x32_bf16 v[28:31], a[24:27], v[180:183], v[28:31]
    v_mfma_f32_16x16x32_bf16 v[32:35], a[28:31], v[180:183], v[32:35]
    v_mfma_f32_16x16x32_bf16 v[36:39], a[32:35], v[180:183], v[36:39]
    v_mfma_f32_16x16x32_bf16 v[40:43], a[36:39], v[180:183], v[40:43]
    s_lshl_b32 s75, s60, 10
    s_add_u32 m0, s75, 49152
    s_sub_u32 s29, s6, s70
    s_add_u32 s29, s29, s75
    s_add_u32 s29, s29, 49152
    s_lshr_b32 s75, s7, 1
    s_add_u32 s29, s29, s75
    s_cmp_ge_u32 s60, 2
    s_cselect_b32 s75, s7, 0
    s_sub_u32 s29, s29, s75
    buffer_load_dwordx4 v4, s[44:47], s29 offen sc1 lds
    s_waitcnt vmcnt(20)
    v_mfma_f32_16x16x32_bf16 v[24:27], a[40:43], v[184:187], v[24:27]
    v_mfma_f32_16x16x32_bf16 v[28:31], a[44:47], v[184:187], v[28:31]
    v_mfma_f32_16x16x32_bf16 v[32:35], a[48:51], v[184:187], v[32:35]
    v_mfma_f32_16x16x32_bf16 v[36:39], a[52:55], v[184:187], v[36:39]
    s_lshl_b32 s75, s60, 10
    s_add_u32 m0, s75, 53248
    s_sub_u32 s29, s6, s70
    s_add_u32 s29, s29, s75
    s_add_u32 s29, s29, 53248
    s_lshr_b32 s75, s7, 1
    s_sub_u32 s29, s29, s75
    buffer_load_dwordx4 v4, s[44:47], s29 offen sc1 lds
    v_mfma_f32_16x16x32_bf16 v[40:43], a[56:59], v[184:187], v[40:43]
    s_waitcnt vmcnt(20)
    v_mfma_f32_16x16x32_bf16 v[24:27], a[60:63], v[188:191], v[24:27]
    v_mfma_f32_16x16x32_bf16 v[28:31], a[64:67], v[188:191], v[28:31]
    v_mfma_f32_16x16x32_bf16 v[32:35], a[68:71], v[188:191], v[32:35]
    s_lshl_b32 s75, s60, 10
    s_add_u32 m0, s75, 57344
    s_sub_u32 s29, s6, s70
    s_add_u32 s29, s29, s75
    s_add_u32 s29, s29, 57344
    s_lshr_b32 s75, s7, 1
    s_sub_u32 s29, s29, s75
    buffer_load_dwordx4 v4, s[44:47], s29 offen sc1 lds
    v_mfma_f32_16x16x32_bf16 v[36:39], a[72:75], v[188:191], v[36:39]
    v_mfma_f32_16x16x32_bf16 v[40:43], a[76:79], v[188:191], v[40:43]
    s_waitcnt vmcnt(20)
    v_mfma_f32_16x16x32_bf16 v[24:27], a[80:83], v[192:195], v[24:27]
    v_mfma_f32_16x16x32_bf16 v[28:31], a[84:87], v[192:195], v[28:31]
    s_add_u32 m0, s70, 61440
    s_add_u32 s29, s69, 61440
    s_add_u32 s29, s29, s7
    buffer_load_dwordx4 v4, s[44:47], s29 offen offset:0 sc1 lds
    v_mfma_f32_16x16x32_bf16 v[32:35], a[88:91], v[192:195], v[32:35]
    v_mfma_f32_16x16x32_bf16 v[36:39], a[92:95], v[192:195], v[36:39]
    v_mfma_f32_16x16x32_bf16 v[40:43], a[96:99], v[192:195], v[40:43]
    s_waitcnt vmcnt(20)
    v_mfma_f32_16x16x32_bf16 v[44:47], a[0:3], v[196:199], 0
    v_mfma_f32_16x16x32_bf16 v[48:51], a[4:7], v[196:199], 0
    buffer_load_dwordx4 v4, s[44:47], s29 offen offset:1024 sc1 lds
    v_mfma_f32_16x16x32_bf16 v[52:55], a[8:11], v[196:199], 0
    v_mfma_f32_16x16x32_bf16 v[56:59], a[12:15], v[196:199], 0
    v_mfma_f32_16x16x32_bf16 v[60:63], a[16:19], v[196:199], 0
    s_waitcnt vmcnt(20)
    v_mfma_f32_16x16x32_bf16 v[44:47], a[20:23], v[200:203], v[44:47]
    ds_write_b128 v164, v[24:27] offset:0
    buffer_load_dwordx4 v4, s[44:47], s29 offen offset:2048 sc1 lds
    v_mfma_f32_16x16x32_bf16 v[48:51], a[24:27], v[200:203], v[48:51]
    v_mfma_f32_16x16x32_bf16 v[52:55], a[28:31], v[200:203], v[52:55]
    v_mfma_f32_16x16x32_bf16 v[56:59], a[32:35], v[200:203], v[56:59]
    ds_write_b128 v164, v[28:31] offset:1024
    v_mfma_f32_16x16x32_bf16 v[60:63], a[36:39], v[200:203], v[60:63]
    buffer_load_dwordx4 v4, s[44:47], s29 offen offset:3072 sc1 lds
    s_waitcnt vmcnt(21)
    v_mfma_f32_16x16x32_bf16 v[44:47], a[40:43], v[204:207], v[44:47]
    v_mfma_f32_16x16x32_bf16 v[48:51], a[44:47], v[204:207], v[48:51]
    ds_write_b128 v164, v[32:35] offset:2048
    v_mfma_f32_16x16x32_bf16 v[52:55], a[48:51], v[204:207], v[52:55]
    v_mfma_f32_16x16x32_bf16 v[56:59], a[52:55], v[204:207], v[56:59]
    s_lshl_b32 s75, s60, 10
    s_add_u32 m0, s75, 77824
    s_sub_u32 s29, s69, s70
    s_add_u32 s29, s29, s75
    s_add_u32 s29, s29, 77824
    s_add_u32 s29, s29, s7
    buffer_load_dwordx4 v4, s[44:47], s29 offen sc1 lds
    v_mfma_f32_16x16x32_bf16 v[60:63], a[56:59], v[204:207], v[60:63]
    ds_write_b128 v164, v[36:39] offset:3072
    s_waitcnt vmcnt(21)
    v_mfma_f32_16x16x32_bf16 v[44:47], a[60:63], v[208:211], v[44:47]
    v_mfma_f32_16x16x32_bf16 v[48:51], a[64:67], v[208:211], v[48:51]
    v_mfma_f32_16x16x32_bf16 v[52:55], a[68:71], v[208:211], v[52:55]
    ds_write_b128 v164, v[40:43] offset:4096
    s_add_u32 m0, s70, 81920
    s_add_u32 s29, s69, 81920
    s_sub_u32 s29, s29, s7
    buffer_load_dwordx4 v4, s[44:47], s29 offen offset:0 sc1 lds
    v_mfma_f32_16x16x32_bf16 v[56:59], a[72:75], v[208:211], v[56:59]
    v_mfma_f32_16x16x32_bf16 v[60:63], a[76:79], v[208:211], v[60:63]
    s_waitcnt vmcnt(21)
    v_mfma_f32_16x16x32_bf16 v[44:47], a[80:83], v[212:215], v[44:47]
    v_mfma_f32_16x16x32_bf16 v[48:51], a[84:87], v[212:215], v[48:51]
    buffer_load_dwordx4 v4, s[44:47], s29 offen offset:1024 sc1 lds
    v_mfma_f32_16x16x32_bf16 v[52:55], a[88:91], v[212:215], v[52:55]
    v_mfma_f32_16x16x32_bf16 v[56:59], a[92:95], v[212:215], v[56:59]
    v_mfma_f32_16x16x32_bf16 v[60:63], a[96:99], v[212:215], v[60:63]
    s_waitcnt vmcnt(21)
    v_mfma_f32_16x16x32_bf16 v[64:67], a[0:3], v[216:219], 0
    v_mfma_f32_16x16x32_bf16 v[68:71], a[4:7], v[216:219], 0
    buffer_load_dwordx4 v4, s[44:47], s29 offen offset:2048 sc1 lds
    v_mfma_f32_16x16x32_bf16 v[72:75], a[8:11], v[216:219], 0
    v_mfma_f32_16x16x32_bf16 v[76:79], a[12:15], v[216:219], 0
    v_mfma_f32_16x16x32_bf16 v[80:83], a[16:19], v[216:219], 0
    s_waitcnt vmcnt(21)
    v_mfma_f32_16x16x32_bf16 v[64:67], a[20:23], v[220:223], v[64:67]
    ds_write_b128 v165, v[44:47] offset:0
    buffer_load_dwordx4 v4, s[44:47], s29 offen offset:3072 sc1 lds
    v_mfma_f32_16x16x32_bf16 v[68:71], a[24:27], v[220:223], v[68:71]
    v_mfma_f32_16x16x32_bf16 v[72:75], a[28:31], v[220:223], v[72:75]
    v_mfma_f32_16x16x32_bf16 v[76:79], a[32:35], v[220:223], v[76:79]
    ds_write_b128 v165, v[48:51] offset:1024
    v_mfma_f32_16x16x32_bf16 v[80:83], a[36:39], v[220:223], v[80:83]
    s_lshl_b32 s75, s60, 10
    s_add_u32 m0, s75, 98304
    s_sub_u32 s29, s69, s70
    s_add_u32 s29, s29, s75
    s_add_u32 s29, s29, 98304
    s_sub_u32 s29, s29, s7
    buffer_load_dwordx4 v4, s[44:47], s29 offen sc1 lds
    s_waitcnt vmcnt(22)
    v_mfma_f32_16x16x32_bf16 v[64:67], a[40:43], v[224:227], v[64:67]
    v_mfma_f32_16x16x32_bf16 v[68:71], a[44:47], v[224:227], v[68:71]
    ds_write_b128 v165, v[52:55] offset:2048
    v_mfma_f32_16x16x32_bf16 v[72:75], a[48:51], v[224:227], v[72:75]
    v_mfma_f32_16x16x32_bf16 v[76:79], a[52:55], v[224:227], v[76:79]
    s_add_u32 s28, s35, 81920
    buffer_load_dwordx4 a[160:163], v4, s[44:47], s28 offen offset:0 sc1
    v_mfma_f32_16x16x32_bf16 v[80:83], a[56:59], v[224:227], v[80:83]
    ds_write_b128 v165, v[56:59] offset:3072
    s_waitcnt vmcnt(22)
    v_mfma_f32_16x16x32_bf16 v[64:67], a[60:63], v[228:231], v[64:67]
    v_mfma_f32_16x16x32_bf16 v[68:71], a[64:67], v[228:231], v[68:71]
    v_mfma_f32_16x16x32_bf16 v[72:75], a[68:71], v[228:231], v[72:75]
    ds_write_b128 v165, v[60:63] offset:4096
    buffer_load_dwordx4 a[164:167], v4, s[44:47], s28 offen offset:1024 sc1
    v_mfma_f32_16x16x32_bf16 v[76:79], a[72:75], v[228:231], v[76:79]
    v_mfma_f32_16x16x32_bf16 v[80:83], a[76:79], v[228:231], v[80:83]
    s_waitcnt vmcnt(22)
    v_mfma_f32_16x16x32_bf16 v[64:67], a[80:83], v[232:235], v[64:67]
    v_mfma_f32_16x16x32_bf16 v[68:71], a[84:87], v[232:235], v[68:71]
    buffer_load_dwordx4 a[168:171], v4, s[44:47], s28 offen offset:2048 sc1
    v_mfma_f32_16x16x32_bf16 v[72:75], a[88:91], v[232:235], v[72:75]
    v_mfma_f32_16x16x32_bf16 v[76:79], a[92:95], v[232:235], v[76:79]
    v_mfma_f32_16x16x32_bf16 v[80:83], a[96:99], v[232:235], v[80:83]
    s_waitcnt vmcnt(22)
    v_mfma_f32_16x16x32_bf16 v[84:87], a[0:3], v[236:239], 0
    v_mfma_f32_16x16x32_bf16 v[88:91], a[4:7], v[236:239], 0
    buffer_load_dwordx4 a[172:175], v4, s[44:47], s28 offen offset:3072 sc1
    v_mfma_f32_16x16x32_bf16 v[92:95], a[8:11], v[236:239], 0
    v_mfma_f32_16x16x32_bf16 v[96:99], a[12:15], v[236:239], 0
    v_mfma_f32_16x16x32_bf16 v[100:103], a[16:19], v[236:239], 0
    s_waitcnt vmcnt(22)
    v_mfma_f32_16x16x32_bf16 v[84:87], a[20:23], v[240:243], v[84:87]
    ds_write_b128 v166, v[64:67] offset:0
    buffer_load_dwordx4 a[176:179], v5, s[44:47], s28 offen offset:0 sc1
    v_mfma_f32_16x16x32_bf16 v[88:91], a[24:27], v[240:243], v[88:91]
    v_mfma_f32_16x16x32_bf16 v[92:95], a[28:31], v[240:243], v[92:95]
    v_mfma_f32_16x16x32_bf16 v[96:99], a[32:35], v[240:243], v[96:99]
    ds_write_b128 v166, v[68:71] offset:1024
    v_mfma_f32_16x16x32_bf16 v[100:103], a[36:39], v[240:243], v[100:103]
    s_add_u32 s28, s35, 102400
    s_cmp_ge_u32 s60, 2
    s_cselect_b32 s28, 0x7ff00000, s28
    buffer_load_dwordx4 a[180:183], v4, s[44:47], s28 offen offset:0 sc1
    s_waitcnt vmcnt(23)
    v_mfma_f32_16x16x32_bf16 v[84:87], a[40:43], v[244:247], v[84:87]
    v_mfma_f32_16x16x32_bf16 v[88:91], a[44:47], v[244:247], v[88:91]
    ds_write_b128 v166, v[72:75] offset:2048
    v_mfma_f32_16x16x32_bf16 v[92:95], a[48:51], v[244:247], v[92:95]
    v_mfma_f32_16x16x32_bf16 v[96:99], a[52:55], v[244:247], v[96:99]
    buffer_load_dwordx4 a[184:187], v4, s[44:47], s28 offen offset:1024 sc1
    v_mfma_f32_16x16x32_bf16 v[100:103], a[56:59], v[244:247], v[100:103]
    ds_write_b128 v166, v[76:79] offset:3072
    s_waitcnt vmcnt(23)
    v_mfma_f32_16x16x32_bf16 v[84:87], a[60:63], v[248:251], v[84:87]
    v_mfma_f32_16x16x32_bf16 v[88:91], a[64:67], v[248:251], v[88:91]
    v_mfma_f32_16x16x32_bf16 v[92:95], a[68:71], v[248:251], v[92:95]
    ds_write_b128 v166, v[80:83] offset:4096
    buffer_load_dwordx4 a[188:191], v4, s[44:47], s28 offen offset:2048 sc1
    v_mfma_f32_16x16x32_bf16 v[96:99], a[72:75], v[248:251], v[96:99]
    v_mfma_f32_16x16x32_bf16 v[100:103], a[76:79], v[248:251], v[100:103]
    s_waitcnt vmcnt(23)
    v_mfma_f32_16x16x32_bf16 v[84:87], a[80:83], v[252:255], v[84:87]
    v_mfma_f32_16x16x32_bf16 v[88:91], a[84:87], v[252:255], v[88:91]
    buffer_load_dwordx4 a[192:195], v4, s[44:47], s28 offen offset:3072 sc1
    v_mfma_f32_16x16x32_bf16 v[92:95], a[88:91], v[252:255], v[92:95]
    v_mfma_f32_16x16x32_bf16 v[96:99], a[92:95], v[252:255], v[96:99]
    v_mfma_f32_16x16x32_bf16 v[100:103], a[96:99], v[252:255], v[100:103]
    buffer_load_dwordx4 a[196:199], v5, s[44:47], s28 offen offset:0 sc1
    s_add_u32 s28, s35, 122880
    buffer_load_dwordx4 a[200:203], v4, s[44:47], s28 offen offset:0 sc1
    buffer_load_dwordx4 a[204:207], v4, s[44:47], s28 offen offset:1024 sc1
    buffer_load_dwordx4 a[208:211], v4, s[44:47], s28 offen offset:2048 sc1
    buffer_load_dwordx4 a[212:215], v4, s[44:47], s28 offen offset:3072 sc1
    buffer_load_dwordx4 a[216:219], v5, s[44:47], s28 offen offset:0 sc1
    s_add_u32 s28, s35, 143360
    buffer_load_dwordx4 a[220:223], v4, s[44:47], s28 offen offset:0 sc1
    buffer_load_dwordx4 a[224:227], v4, s[44:47], s28 offen offset:1024 sc1
    buffer_load_dwordx4 a[228:231], v4, s[44:47], s28 offen offset:2048 sc1
    buffer_load_dwordx4 a[232:235], v4, s[44:47], s28 offen offset:3072 sc1
    buffer_load_dwordx4 a[236:239], v5, s[44:47], s28 offen offset:0 sc1
    s_lshl_b32 s68, s52, 2
    s_add_u32 s68, s68, s60
    s_lshr_b32 s66, s68, 1
    s_mul_i32 s66, s66, 40960
    s_and_b32 s67, s68, 1
    s_lshl_b32 s67, s67, 10
    s_add_u32 s66, s66, s67
    s_add_u32 s66, s66, 4198400
    s_lshl_b32 s72, s54, 11
    s_add_u32 s72, s72, s66
    s_lshr_b32 s73, s55, 1
    s_lshl_b32 s73, s73, 11
    s_and_b32 s67, s55, 1
    s_lshl_b32 s67, s67, 9
    s_add_u32 s73, s73, s67
    s_add_u32 s73, s73, s66
    s_lshl_b32 s66, s68, 10
    s_lshl_b32 s67, s53, 7
    s_add_u32 s66, s66, s67
    s_add_u32 s66, s66, 3604480
    s_waitcnt lgkmcnt(0)
    s_barrier
    s_mul_i32 s65, s60, 15360
    s_add_u32 s65, s65, 102400
    v_add_u32 v7, s65, v4
    ds_read_b128 v[24:27], v7 offset:0
    ds_read_b128 v[28:31], v7 offset:1024
    ds_read_b128 v[32:35], v7 offset:2048
    ds_read_b128 v[36:39], v7 offset:3072
    ds_read_b128 v[40:43], v7 offset:4096
    ds_read_b128 v[44:47], v7 offset:5120
    ds_read_b128 v[48:51], v7 offset:6144
    ds_read_b128 v[52:55], v7 offset:7168
    ds_read_b128 v[56:59], v7 offset:8192
    ds_read_b128 v[60:63], v7 offset:9216
    ds_read_b128 v[64:67], v7 offset:10240
    ds_read_b128 v[68:71], v7 offset:11264
    ds_read_b128 v[72:75], v7 offset:12288
    ds_read_b128 v[76:79], v7 offset:13312
    ds_read_b128 v[80:83], v7 offset:14336
    s_waitcnt lgkmcnt(10)
    v_pk_add_f32 v[84:85], v[84:85], v[24:25]
    v_pk_add_f32 v[86:87], v[86:87], v[26:27]
    v_pk_add_f32 v[88:89], v[88:89], v[28:29]
    v_pk_add_f32 v[90:91], v[90:91], v[30:31]
    v_pk_add_f32 v[92:93], v[92:93], v[32:33]
    v_pk_add_f32 v[94:95], v[94:95], v[34:35]
    v_pk_add_f32 v[96:97], v[96:97], v[36:37]
    v_pk_add_f32 v[98:99], v[98:99], v[38:39]
    v_pk_add_f32 v[100:101], v[100:101], v[40:41]
    v_pk_add_f32 v[102:103], v[102:103], v[42:43]
    s_waitcnt lgkmcnt(5)
    v_pk_add_f32 v[84:85], v[84:85], v[44:45]
    v_pk_add_f32 v[86:87], v[86:87], v[46:47]
    v_pk_add_f32 v[88:89], v[88:89], v[48:49]
    v_pk_add_f32 v[90:91], v[90:91], v[50:51]
    v_pk_add_f32 v[92:93], v[92:93], v[52:53]
    v_pk_add_f32 v[94:95], v[94:95], v[54:55]
    v_pk_add_f32 v[96:97], v[96:97], v[56:57]
    v_pk_add_f32 v[98:99], v[98:99], v[58:59]
    v_pk_add_f32 v[100:101], v[100:101], v[60:61]
    v_pk_add_f32 v[102:103], v[102:103], v[62:63]
    s_waitcnt lgkmcnt(0)
    v_pk_add_f32 v[84:85], v[84:85], v[64:65]
    v_pk_add_f32 v[86:87], v[86:87], v[66:67]
    v_pk_add_f32 v[88:89], v[88:89], v[68:69]
    v_pk_add_f32 v[90:91], v[90:91], v[70:71]
    v_pk_add_f32 v[92:93], v[92:93], v[72:73]
    v_pk_add_f32 v[94:95], v[94:95], v[74:75]
    v_pk_add_f32 v[96:97], v[96:97], v[76:77]
    v_pk_add_f32 v[98:99], v[98:99], v[78:79]
    v_pk_add_f32 v[100:101], v[100:101], v[80:81]
    v_pk_add_f32 v[102:103], v[102:103], v[82:83]
    v_cvt_pk_bf16_f32 v108, v84, v85
    v_cvt_pk_bf16_f32 v114, v86, v87
    v_cvt_pk_bf16_f32 v120, v88, v89
    v_cvt_pk_bf16_f32 v126, v90, v91
    v_lshlrev_b32 v106, 16, v12
    v_lshlrev_b32 v112, 16, v13
    v_lshlrev_b32 v118, 16, v14
    v_lshlrev_b32 v124, 16, v15
    v_and_b32 v107, 0xffff0000, v12
    v_and_b32 v113, 0xffff0000, v13
    v_and_b32 v119, 0xffff0000, v14
    v_and_b32 v125, 0xffff0000, v15
    v_lshlrev_b32 v104, 16, v108
    v_lshlrev_b32 v110, 16, v114
    v_lshlrev_b32 v116, 16, v120
    v_lshlrev_b32 v122, 16, v126
    v_and_b32 v105, 0xffff0000, v108
    v_and_b32 v111, 0xffff0000, v114
    v_and_b32 v117, 0xffff0000, v120
    v_and_b32 v123, 0xffff0000, v126
    v_pk_add_f32 v[104:105], v[104:105], v[106:107]
    v_pk_add_f32 v[110:111], v[110:111], v[112:113]
    v_pk_add_f32 v[116:117], v[116:117], v[118:119]
    v_pk_add_f32 v[122:123], v[122:123], v[124:125]
    v_cvt_pk_bf16_f32 v12, v104, v105
    v_cvt_pk_bf16_f32 v13, v110, v111
    v_cvt_pk_bf16_f32 v14, v116, v117
    v_cvt_pk_bf16_f32 v15, v122, v123
    v_cvt_pk_bf16_f32 v108, v92, v93
    v_cvt_pk_bf16_f32 v114, v94, v95
    v_cvt_pk_bf16_f32 v120, v96, v97
    v_cvt_pk_bf16_f32 v126, v98, v99
    v_lshlrev_b32 v106, 16, v16
    v_lshlrev_b32 v112, 16, v17
    v_lshlrev_b32 v118, 16, v18
    v_lshlrev_b32 v124, 16, v19
    v_and_b32 v107, 0xffff0000, v16
    v_and_b32 v113, 0xffff0000, v17
    v_and_b32 v119, 0xffff0000, v18
    v_and_b32 v125, 0xffff0000, v19
    v_lshlrev_b32 v104, 16, v108
    v_lshlrev_b32 v110, 16, v114
    v_lshlrev_b32 v116, 16, v120
    v_lshlrev_b32 v122, 16, v126
    v_and_b32 v105, 0xffff0000, v108
    v_and_b32 v111, 0xffff0000, v114
    v_and_b32 v117, 0xffff0000, v120
    v_and_b32 v123, 0xffff0000, v126
    v_pk_add_f32 v[104:105], v[104:105], v[106:107]
    v_pk_add_f32 v[110:111], v[110:111], v[112:113]
    v_pk_add_f32 v[116:117], v[116:117], v[118:119]
    v_pk_add_f32 v[122:123], v[122:123], v[124:125]
    v_cvt_pk_bf16_f32 v16, v104, v105
    v_cvt_pk_bf16_f32 v17, v110, v111
    v_cvt_pk_bf16_f32 v18, v116, v117
    v_cvt_pk_bf16_f32 v19, v122, v123
    v_cvt_pk_bf16_f32 v108, v100, v101
    v_cvt_pk_bf16_f32 v114, v102, v103
    v_lshlrev_b32 v106, 16, v20
    v_lshlrev_b32 v112, 16, v21
    v_and_b32 v107, 0xffff0000, v20
    v_and_b32 v113, 0xffff0000, v21
    v_lshlrev_b32 v104, 16, v108
    v_lshlrev_b32 v110, 16, v114
    v_and_b32 v105, 0xffff0000, v108
    v_and_b32 v111, 0xffff0000, v114
    v_pk_add_f32 v[104:105], v[104:105], v[106:107]
    v_pk_add_f32 v[110:111], v[110:111], v[112:113]
    v_cvt_pk_bf16_f32 v20, v104, v105
    v_cvt_pk_bf16_f32 v21, v110, v111
    buffer_store_dwordx4 v[12:15], v4, s[44:47], s72 offen sc1
    buffer_store_dwordx4 v[16:19], v4, s[44:47], s72 offen offset:2048 sc1
    buffer_store_dwordx2 v[20:21], v23, s[44:47], s73 offen sc1
    v_lshlrev_b32 v24, 16, v12
    v_and_b32 v25, 0xffff0000, v12
    v_lshlrev_b32 v26, 16, v13
    v_and_b32 v27, 0xffff0000, v13
    v_lshlrev_b32 v28, 16, v14
    v_and_b32 v29, 0xffff0000, v14
    v_lshlrev_b32 v30, 16, v15
    v_and_b32 v31, 0xffff0000, v15
    v_lshlrev_b32 v32, 16, v16
    v_and_b32 v33, 0xffff0000, v16
    v_lshlrev_b32 v34, 16, v17
    v_and_b32 v35, 0xffff0000, v17
    v_lshlrev_b32 v36, 16, v18
    v_and_b32 v37, 0xffff0000, v18
    v_lshlrev_b32 v38, 16, v19
    v_and_b32 v39, 0xffff0000, v19
    v_lshlrev_b32 v40, 16, v20
    v_and_b32 v41, 0xffff0000, v20
    v_lshlrev_b32 v42, 16, v21
    v_and_b32 v43, 0xffff0000, v21
    v_pk_add_f32 v[106:107], v[24:25], v[26:27]
    v_pk_mul_f32 v[108:109], v[24:25], v[24:25]
    v_pk_mul_f32 v[110:111], v[26:27], v[26:27]
    v_pk_add_f32 v[106:107], v[106:107], v[28:29]
    v_pk_fma_f32 v[108:109], v[28:29], v[28:29], v[108:109]
    v_pk_add_f32 v[106:107], v[106:107], v[30:31]
    v_pk_fma_f32 v[110:111], v[30:31], v[30:31], v[110:111]
    v_pk_add_f32 v[106:107], v[106:107], v[32:33]
    v_pk_fma_f32 v[108:109], v[32:33], v[32:33], v[108:109]
    v_pk_add_f32 v[106:107], v[106:107], v[34:35]
    v_pk_fma_f32 v[110:111], v[34:35], v[34:35], v[110:111]
    v_pk_add_f32 v[106:107], v[106:107], v[36:37]
    v_pk_fma_f32 v[108:109], v[36:37], v[36:37], v[108:109]
    v_pk_add_f32 v[106:107], v[106:107], v[38:39]
    v_pk_fma_f32 v[110:111], v[38:39], v[38:39], v[110:111]
    v_pk_add_f32 v[106:107], v[106:107], v[40:41]
    v_pk_fma_f32 v[108:109], v[40:41], v[40:41], v[108:109]
    v_pk_add_f32 v[106:107], v[106:107], v[42:43]
    v_pk_fma_f32 v[110:111], v[42:43], v[42:43], v[110:111]
    v_pk_add_f32 v[108:109], v[108:109], v[110:111]
    v_add_f32 v104, v106, v107
    v_add_f32 v105, v108, v109
    v_mov_b32 v106, v104
    v_mov_b32 v107, v105
    s_nop 0
    v_permlane32_swap_b32 v104, v106
    v_permlane32_swap_b32 v105, v107
    v_add_f32 v104, v104, v106
    v_add_f32 v105, v105, v107
    v_mov_b32 v106, v104
    v_mov_b32 v107, v105
    s_nop 0
    v_permlane16_swap_b32 v104, v106
    v_permlane16_swap_b32 v105, v107
    v_add_f32 v104, v104, v106
    v_add_f32 v105, v105, v107
    s_mov_b64 exec, 0xffff
    buffer_store_dwordx2 v[104:105], v23, s[44:47], s66 offen sc1
    s_mov_b64 exec, -1
    v_and_b32 v7, 7, v1
    v_cmp_gt_u32 vcc, 5, v7
    v_mul_u32_u24 v7, 14336, v7
    v_lshl_add_u32 v7, v2, 4, v7
    v_mov_b32 v9, 0x7ff00000
    v_cndmask_b32 v7, v9, v7, vcc
    s_mul_i32 s65, s56, 896
    s_add_u32 s65, s65, 3866624
    buffer_load_dwordx4 v[136:139], v7, s[44:47], s65 offen offset:0 sc1
    buffer_load_dwordx4 v[140:143], v7, s[44:47], s65 offen offset:128 sc1
    buffer_load_dwordx4 v[144:147], v7, s[44:47], s65 offen offset:256 sc1
    buffer_load_dwordx4 v[148:151], v7, s[44:47], s65 offen offset:384 sc1
    buffer_load_dwordx4 v[152:155], v7, s[44:47], s65 offen offset:512 sc1
    buffer_load_dwordx4 v[156:159], v7, s[44:47], s65 offen offset:640 sc1
    s_cmp_eq_u32 s6, 0x7ff00000
    s_cselect_b32 s65, s6, s65
    buffer_load_dwordx4 v[160:163], v7, s[44:47], s65 offen offset:768 sc1
    s_waitcnt vmcnt(7)
    s_barrier
    s_mov_b64 exec, 1
    buffer_atomic_add v10, v11, s[44:47], s64 offen offset:0 sc1
    s_mov_b64 exec, -1
    s_add_u32 m0, s70, 102400
    s_add_u32 s29, s69, 102400
    s_add_u32 s29, s29, s7
    buffer_load_dwordx4 v4, s[44:47], s29 offen offset:0 sc1 lds
    buffer_load_dwordx4 v4, s[44:47], s29 offen offset:1024 sc1 lds
    buffer_load_dwordx4 v4, s[44:47], s29 offen offset:2048 sc1 lds
    buffer_load_dwordx4 v4, s[44:47], s29 offen offset:3072 sc1 lds
    s_lshl_b32 s75, s60, 10
    s_add_u32 m0, s75, 118784
    s_sub_u32 s29, s69, s70
    s_add_u32 s29, s29, s75
    s_add_u32 s29, s29, 118784
    s_add_u32 s29, s29, s7
    buffer_load_dwordx4 v4, s[44:47], s29 offen sc1 lds
    s_add_u32 m0, s70, 122880
    s_add_u32 s29, s69, 122880
    s_sub_u32 s29, s29, s7
    buffer_load_dwordx4 v4, s[44:47], s29 offen offset:0 sc1 lds
    buffer_load_dwordx4 v4, s[44:47], s29 offen offset:1024 sc1 lds
    buffer_load_dwordx4 v4, s[44:47], s29 offen offset:2048 sc1 lds
    buffer_load_dwordx4 v4, s[44:47], s29 offen offset:3072 sc1 lds
    s_lshl_b32 s75, s60, 10
    s_add_u32 m0, s75, 139264
    s_sub_u32 s29, s69, s70
    s_add_u32 s29, s29, s75
    s_add_u32 s29, s29, 139264
    s_sub_u32 s29, s29, s7
    buffer_load_dwordx4 v4, s[44:47], s29 offen sc1 lds
    s_add_u32 s28, s35, 0
    buffer_load_dwordx4 v[176:179], v4, s[44:47], s28 offen offset:0 sc1
    buffer_load_dwordx4 v[180:183], v4, s[44:47], s28 offen offset:1024 sc1
    buffer_load_dwordx4 v[184:187], v4, s[44:47], s28 offen offset:2048 sc1
    buffer_load_dwordx4 v[188:191], v4, s[44:47], s28 offen offset:3072 sc1
    buffer_load_dwordx4 v[192:195], v5, s[44:47], s28 offen offset:0 sc1
    s_add_u32 s28, s35, 20480
    buffer_load_dwordx4 v[196:199], v4, s[44:47], s28 offen offset:0 sc1
    buffer_load_dwordx4 v[200:203], v4, s[44:47], s28 offen offset:1024 sc1
    buffer_load_dwordx4 v[204:207], v4, s[44:47], s28 offen offset:2048 sc1
    buffer_load_dwordx4 v[208:211], v4, s[44:47], s28 offen offset:3072 sc1
    buffer_load_dwordx4 v[212:215], v5, s[44:47], s28 offen offset:0 sc1
    s_mov_b64 exec, 1
    buffer_load_dword v8, v6, s[44:47], s5 offen offset:0 sc1
    s_mov_b64 exec, -1
    s_lshl_b32 s65, s4, 2
    s_add_u32 s65, s65, s60
    s_mul_i32 s72, s65, 40960
    s_add_u32 s72, s72, 4198400
    s_add_u32 s72, s72, s7
    s_lshl_b32 s65, s65, 11
    s_add_u32 s65, s65, 3604480
    v_add_u32 v9, 65536, v4
    v_add_u32 v22, 131072, v4
    s_lshl_b32 s67, s4, 1
    s_lshr_b32 s68, s60, 1
    s_add_u32 s67, s67, s68
    s_mul_i32 s61, s67, 229376
    s_and_b32 s68, s60, 1
    s_lshl_b32 s68, s68, 11
    s_add_u32 s61, s61, s68
    s_add_u32 s61, s61, 11599872
    s_lshr_b32 s62, s56, 3
    s_mul_i32 s62, s62, 3
    s_and_b32 s67, s56, 7
    s_lshr_b32 s68, s67, 1
    s_add_u32 s62, s62, s68
    s_lshl_b32 s62, s62, 12
    s_and_b32 s68, s56, 1
    s_lshl_b32 s68, s68, 9
    s_add_u32 s62, s62, s68
    s_add_u32 s62, s62, s61
    s_add_u32 s62, s62, 65536
    s_cmp_ge_u32 s67, 6
    s_cselect_b32 s62, 0x7ff00000, s62
    s_lshl_b32 s67, s56, 12
    s_add_u32 s61, s61, s67
    s_mul_i32 s63, s52, 229376
    s_lshl_b32 s67, s60, 12
    s_add_u32 s63, s63, s67
    s_add_u32 s63, s63, 11599872
    s_waitcnt vmcnt(11)
    s_cmp_lg_u32 s60, 0
    s_cbranch_scc1 Lok_1016
    s_waitcnt vmcnt(0)
    s_mov_b32 s75, 0
    s_mov_b64 exec, 1
Lp_1015:
    v_cmp_gt_u32 vcc, 16, v8
    s_add_u32 s75, s75, 1
    s_cmp_eq_u64 vcc, 0
    s_cbranch_scc1 Lok_1016
    s_cmp_ge_u32 s75, 200000
    s_cbranch_scc1 Lok_1016
    s_sleep 1
    buffer_load_dword v8, v6, s[44:47], s5 offen offset:0 sc1
    s_waitcnt vmcnt(0)
    s_branch Lp_1015
Lok_1016:
    s_mov_b64 exec, -1
    s_barrier
    buffer_load_dwordx2 v[164:165], v23, s[44:47], s65 offen offset:0 sc1
    buffer_load_dwordx2 v[166:167], v23, s[44:47], s65 offen offset:512 sc1
    buffer_load_dwordx2 v[168:169], v23, s[44:47], s65 offen offset:1024 sc1
    buffer_load_dwordx2 v[170:171], v23, s[44:47], s65 offen offset:1536 sc1
    buffer_load_dwordx4 a[0:3], v4, s[44:47], s72 offen offset:0 sc1
    buffer_load_dwordx4 a[4:7], v4, s[44:47], s72 offen offset:1024 sc1
    buffer_load_dwordx4 a[8:11], v4, s[44:47], s72 offen offset:2048 sc1
    buffer_load_dwordx4 a[12:15], v4, s[44:47], s72 offen offset:3072 sc1
    s_add_u32 s72, s72, 4096
    buffer_load_dwordx2 a[16:17], v23, s[44:47], s72 offen offset:0 sc1
    buffer_load_dwordx2 a[18:19], v23, s[44:47], s72 offen offset:512 sc1
    buffer_load_dwordx2 a[20:21], v23, s[44:47], s72 offen offset:1024 sc1
    buffer_load_dwordx2 a[22:23], v23, s[44:47], s72 offen offset:1536 sc1
    buffer_load_dwordx4 a[24:27], v4, s[44:47], s72 offen offset:2048 sc1
    buffer_load_dwordx4 a[28:31], v4, s[44:47], s72 offen offset:3072 sc1
    s_add_u32 s72, s72, 4096
    buffer_load_dwordx4 a[32:35], v4, s[44:47], s72 offen offset:0 sc1
    buffer_load_dwordx4 a[36:39], v4, s[44:47], s72 offen offset:1024 sc1
    buffer_load_dwordx4 a[40:43], v4, s[44:47], s72 offen offset:2048 sc1
    buffer_load_dwordx4 a[44:47], v4, s[44:47], s72 offen offset:3072 sc1
    s_add_u32 s72, s72, 4096
    buffer_load_dwordx4 a[48:51], v4, s[44:47], s72 offen offset:0 sc1
    buffer_load_dwordx4 a[52:55], v4, s[44:47], s72 offen offset:1024 sc1
    ds_read_b128 v[104:107], v4 offset:0
    ds_read_b128 v[108:111], v4 offset:1024
    ds_read_b128 v[112:115], v4 offset:40960
    s_waitcnt vmcnt(14)
    s_waitcnt lgkmcnt(0)
    v_mfma_f32_16x16x32_bf16 v[24:27], v[104:107], a[0:3], 0
    ds_read_b128 v[120:123], v4 offset:2048
    v_add_f32_dpp v136, v136, v136 quad_perm:[1,0,3,2] row_mask:0xf bank_mask:0xf
    v_mfma_f32_16x16x32_bf16 v[52:55], v[104:107], a[4:7], 0
    ds_read_b128 v[124:127], v4 offset:3072
    v_add_f32_dpp v137, v137, v137 quad_perm:[1,0,3,2] row_mask:0xf bank_mask:0xf
    v_mfma_f32_16x16x32_bf16 v[28:31], v[108:111], a[0:3], 0
    ds_read_b128 v[128:131], v4 offset:41984
    v_add_f32_dpp v138, v138, v138 quad_perm:[1,0,3,2] row_mask:0xf bank_mask:0xf
    v_mfma_f32_16x16x32_bf16 v[56:59], v[108:111], a[4:7], 0
    v_add_f32_dpp v139, v139, v139 quad_perm:[1,0,3,2] row_mask:0xf bank_mask:0xf
    v_add_f32_dpp v140, v140, v140 quad_perm:[1,0,3,2] row_mask:0xf bank_mask:0xf
    v_mfma_f32_16x16x32_bf16 v[48:51], v[112:115], a[0:3], 0
    buffer_load_dwordx2 a[56:57], v23, s[44:47], s72 offen offset:2048 sc1
    buffer_load_dwordx2 a[58:59], v23, s[44:47], s72 offen offset:2560 sc1
    v_mfma_f32_16x16x32_bf16 v[76:79], v[112:115], a[4:7], 0
    buffer_load_dwordx2 a[60:61], v23, s[44:47], s72 offen offset:3072 sc1
    buffer_load_dwordx2 a[62:63], v23, s[44:47], s72 offen offset:3584 sc1
    s_waitcnt vmcnt(16)
    s_waitcnt lgkmcnt(0)
    v_mfma_f32_16x16x32_bf16 v[24:27], v[120:123], a[8:11], v[24:27]
    ds_read_b128 v[104:107], v4 offset:4096
    v_add_f32_dpp v141, v141, v141 quad_perm:[1,0,3,2] row_mask:0xf bank_mask:0xf
    v_mfma_f32_16x16x32_bf16 v[52:55], v[120:123], a[12:15], v[52:55]
    ds_read_b128 v[108:111], v4 offset:5120
    v_add_f32_dpp v142, v142, v142 quad_perm:[1,0,3,2] row_mask:0xf bank_mask:0xf
    v_mfma_f32_16x16x32_bf16 v[28:31], v[124:127], a[8:11], v[28:31]
    ds_read_b128 v[112:115], v4 offset:43008
    v_add_f32_dpp v143, v143, v143 quad_perm:[1,0,3,2] row_mask:0xf bank_mask:0xf
    v_mfma_f32_16x16x32_bf16 v[56:59], v[124:127], a[12:15], v[56:59]
    v_add_f32_dpp v144, v144, v144 quad_perm:[1,0,3,2] row_mask:0xf bank_mask:0xf
    v_add_f32_dpp v145, v145, v145 quad_perm:[1,0,3,2] row_mask:0xf bank_mask:0xf
    v_mfma_f32_16x16x32_bf16 v[48:51], v[128:131], a[8:11], v[48:51]
    s_add_u32 s72, s72, 4096
    buffer_load_dwordx4 a[64:67], v4, s[44:47], s72 offen offset:0 sc1
    v_mfma_f32_16x16x32_bf16 v[76:79], v[128:131], a[12:15], v[76:79]
    buffer_load_dwordx4 a[68:71], v4, s[44:47], s72 offen offset:1024 sc1
    s_waitcnt vmcnt(14)
    s_waitcnt lgkmcnt(0)
    v_mfma_f32_16x16x32_bf16 v[24:27], v[104:107], a[16:19], v[24:27]
    ds_read_b128 v[120:123], v4 offset:6144
    v_add_f32_dpp v146, v146, v146 quad_perm:[1,0,3,2] row_mask:0xf bank_mask:0xf
    v_mfma_f32_16x16x32_bf16 v[52:55], v[104:107], a[20:23], v[52:55]
    ds_read_b128 v[124:127], v4 offset:7168
    v_add_f32_dpp v147, v147, v147 quad_perm:[1,0,3,2] row_mask:0xf bank_mask:0xf
    v_mfma_f32_16x16x32_bf16 v[28:31], v[108:111], a[16:19], v[28:31]
    ds_read_b128 v[128:131], v4 offset:44032
    v_add_f32_dpp v148, v148, v148 quad_perm:[1,0,3,2] row_mask:0xf bank_mask:0xf
    v_mfma_f32_16x16x32_bf16 v[56:59], v[108:111], a[20:23], v[56:59]
    v_add_f32_dpp v149, v149, v149 quad_perm:[1,0,3,2] row_mask:0xf bank_mask:0xf
    v_add_f32_dpp v150, v150, v150 quad_perm:[1,0,3,2] row_mask:0xf bank_mask:0xf
    v_mfma_f32_16x16x32_bf16 v[48:51], v[112:115], a[16:19], v[48:51]
    buffer_load_dwordx4 a[72:75], v4, s[44:47], s72 offen offset:2048 sc1
    v_mfma_f32_16x16x32_bf16 v[76:79], v[112:115], a[20:23], v[76:79]
    buffer_load_dwordx4 a[76:79], v4, s[44:47], s72 offen offset:3072 sc1
    s_waitcnt vmcnt(14)
    s_waitcnt lgkmcnt(0)
    v_mfma_f32_16x16x32_bf16 v[24:27], v[120:123], a[24:27], v[24:27]
    ds_read_b128 v[104:107], v4 offset:8192
    v_add_f32_dpp v151, v151, v151 quad_perm:[1,0,3,2] row_mask:0xf bank_mask:0xf
    v_mfma_f32_16x16x32_bf16 v[52:55], v[120:123], a[28:31], v[52:55]
    ds_read_b128 v[108:111], v4 offset:9216
    v_add_f32_dpp v152, v152, v152 quad_perm:[1,0,3,2] row_mask:0xf bank_mask:0xf
    v_mfma_f32_16x16x32_bf16 v[28:31], v[124:127], a[24:27], v[28:31]
    ds_read_b128 v[112:115], v4 offset:45056
    v_add_f32_dpp v153, v153, v153 quad_perm:[1,0,3,2] row_mask:0xf bank_mask:0xf
    v_mfma_f32_16x16x32_bf16 v[56:59], v[124:127], a[28:31], v[56:59]
    v_add_f32_dpp v154, v154, v154 quad_perm:[1,0,3,2] row_mask:0xf bank_mask:0xf
    v_add_f32_dpp v155, v155, v155 quad_perm:[1,0,3,2] row_mask:0xf bank_mask:0xf
    v_mfma_f32_16x16x32_bf16 v[48:51], v[128:131], a[24:27], v[48:51]
    s_add_u32 s72, s72, 4096
    s_sub_u32 s72, s72, s7
    s_sub_u32 s72, s72, s7
    buffer_load_dwordx4 a[80:83], v4, s[44:47], s72 offen offset:0 sc1
    v_mfma_f32_16x16x32_bf16 v[76:79], v[128:131], a[28:31], v[76:79]
    buffer_load_dwordx4 a[84:87], v4, s[44:47], s72 offen offset:1024 sc1
    s_waitcnt vmcnt(14)
    s_waitcnt lgkmcnt(0)
    v_mfma_f32_16x16x32_bf16 v[24:27], v[104:107], a[32:35], v[24:27]
    ds_read_b128 v[120:123], v4 offset:10240
    v_add_f32_dpp v156, v156, v156 quad_perm:[1,0,3,2] row_mask:0xf bank_mask:0xf
    v_mfma_f32_16x16x32_bf16 v[52:55], v[104:107], a[36:39], v[52:55]
    ds_read_b128 v[124:127], v4 offset:11264
    v_add_f32_dpp v157, v157, v157 quad_perm:[1,0,3,2] row_mask:0xf bank_mask:0xf
    v_mfma_f32_16x16x32_bf16 v[28:31], v[108:111], a[32:35], v[28:31]
    ds_read_b128 v[128:131], v4 offset:46080
    v_add_f32_dpp v158, v158, v158 quad_perm:[1,0,3,2] row_mask:0xf bank_mask:0xf
    v_mfma_f32_16x16x32_bf16 v[56:59], v[108:111], a[36:39], v[56:59]
    v_add_f32_dpp v159, v159, v159 quad_perm:[1,0,3,2] row_mask:0xf bank_mask:0xf
    v_add_f32_dpp v160, v160, v160 quad_perm:[1,0,3,2] row_mask:0xf bank_mask:0xf
    v_mfma_f32_16x16x32_bf16 v[48:51], v[112:115], a[32:35], v[48:51]
    buffer_load_dwordx4 a[88:91], v4, s[44:47], s72 offen offset:2048 sc1
    v_mfma_f32_16x16x32_bf16 v[76:79], v[112:115], a[36:39], v[76:79]
    buffer_load_dwordx4 a[92:95], v4, s[44:47], s72 offen offset:3072 sc1
    s_waitcnt vmcnt(14)
    s_waitcnt lgkmcnt(0)
    v_mfma_f32_16x16x32_bf16 v[24:27], v[120:123], a[40:43], v[24:27]
    ds_read_b128 v[104:107], v4 offset:12288
    v_add_f32_dpp v161, v161, v161 quad_perm:[1,0,3,2] row_mask:0xf bank_mask:0xf
    v_mfma_f32_16x16x32_bf16 v[52:55], v[120:123], a[44:47], v[52:55]
    ds_read_b128 v[108:111], v4 offset:13312
    v_add_f32_dpp v162, v162, v162 quad_perm:[1,0,3,2] row_mask:0xf bank_mask:0xf
    v_mfma_f32_16x16x32_bf16 v[28:31], v[124:127], a[40:43], v[28:31]
    ds_read_b128 v[112:115], v4 offset:47104
    v_add_f32_dpp v163, v163, v163 quad_perm:[1,0,3,2] row_mask:0xf bank_mask:0xf
    v_mfma_f32_16x16x32_bf16 v[56:59], v[124:127], a[44:47], v[56:59]
    v_add_f32_dpp v136, v136, v136 quad_perm:[2,3,0,1] row_mask:0xf bank_mask:0xf
    v_add_f32_dpp v137, v137, v137 quad_perm:[2,3,0,1] row_mask:0xf bank_mask:0xf
    v_mfma_f32_16x16x32_bf16 v[48:51], v[128:131], a[40:43], v[48:51]
    s_add_u32 s72, s72, 4096
    buffer_load_dwordx2 a[96:97], v23, s[44:47], s72 offen offset:0 sc1
    buffer_load_dwordx2 a[98:99], v23, s[44:47], s72 offen offset:512 sc1
    v_mfma_f32_16x16x32_bf16 v[76:79], v[128:131], a[44:47], v[76:79]
    buffer_load_dwordx2 a[100:101], v23, s[44:47], s72 offen offset:1024 sc1
    buffer_load_dwordx2 a[102:103], v23, s[44:47], s72 offen offset:1536 sc1
    s_waitcnt vmcnt(16)
    s_waitcnt lgkmcnt(0)
    v_mfma_f32_16x16x32_bf16 v[24:27], v[104:107], a[48:51], v[24:27]
    ds_read_b128 v[120:123], v4 offset:14336
    v_add_f32_dpp v138, v138, v138 quad_perm:[2,3,0,1] row_mask:0xf bank_mask:0xf
    v_mfma_f32_16x16x32_bf16 v[52:55], v[104:107], a[52:55], v[52:55]
    ds_read_b128 v[124:127], v4 offset:15360
    v_add_f32_dpp v139, v139, v139 quad_perm:[2,3,0,1] row_mask:0xf bank_mask:0xf
    v_mfma_f32_16x16x32_bf16 v[28:31], v[108:111], a[48:51], v[28:31]
    ds_read_b128 v[128:131], v4 offset:48128
    v_add_f32_dpp v140, v140, v140 quad_perm:[2,3,0,1] row_mask:0xf bank_mask:0xf
    v_mfma_f32_16x16x32_bf16 v[56:59], v[108:111], a[52:55], v[56:59]
    v_add_f32_dpp v141, v141, v141 quad_perm:[2,3,0,1] row_mask:0xf bank_mask:0xf
    v_add_f32_dpp v142, v142, v142 quad_perm:[2,3,0,1] row_mask:0xf bank_mask:0xf
    v_mfma_f32_16x16x32_bf16 v[48:51], v[112:115], a[48:51], v[48:51]
    buffer_load_dwordx4 a[104:107], v4, s[44:47], s72 offen offset:2048 sc1
    v_mfma_f32_16x16x32_bf16 v[76:79], v[112:115], a[52:55], v[76:79]
    buffer_load_dwordx4 a[108:111], v4, s[44:47], s72 offen offset:3072 sc1
    s_waitcnt vmcnt(14)
    s_waitcnt lgkmcnt(0)
    v_mfma_f32_16x16x32_bf16 v[24:27], v[120:123], a[56:59], v[24:27]
    ds_read_b128 v[104:107], v4 offset:16384
    v_add_f32_dpp v143, v143, v143 quad_perm:[2,3,0,1] row_mask:0xf bank_mask:0xf
    v_mfma_f32_16x16x32_bf16 v[52:55], v[120:123], a[60:63], v[52:55]
    ds_read_b128 v[108:111], v4 offset:17408
    v_add_f32_dpp v144, v144, v144 quad_perm:[2,3,0,1] row_mask:0xf bank_mask:0xf
    v_mfma_f32_16x16x32_bf16 v[28:31], v[124:127], a[56:59], v[28:31]
    ds_read_b128 v[112:115], v4 offset:49152
    v_add_f32_dpp v145, v145, v145 quad_perm:[2,3,0,1] row_mask:0xf bank_mask:0xf
    v_mfma_f32_16x16x32_bf16 v[56:59], v[124:127], a[60:63], v[56:59]
    v_add_f32_dpp v146, v146, v146 quad_perm:[2,3,0,1] row_mask:0xf bank_mask:0xf
    v_add_f32_dpp v147, v147, v147 quad_perm:[2,3,0,1] row_mask:0xf bank_mask:0xf
    v_mfma_f32_16x16x32_bf16 v[48:51], v[128:131], a[56:59], v[48:51]
    s_add_u32 s72, s72, 4096
    buffer_load_dwordx4 a[112:115], v4, s[44:47], s72 offen offset:0 sc1
    v_mfma_f32_16x16x32_bf16 v[76:79], v[128:131], a[60:63], v[76:79]
    buffer_load_dwordx4 a[116:119], v4, s[44:47], s72 offen offset:1024 sc1
    s_waitcnt vmcnt(14)
    s_waitcnt lgkmcnt(0)
    v_mfma_f32_16x16x32_bf16 v[24:27], v[104:107], a[64:67], v[24:27]
    ds_read_b128 v[120:123], v4 offset:18432
    v_add_f32_dpp v148, v148, v148 quad_perm:[2,3,0,1] row_mask:0xf bank_mask:0xf
    v_mfma_f32_16x16x32_bf16 v[52:55], v[104:107], a[68:71], v[52:55]
    ds_read_b128 v[124:127], v4 offset:19456
    v_add_f32_dpp v149, v149, v149 quad_perm:[2,3,0,1] row_mask:0xf bank_mask:0xf
    v_mfma_f32_16x16x32_bf16 v[28:31], v[108:111], a[64:67], v[28:31]
    ds_read_b128 v[128:131], v4 offset:50176
    v_add_f32_dpp v150, v150, v150 quad_perm:[2,3,0,1] row_mask:0xf bank_mask:0xf
    v_mfma_f32_16x16x32_bf16 v[56:59], v[108:111], a[68:71], v[56:59]
    v_add_f32_dpp v151, v151, v151 quad_perm:[2,3,0,1] row_mask:0xf bank_mask:0xf
    v_add_f32_dpp v152, v152, v152 quad_perm:[2,3,0,1] row_mask:0xf bank_mask:0xf
    v_mfma_f32_16x16x32_bf16 v[48:51], v[112:115], a[64:67], v[48:51]
    buffer_load_dwordx4 a[120:123], v4, s[44:47], s72 offen offset:2048 sc1
    v_mfma_f32_16x16x32_bf16 v[76:79], v[112:115], a[68:71], v[76:79]
    buffer_load_dwordx4 a[124:127], v4, s[44:47], s72 offen offset:3072 sc1
    s_waitcnt vmcnt(14)
    s_waitcnt lgkmcnt(0)
    v_mfma_f32_16x16x32_bf16 v[24:27], v[120:123], a[72:75], v[24:27]
    ds_read_b128 v[104:107], v4 offset:20480
    v_add_f32_dpp v153, v153, v153 quad_perm:[2,3,0,1] row_mask:0xf bank_mask:0xf
    v_mfma_f32_16x16x32_bf16 v[52:55], v[120:123], a[76:79], v[52:55]
    ds_read_b128 v[108:111], v4 offset:21504
    v_add_f32_dpp v154, v154, v154 quad_perm:[2,3,0,1] row_mask:0xf bank_mask:0xf
    v_mfma_f32_16x16x32_bf16 v[28:31], v[124:127], a[72:75], v[28:31]
    ds_read_b128 v[112:115], v4 offset:51200
    v_add_f32_dpp v155, v155, v155 quad_perm:[2,3,0,1] row_mask:0xf bank_mask:0xf
    v_mfma_f32_16x16x32_bf16 v[56:59], v[124:127], a[76:79], v[56:59]
    v_add_f32_dpp v156, v156, v156 quad_perm:[2,3,0,1] row_mask:0xf bank_mask:0xf
    v_add_f32_dpp v157, v157, v157 quad_perm:[2,3,0,1] row_mask:0xf bank_mask:0xf
    v_mfma_f32_16x16x32_bf16 v[48:51], v[128:131], a[72:75], v[48:51]
    s_add_u32 s72, s72, 4096
    buffer_load_dwordx4 a[128:131], v4, s[44:47], s72 offen offset:0 sc1
    v_mfma_f32_16x16x32_bf16 v[76:79], v[128:131], a[76:79], v[76:79]
    buffer_load_dwordx4 a[132:135], v4, s[44:47], s72 offen offset:1024 sc1
    s_waitcnt vmcnt(14)
    s_waitcnt lgkmcnt(0)
    v_mfma_f32_16x16x32_bf16 v[24:27], v[104:107], a[80:83], v[24:27]
    ds_read_b128 v[120:123], v4 offset:22528
    v_add_f32_dpp v158, v158, v158 quad_perm:[2,3,0,1] row_mask:0xf bank_mask:0xf
    v_mfma_f32_16x16x32_bf16 v[52:55], v[104:107], a[84:87], v[52:55]
    ds_read_b128 v[124:127], v4 offset:23552
    v_add_f32_dpp v159, v159, v159 quad_perm:[2,3,0,1] row_mask:0xf bank_mask:0xf
    v_mfma_f32_16x16x32_bf16 v[28:31], v[108:111], a[80:83], v[28:31]
    ds_read_b128 v[128:131], v4 offset:52224
    v_add_f32_dpp v160, v160, v160 quad_perm:[2,3,0,1] row_mask:0xf bank_mask:0xf
    v_mfma_f32_16x16x32_bf16 v[56:59], v[108:111], a[84:87], v[56:59]
    v_add_f32_dpp v161, v161, v161 quad_perm:[2,3,0,1] row_mask:0xf bank_mask:0xf
    v_add_f32_dpp v162, v162, v162 quad_perm:[2,3,0,1] row_mask:0xf bank_mask:0xf
    v_mfma_f32_16x16x32_bf16 v[48:51], v[112:115], a[80:83], v[48:51]
    buffer_load_dwordx2 a[136:137], v23, s[44:47], s72 offen offset:2048 sc1
    buffer_load_dwordx2 a[138:139], v23, s[44:47], s72 offen offset:2560 sc1
    v_mfma_f32_16x16x32_bf16 v[76:79], v[112:115], a[84:87], v[76:79]
    buffer_load_dwordx2 a[140:141], v23, s[44:47], s72 offen offset:3072 sc1
    buffer_load_dwordx2 a[142:143], v23, s[44:47], s72 offen offset:3584 sc1
    s_waitcnt vmcnt(16)
    s_waitcnt lgkmcnt(0)
    v_mfma_f32_16x16x32_bf16 v[24:27], v[120:123], a[88:91], v[24:27]
    ds_read_b128 v[104:107], v4 offset:24576
    v_add_f32_dpp v163, v163, v163 quad_perm:[2,3,0,1] row_mask:0xf bank_mask:0xf
    v_mfma_f32_16x16x32_bf16 v[52:55], v[120:123], a[92:95], v[52:55]
    ds_read_b128 v[108:111], v4 offset:25600
    v_add_f32_dpp v136, v136, v136 row_half_mirror row_mask:0xf bank_mask:0xf
    v_mfma_f32_16x16x32_bf16 v[28:31], v[124:127], a[88:91], v[28:31]
    ds_read_b128 v[112:115], v4 offset:53248
    v_add_f32_dpp v137, v137, v137 row_half_mirror row_mask:0xf bank_mask:0xf
    v_mfma_f32_16x16x32_bf16 v[56:59], v[124:127], a[92:95], v[56:59]
    v_add_f32_dpp v138, v138, v138 row_half_mirror row_mask:0xf bank_mask:0xf
    v_add_f32_dpp v139, v139, v139 row_half_mirror row_mask:0xf bank_mask:0xf
    v_mfma_f32_16x16x32_bf16 v[48:51], v[128:131], a[88:91], v[48:51]
    s_add_u32 s72, s72, 4096
    buffer_load_dwordx4 a[144:147], v4, s[44:47], s72 offen offset:0 sc1
    v_mfma_f32_16x16x32_bf16 v[76:79], v[128:131], a[92:95], v[76:79]
    buffer_load_dwordx4 a[148:151], v4, s[44:47], s72 offen offset:1024 sc1
    s_waitcnt vmcnt(14)
    s_waitcnt lgkmcnt(0)
    v_mfma_f32_16x16x32_bf16 v[24:27], v[104:107], a[96:99], v[24:27]
    ds_read_b128 v[120:123], v4 offset:26624
    v_add_f32_dpp v140, v140, v140 row_half_mirror row_mask:0xf bank_mask:0xf
    v_mfma_f32_16x16x32_bf16 v[52:55], v[104:107], a[100:103], v[52:55]
    ds_read_b128 v[124:127], v4 offset:27648
    v_add_f32_dpp v141, v141, v141 row_half_mirror row_mask:0xf bank_mask:0xf
    v_mfma_f32_16x16x32_bf16 v[28:31], v[108:111], a[96:99], v[28:31]
    ds_read_b128 v[128:131], v4 offset:54272
    v_add_f32_dpp v142, v142, v142 row_half_mirror row_mask:0xf bank_mask:0xf
    v_mfma_f32_16x16x32_bf16 v[56:59], v[108:111], a[100:103], v[56:59]
    v_add_f32_dpp v143, v143, v143 row_half_mirror row_mask:0xf bank_mask:0xf
    v_add_f32_dpp v144, v144, v144 row_half_mirror row_mask:0xf bank_mask:0xf
    v_mfma_f32_16x16x32_bf16 v[48:51], v[112:115], a[96:99], v[48:51]
    buffer_load_dwordx4 a[152:155], v4, s[44:47], s72 offen offset:2048 sc1
    v_mfma_f32_16x16x32_bf16 v[76:79], v[112:115], a[100:103], v[76:79]
    buffer_load_dwordx4 a[156:159], v4, s[44:47], s72 offen offset:3072 sc1
    s_waitcnt vmcnt(14)
    s_waitcnt lgkmcnt(0)
    v_mfma_f32_16x16x32_bf16 v[24:27], v[120:123], a[104:107], v[24:27]
    ds_read_b128 v[104:107], v4 offset:28672
    v_add_f32_dpp v145, v145, v145 row_half_mirror row_mask:0xf bank_mask:0xf
    v_mfma_f32_16x16x32_bf16 v[52:55], v[120:123], a[108:111], v[52:55]
    ds_read_b128 v[108:111], v4 offset:29696
    v_add_f32_dpp v146, v146, v146 row_half_mirror row_mask:0xf bank_mask:0xf
    v_mfma_f32_16x16x32_bf16 v[28:31], v[124:127], a[104:107], v[28:31]
    ds_read_b128 v[112:115], v4 offset:55296
    v_add_f32_dpp v147, v147, v147 row_half_mirror row_mask:0xf bank_mask:0xf
    v_mfma_f32_16x16x32_bf16 v[56:59], v[124:127], a[108:111], v[56:59]
    v_add_f32_dpp v148, v148, v148 row_half_mirror row_mask:0xf bank_mask:0xf
    v_add_f32_dpp v149, v149, v149 row_half_mirror row_mask:0xf bank_mask:0xf
    v_mfma_f32_16x16x32_bf16 v[48:51], v[128:131], a[104:107], v[48:51]
    s_add_u32 s28, s35, 40960
    buffer_load_dwordx4 v[216:219], v4, s[44:47], s28 offen offset:0 sc1
    v_mfma_f32_16x16x32_bf16 v[76:79], v[128:131], a[108:111], v[76:79]
    buffer_load_dwordx4 v[220:223], v4, s[44:47], s28 offen offset:1024 sc1
    s_waitcnt vmcnt(14)
    s_waitcnt lgkmcnt(0)
    v_mfma_f32_16x16x32_bf16 v[24:27], v[104:107], a[112:115], v[24:27]
    ds_read_b128 v[120:123], v4 offset:30720
    v_add_f32_dpp v150, v150, v150 row_half_mirror row_mask:0xf bank_mask:0xf
    v_mfma_f32_16x16x32_bf16 v[52:55], v[104:107], a[116:119], v[52:55]
    ds_read_b128 v[124:127], v4 offset:31744
    v_add_f32_dpp v151, v151, v151 row_half_mirror row_mask:0xf bank_mask:0xf
    v_mfma_f32_16x16x32_bf16 v[28:31], v[108:111], a[112:115], v[28:31]
    ds_read_b128 v[128:131], v4 offset:56320
    v_add_f32_dpp v152, v152, v152 row_half_mirror row_mask:0xf bank_mask:0xf
    v_mfma_f32_16x16x32_bf16 v[56:59], v[108:111], a[116:119], v[56:59]
    v_add_f32_dpp v153, v153, v153 row_half_mirror row_mask:0xf bank_mask:0xf
    v_add_f32_dpp v154, v154, v154 row_half_mirror row_mask:0xf bank_mask:0xf
    v_mfma_f32_16x16x32_bf16 v[48:51], v[112:115], a[112:115], v[48:51]
    buffer_load_dwordx4 v[224:227], v4, s[44:47], s28 offen offset:2048 sc1
    v_mfma_f32_16x16x32_bf16 v[76:79], v[112:115], a[116:119], v[76:79]
    buffer_load_dwordx4 v[228:231], v4, s[44:47], s28 offen offset:3072 sc1
    s_waitcnt vmcnt(14)
    s_waitcnt lgkmcnt(0)
    v_mfma_f32_16x16x32_bf16 v[24:27], v[120:123], a[120:123], v[24:27]
    ds_read_b128 v[104:107], v4 offset:32768
    v_add_f32_dpp v155, v155, v155 row_half_mirror row_mask:0xf bank_mask:0xf
    v_mfma_f32_16x16x32_bf16 v[52:55], v[120:123], a[124:127], v[52:55]
    ds_read_b128 v[108:111], v4 offset:33792
    v_add_f32_dpp v156, v156, v156 row_half_mirror row_mask:0xf bank_mask:0xf
    v_mfma_f32_16x16x32_bf16 v[28:31], v[124:127], a[120:123], v[28:31]
    ds_read_b128 v[112:115], v4 offset:57344
    v_add_f32_dpp v157, v157, v157 row_half_mirror row_mask:0xf bank_mask:0xf
    v_mfma_f32_16x16x32_bf16 v[56:59], v[124:127], a[124:127], v[56:59]
    v_add_f32_dpp v158, v158, v158 row_half_mirror row_mask:0xf bank_mask:0xf
    v_add_f32_dpp v159, v159, v159 row_half_mirror row_mask:0xf bank_mask:0xf
    v_mfma_f32_16x16x32_bf16 v[48:51], v[128:131], a[120:123], v[48:51]
    buffer_load_dwordx4 v[232:235], v5, s[44:47], s28 offen offset:0 sc1
    v_mfma_f32_16x16x32_bf16 v[76:79], v[128:131], a[124:127], v[76:79]
    s_add_u32 s28, s35, 61440
    buffer_load_dwordx4 v[236:239], v4, s[44:47], s28 offen offset:0 sc1
    s_waitcnt vmcnt(14)
    s_waitcnt lgkmcnt(0)
    v_mfma_f32_16x16x32_bf16 v[24:27], v[104:107], a[128:131], v[24:27]
    ds_read_b128 v[120:123], v4 offset:34816
    v_add_f32_dpp v160, v160, v160 row_half_mirror row_mask:0xf bank_mask:0xf
    v_mfma_f32_16x16x32_bf16 v[52:55], v[104:107], a[132:135], v[52:55]
    ds_read_b128 v[124:127], v4 offset:35840
    v_add_f32_dpp v161, v161, v161 row_half_mirror row_mask:0xf bank_mask:0xf
    v_mfma_f32_16x16x32_bf16 v[28:31], v[108:111], a[128:131], v[28:31]
    ds_read_b128 v[128:131], v4 offset:58368
    v_add_f32_dpp v162, v162, v162 row_half_mirror row_mask:0xf bank_mask:0xf
    v_mfma_f32_16x16x32_bf16 v[56:59], v[108:111], a[132:135], v[56:59]
    v_add_f32_dpp v163, v163, v163 row_half_mirror row_mask:0xf bank_mask:0xf
    v_add_f32 v82, v164, v166
    v_mfma_f32_16x16x32_bf16 v[48:51], v[112:115], a[128:131], v[48:51]
    buffer_load_dwordx4 v[240:243], v4, s[44:47], s28 offen offset:1024 sc1
    v_mfma_f32_16x16x32_bf16 v[76:79], v[112:115], a[132:135], v[76:79]
    buffer_load_dwordx4 v[244:247], v4, s[44:47], s28 offen offset:2048 sc1
    s_waitcnt vmcnt(12)
    s_waitcnt lgkmcnt(0)
    v_mfma_f32_16x16x32_bf16 v[24:27], v[120:123], a[136:139], v[24:27]
    ds_read_b128 v[104:107], v4 offset:36864
    v_add_f32 v86, v168, v170
    v_mfma_f32_16x16x32_bf16 v[52:55], v[120:123], a[140:143], v[52:55]
    ds_read_b128 v[108:111], v4 offset:37888
    v_add_f32 v88, v165, v167
    v_mfma_f32_16x16x32_bf16 v[28:31], v[124:127], a[136:139], v[28:31]
    ds_read_b128 v[112:115], v4 offset:59392
    v_add_f32 v90, v169, v171
    v_mfma_f32_16x16x32_bf16 v[56:59], v[124:127], a[140:143], v[56:59]
    v_mov_b32 v89, v82
    v_mov_b32 v91, v86
    v_mfma_f32_16x16x32_bf16 v[48:51], v[128:131], a[136:139], v[48:51]
    buffer_load_dwordx4 v[248:251], v4, s[44:47], s28 offen offset:3072 sc1
    v_mfma_f32_16x16x32_bf16 v[76:79], v[128:131], a[140:143], v[76:79]
    buffer_load_dwordx4 v[252:255], v5, s[44:47], s28 offen offset:0 sc1
    s_waitcnt vmcnt(12)
    s_waitcnt lgkmcnt(0)
    v_mfma_f32_16x16x32_bf16 v[24:27], v[104:107], a[144:147], v[24:27]
    ds_read_b128 v[120:123], v4 offset:38912
    v_permlane32_swap_b32 v82, v89
    v_mfma_f32_16x16x32_bf16 v[52:55], v[104:107], a[148:151], v[52:55]
    ds_read_b128 v[124:127], v4 offset:39936
    v_permlane32_swap_b32 v86, v91
    v_mfma_f32_16x16x32_bf16 v[28:31], v[108:111], a[144:147], v[28:31]
    ds_read_b128 v[128:131], v4 offset:60416
    v_add_f32 v82, v82, v89
    v_mfma_f32_16x16x32_bf16 v[56:59], v[108:111], a[148:151], v[56:59]
    v_add_f32 v86, v86, v91
    v_mov_b32 v89, v82
    v_mfma_f32_16x16x32_bf16 v[48:51], v[112:115], a[144:147], v[48:51]
    s_add_u32 s28, s35, 163840
    s_mul_i32 s75, s60, 5120
    s_add_u32 m0, s75, 143360
    s_nop 0
    buffer_load_dwordx4 v4, s[44:47], s28 offen offset:0 sc1 lds
    v_mfma_f32_16x16x32_bf16 v[76:79], v[112:115], a[148:151], v[76:79]
    buffer_load_dwordx4 v4, s[44:47], s28 offen offset:1024 sc1 lds
    s_waitcnt vmcnt(12)
    s_waitcnt lgkmcnt(0)
    v_mfma_f32_16x16x32_bf16 v[24:27], v[120:123], a[152:155], v[24:27]
    ds_read_b128 v[104:107], v4 offset:61440
    v_mov_b32 v91, v86
    v_mfma_f32_16x16x32_bf16 v[52:55], v[120:123], a[156:159], v[52:55]
    ds_read_b128 v[108:111], v4 offset:62464
    v_permlane16_swap_b32 v82, v89
    v_mfma_f32_16x16x32_bf16 v[28:31], v[124:127], a[152:155], v[28:31]
    ds_read_b128 v[112:115], v4 offset:63488
    v_permlane16_swap_b32 v86, v91
    v_mfma_f32_16x16x32_bf16 v[56:59], v[124:127], a[156:159], v[56:59]
    ds_read_b128 v[116:119], v4 offset:64512
    v_add_f32 v82, v82, v89
    v_mfma_f32_16x16x32_bf16 v[48:51], v[128:131], a[152:155], v[48:51]
    buffer_load_dwordx4 v4, s[44:47], s28 offen offset:2048 sc1 lds
    v_mfma_f32_16x16x32_bf16 v[76:79], v[128:131], a[156:159], v[76:79]
    buffer_load_dwordx4 v4, s[44:47], s28 offen offset:3072 sc1 lds
    v_add_f32 v86, v86, v91
    v_mov_b32 v89, v88
    v_mov_b32 v91, v90
    s_nop 0
    v_permlane32_swap_b32 v88, v89
    v_permlane32_swap_b32 v90, v91
    v_add_f32 v88, v88, v89
    v_add_f32 v90, v90, v91
    v_mov_b32 v89, v88
    v_mov_b32 v91, v90
    s_nop 0
    v_permlane16_swap_b32 v88, v89
    v_permlane16_swap_b32 v90, v91
    v_add_f32 v88, v88, v89
    v_add_f32 v90, v90, v91
    v_mul_f32 v82, 0x3acccccd, v82
    v_mul_f32 v86, 0x3acccccd, v86
    v_mul_f32 v88, 0x3acccccd, v88
    v_mul_f32 v90, 0x3acccccd, v90
    v_fma_f32 v88, -v82, v82, v88
    v_fma_f32 v90, -v86, v86, v90
    v_max_f32 v88, 0, v88
    v_max_f32 v90, 0, v90
    v_cvt_pk_bf16_f32 v82, v82, v82
    v_cvt_pk_bf16_f32 v86, v86, v86
    v_lshlrev_b32 v82, 16, v82
    v_lshlrev_b32 v86, 16, v86
    v_cvt_pk_bf16_f32 v88, v88, v88
    v_cvt_pk_bf16_f32 v90, v90, v90
    v_lshlrev_b32 v88, 16, v88
    v_lshlrev_b32 v90, 16, v90
    v_add_f32 v88, 0x3727c5ac, v88
    v_add_f32 v90, 0x3727c5ac, v90
    v_cvt_pk_bf16_f32 v88, v88, v88
    v_cvt_pk_bf16_f32 v90, v90, v90
    v_lshlrev_b32 v88, 16, v88
    v_lshlrev_b32 v90, 16, v90
    v_sqrt_f32 v88, v88
    v_sqrt_f32 v90, v90
    v_cvt_pk_bf16_f32 v88, v88, v88
    v_cvt_pk_bf16_f32 v90, v90, v90
    v_lshlrev_b32 v88, 16, v88
    v_lshlrev_b32 v90, 16, v90
    v_rcp_f32 v80, v88
    v_rcp_f32 v84, v90
    v_mul_f32 v82, v82, v80
    v_mul_f32 v86, v86, v84
    v_sub_f32 v82, 0, v82
    v_sub_f32 v86, 0, v86
    v_mov_b32 v164, v80
    v_mov_b32 v168, v84
    v_mov_b32 v165, v82
    v_mov_b32 v169, v86
    s_waitcnt lgkmcnt(0)
    v_mfma_f32_16x16x32_bf16 v[32:35], v[104:107], a[0:3], 0
    ds_read_b128 v[120:123], v9 offset:0
    v_mul_f32 v24, v24, v164
    v_mul_f32 v25, v25, v164
    v_mfma_f32_16x16x32_bf16 v[60:63], v[104:107], a[4:7], 0
    ds_read_b128 v[124:127], v9 offset:1024
    v_mul_f32 v26, v26, v164
    v_mul_f32 v27, v27, v164
    v_mfma_f32_16x16x32_bf16 v[36:39], v[108:111], a[0:3], 0
    ds_read_b128 v[128:131], v9 offset:2048
    v_fmac_f32 v24, v136, v165
    v_fmac_f32 v25, v137, v165
    v_mfma_f32_16x16x32_bf16 v[64:67], v[108:111], a[4:7], 0
    ds_read_b128 v[132:135], v9 offset:3072
    v_fmac_f32 v26, v138, v165
    v_fmac_f32 v27, v139, v165
    v_mfma_f32_16x16x32_bf16 v[32:35], v[112:115], a[8:11], v[32:35]
    v_cvt_pk_bf16_f32 v80, v24, v25
    v_cvt_pk_bf16_f32 v81, v26, v27
    v_pk_max_i16 v80, v80, v11
    v_mfma_f32_16x16x32_bf16 v[60:63], v[112:115], a[12:15], v[60:63]
    v_pk_max_i16 v81, v81, v11
    v_mul_f32 v28, v28, v164
    v_mul_f32 v29, v29, v164
    v_mfma_f32_16x16x32_bf16 v[36:39], v[116:119], a[8:11], v[36:39]
    s_mul_i32 s75, s60, 5120
    s_add_u32 m0, s75, 147456
    s_nop 0
    buffer_load_dwordx4 v5, s[44:47], s28 offen offset:0 sc1 lds
    v_mul_f32 v30, v30, v164
    v_mfma_f32_16x16x32_bf16 v[64:67], v[116:119], a[12:15], v[64:67]
    v_mul_f32 v31, v31, v164
    v_fmac_f32 v28, v140, v165
    v_fmac_f32 v29, v141, v165
    s_waitcnt lgkmcnt(0)
    s_barrier
    v_mfma_f32_16x16x32_bf16 v[32:35], v[120:123], a[16:19], v[32:35]
    ds_read_b128 v[104:107], v9 offset:4096
    v_fmac_f32 v30, v142, v165
    v_fmac_f32 v31, v143, v165
    v_mfma_f32_16x16x32_bf16 v[60:63], v[120:123], a[20:23], v[60:63]
    ds_read_b128 v[108:111], v9 offset:5120
    v_cvt_pk_bf16_f32 v82, v28, v29
    v_cvt_pk_bf16_f32 v83, v30, v31
    v_mfma_f32_16x16x32_bf16 v[36:39], v[124:127], a[16:19], v[36:39]
    ds_read_b128 v[112:115], v9 offset:6144
    v_pk_max_i16 v82, v82, v11
    v_pk_max_i16 v83, v83, v11
    v_mfma_f32_16x16x32_bf16 v[64:67], v[124:127], a[20:23], v[64:67]
    ds_read_b128 v[116:119], v9 offset:7168
    buffer_store_dwordx4 v[80:83], v4, s[44:47], s61 offen offset:0 sc1
    v_mul_f32 v52, v52, v168
    v_mfma_f32_16x16x32_bf16 v[32:35], v[128:131], a[24:27], v[32:35]
    v_mul_f32 v53, v53, v168
    v_mul_f32 v54, v54, v168
    v_mul_f32 v55, v55, v168
    v_mfma_f32_16x16x32_bf16 v[60:63], v[128:131], a[28:31], v[60:63]
    v_fmac_f32 v52, v136, v169
    v_fmac_f32 v53, v137, v169
    v_fmac_f32 v54, v138, v169
    v_mfma_f32_16x16x32_bf16 v[36:39], v[132:135], a[24:27], v[36:39]
    v_fmac_f32 v55, v139, v169
    v_cvt_pk_bf16_f32 v84, v52, v53
    v_cvt_pk_bf16_f32 v85, v54, v55
    v_mfma_f32_16x16x32_bf16 v[64:67], v[132:135], a[28:31], v[64:67]
    v_pk_max_i16 v84, v84, v11
    v_pk_max_i16 v85, v85, v11
    v_mul_f32 v56, v56, v168
    s_waitcnt lgkmcnt(0)
    v_mfma_f32_16x16x32_bf16 v[32:35], v[104:107], a[32:35], v[32:35]
    ds_read_b128 v[120:123], v9 offset:8192
    v_mul_f32 v57, v57, v168
    v_mul_f32 v58, v58, v168
    v_mfma_f32_16x16x32_bf16 v[60:63], v[104:107], a[36:39], v[60:63]
    ds_read_b128 v[124:127], v9 offset:9216
    v_mul_f32 v59, v59, v168
    v_fmac_f32 v56, v140, v169
    v_mfma_f32_16x16x32_bf16 v[36:39], v[108:111], a[32:35], v[36:39]
    ds_read_b128 v[128:131], v9 offset:10240
    v_fmac_f32 v57, v141, v169
    v_fmac_f32 v58, v142, v169
    v_mfma_f32_16x16x32_bf16 v[64:67], v[108:111], a[36:39], v[64:67]
    ds_read_b128 v[132:135], v9 offset:11264
    v_fmac_f32 v59, v143, v169
    v_cvt_pk_bf16_f32 v86, v56, v57
    v_mfma_f32_16x16x32_bf16 v[32:35], v[112:115], a[40:43], v[32:35]
    v_cvt_pk_bf16_f32 v87, v58, v59
    v_pk_max_i16 v86, v86, v11
    v_pk_max_i16 v87, v87, v11
    v_mfma_f32_16x16x32_bf16 v[60:63], v[112:115], a[44:47], v[60:63]
    buffer_store_dwordx4 v[84:87], v4, s[44:47], s61 offen offset:1024 sc1
    v_mul_f32 v48, v48, v164
    v_mul_f32 v49, v49, v164
    v_mfma_f32_16x16x32_bf16 v[36:39], v[116:119], a[40:43], v[36:39]
    v_mul_f32 v50, v50, v164
    v_mul_f32 v51, v51, v164
    v_fmac_f32 v48, v160, v165
    v_mfma_f32_16x16x32_bf16 v[64:67], v[116:119], a[44:47], v[64:67]
    v_fmac_f32 v49, v161, v165
    v_fmac_f32 v50, v162, v165
    v_fmac_f32 v51, v163, v165
    s_waitcnt lgkmcnt(0)
    v_mfma_f32_16x16x32_bf16 v[32:35], v[120:123], a[48:51], v[32:35]
    ds_read_b128 v[104:107], v9 offset:12288
    v_cvt_pk_bf16_f32 v88, v48, v49
    v_cvt_pk_bf16_f32 v89, v50, v51
    v_mfma_f32_16x16x32_bf16 v[60:63], v[120:123], a[52:55], v[60:63]
    ds_read_b128 v[108:111], v9 offset:13312
    v_pk_max_i16 v88, v88, v11
    v_pk_max_i16 v89, v89, v11
    v_mfma_f32_16x16x32_bf16 v[36:39], v[124:127], a[48:51], v[36:39]
    ds_read_b128 v[112:115], v9 offset:14336
    buffer_store_dwordx2 v[88:89], v23, s[44:47], s62 offen offset:0 sc1
    v_mul_f32 v76, v76, v168
    v_mfma_f32_16x16x32_bf16 v[64:67], v[124:127], a[52:55], v[64:67]
    ds_read_b128 v[116:119], v9 offset:15360
    v_mul_f32 v77, v77, v168
    v_mul_f32 v78, v78, v168
    v_mfma_f32_16x16x32_bf16 v[32:35], v[128:131], a[56:59], v[32:35]
    v_mul_f32 v79, v79, v168
    v_fmac_f32 v76, v160, v169
    v_fmac_f32 v77, v161, v169
    v_mfma_f32_16x16x32_bf16 v[60:63], v[128:131], a[60:63], v[60:63]
    v_fmac_f32 v78, v162, v169
    v_fmac_f32 v79, v163, v169
    v_cvt_pk_bf16_f32 v90, v76, v77
    v_mfma_f32_16x16x32_bf16 v[36:39], v[132:135], a[56:59], v[36:39]
    v_cvt_pk_bf16_f32 v91, v78, v79
    v_pk_max_i16 v90, v90, v11
    v_pk_max_i16 v91, v91, v11
    v_mfma_f32_16x16x32_bf16 v[64:67], v[132:135], a[60:63], v[64:67]
    buffer_store_dwordx2 v[90:91], v23, s[44:47], s62 offen offset:1024 sc1
    s_waitcnt lgkmcnt(0)
    v_mfma_f32_16x16x32_bf16 v[32:35], v[104:107], a[64:67], v[32:35]
    ds_read_b128 v[120:123], v9 offset:16384
    v_mfma_f32_16x16x32_bf16 v[60:63], v[104:107], a[68:71], v[60:63]
    ds_read_b128 v[124:127], v9 offset:17408
    v_mfma_f32_16x16x32_bf16 v[36:39], v[108:111], a[64:67], v[36:39]
    ds_read_b128 v[128:131], v9 offset:18432
    v_mfma_f32_16x16x32_bf16 v[64:67], v[108:111], a[68:71], v[64:67]
    ds_read_b128 v[132:135], v9 offset:19456
    v_mfma_f32_16x16x32_bf16 v[32:35], v[112:115], a[72:75], v[32:35]
    v_mfma_f32_16x16x32_bf16 v[60:63], v[112:115], a[76:79], v[60:63]
    v_mfma_f32_16x16x32_bf16 v[36:39], v[116:119], a[72:75], v[36:39]
    s_add_u32 s28, s35, 184320
    s_mul_i32 s75, s60, 5120
    s_add_u32 m0, s75, 0
    s_nop 0
    buffer_load_dwordx4 v4, s[44:47], s28 offen offset:0 sc1 lds
    v_mfma_f32_16x16x32_bf16 v[64:67], v[116:119], a[76:79], v[64:67]
    buffer_load_dwordx4 v4, s[44:47], s28 offen offset:1024 sc1 lds
    s_waitcnt lgkmcnt(0)
    v_mfma_f32_16x16x32_bf16 v[32:35], v[120:123], a[80:83], v[32:35]
    ds_read_b128 v[104:107], v9 offset:20480
    v_mfma_f32_16x16x32_bf16 v[60:63], v[120:123], a[84:87], v[60:63]
    ds_read_b128 v[108:111], v9 offset:21504
    v_mfma_f32_16x16x32_bf16 v[36:39], v[124:127], a[80:83], v[36:39]
    ds_read_b128 v[112:115], v9 offset:22528
    v_mfma_f32_16x16x32_bf16 v[64:67], v[124:127], a[84:87], v[64:67]
    ds_read_b128 v[116:119], v9 offset:23552
    v_mfma_f32_16x16x32_bf16 v[32:35], v[128:131], a[88:91], v[32:35]
    v_mfma_f32_16x16x32_bf16 v[60:63], v[128:131], a[92:95], v[60:63]
    v_mfma_f32_16x16x32_bf16 v[36:39], v[132:135], a[88:91], v[36:39]
    buffer_load_dwordx4 v4, s[44:47], s28 offen offset:2048 sc1 lds
    v_mfma_f32_16x16x32_bf16 v[64:67], v[132:135], a[92:95], v[64:67]
    buffer_load_dwordx4 v4, s[44:47], s28 offen offset:3072 sc1 lds
    s_waitcnt lgkmcnt(0)
    v_mfma_f32_16x16x32_bf16 v[32:35], v[104:107], a[96:99], v[32:35]
    ds_read_b128 v[120:123], v9 offset:24576
    v_mfma_f32_16x16x32_bf16 v[60:63], v[104:107], a[100:103], v[60:63]
    ds_read_b128 v[124:127], v9 offset:25600
    v_mfma_f32_16x16x32_bf16 v[36:39], v[108:111], a[96:99], v[36:39]
    ds_read_b128 v[128:131], v9 offset:26624
    v_mfma_f32_16x16x32_bf16 v[64:67], v[108:111], a[100:103], v[64:67]
    ds_read_b128 v[132:135], v9 offset:27648
    v_mfma_f32_16x16x32_bf16 v[32:35], v[112:115], a[104:107], v[32:35]
    v_mfma_f32_16x16x32_bf16 v[60:63], v[112:115], a[108:111], v[60:63]
    v_mfma_f32_16x16x32_bf16 v[36:39], v[116:119], a[104:107], v[36:39]
    s_mul_i32 s75, s60, 5120
    s_add_u32 m0, s75, 4096
    s_nop 0
    buffer_load_dwordx4 v5, s[44:47], s28 offen offset:0 sc1 lds
    v_mfma_f32_16x16x32_bf16 v[64:67], v[116:119], a[108:111], v[64:67]
    s_add_u32 s28, s35, 204800
    s_mul_i32 s75, s60, 5120
    s_add_u32 m0, s75, 20480
    s_nop 0
    buffer_load_dwordx4 v4, s[44:47], s28 offen offset:0 sc1 lds
    s_waitcnt lgkmcnt(0)
    v_mfma_f32_16x16x32_bf16 v[32:35], v[120:123], a[112:115], v[32:35]
    ds_read_b128 v[104:107], v9 offset:28672
    v_mfma_f32_16x16x32_bf16 v[60:63], v[120:123], a[116:119], v[60:63]
    ds_read_b128 v[108:111], v9 offset:29696
    v_mfma_f32_16x16x32_bf16 v[36:39], v[124:127], a[112:115], v[36:39]
    ds_read_b128 v[112:115], v9 offset:30720
    v_mfma_f32_16x16x32_bf16 v[64:67], v[124:127], a[116:119], v[64:67]
    ds_read_b128 v[116:119], v9 offset:31744
    v_mfma_f32_16x16x32_bf16 v[32:35], v[128:131], a[120:123], v[32:35]
    v_mfma_f32_16x16x32_bf16 v[60:63], v[128:131], a[124:127], v[60:63]
    v_mfma_f32_16x16x32_bf16 v[36:39], v[132:135], a[120:123], v[36:39]
    buffer_load_dwordx4 v4, s[44:47], s28 offen offset:1024 sc1 lds
    v_mfma_f32_16x16x32_bf16 v[64:67], v[132:135], a[124:127], v[64:67]
    buffer_load_dwordx4 v4, s[44:47], s28 offen offset:2048 sc1 lds
    s_waitcnt vmcnt(8)
    s_barrier
    s_mov_b64 exec, 1
    buffer_atomic_add v10, v11, s[44:47], s5 offen offset:128 sc1
    s_mov_b64 exec, -1
    s_waitcnt lgkmcnt(0)
    v_mfma_f32_16x16x32_bf16 v[32:35], v[104:107], a[128:131], v[32:35]
    ds_read_b128 v[120:123], v9 offset:32768
    v_mfma_f32_16x16x32_bf16 v[60:63], v[104:107], a[132:135], v[60:63]
    ds_read_b128 v[124:127], v9 offset:33792
    v_mfma_f32_16x16x32_bf16 v[36:39], v[108:111], a[128:131], v[36:39]
    ds_read_b128 v[128:131], v9 offset:34816
    v_mfma_f32_16x16x32_bf16 v[64:67], v[108:111], a[132:135], v[64:67]
    ds_read_b128 v[132:135], v9 offset:35840
    v_mfma_f32_16x16x32_bf16 v[32:35], v[112:115], a[136:139], v[32:35]
    v_mfma_f32_16x16x32_bf16 v[60:63], v[112:115], a[140:143], v[60:63]
    v_mfma_f32_16x16x32_bf16 v[36:39], v[116:119], a[136:139], v[36:39]
    buffer_load_dwordx4 v4, s[44:47], s28 offen offset:3072 sc1 lds
    v_mfma_f32_16x16x32_bf16 v[64:67], v[116:119], a[140:143], v[64:67]
    s_mul_i32 s75, s60, 5120
    s_add_u32 m0, s75, 24576
    s_nop 0
    buffer_load_dwordx4 v5, s[44:47], s28 offen offset:0 sc1 lds
    s_waitcnt lgkmcnt(0)
    v_mfma_f32_16x16x32_bf16 v[32:35], v[120:123], a[144:147], v[32:35]
    ds_read_b128 v[104:107], v9 offset:36864
    v_mfma_f32_16x16x32_bf16 v[60:63], v[120:123], a[148:151], v[60:63]
    ds_read_b128 v[108:111], v9 offset:37888
    v_mfma_f32_16x16x32_bf16 v[36:39], v[124:127], a[144:147], v[36:39]
    ds_read_b128 v[112:115], v9 offset:38912
    v_mfma_f32_16x16x32_bf16 v[64:67], v[124:127], a[148:151], v[64:67]
    ds_read_b128 v[116:119], v9 offset:39936
    v_mfma_f32_16x16x32_bf16 v[32:35], v[128:131], a[152:155], v[32:35]
    v_mfma_f32_16x16x32_bf16 v[60:63], v[128:131], a[156:159], v[60:63]
    v_mfma_f32_16x16x32_bf16 v[36:39], v[132:135], a[152:155], v[36:39]
    s_add_u32 s28, s35, 225280
    s_mul_i32 s75, s60, 5120
    s_add_u32 m0, s75, 40960
    s_nop 0
    buffer_load_dwordx4 v4, s[44:47], s28 offen offset:0 sc1 lds
    v_mfma_f32_16x16x32_bf16 v[64:67], v[132:135], a[156:159], v[64:67]
    buffer_load_dwordx4 v4, s[44:47], s28 offen offset:1024 sc1 lds
    s_waitcnt lgkmcnt(0)
    v_mfma_f32_16x16x32_bf16 v[40:43], v[104:107], a[0:3], 0
    ds_read_b128 v[120:123], v9 offset:40960
    s_add_u32 s61, s61, 98304
    v_mul_f32 v32, v32, v164
    v_mfma_f32_16x16x32_bf16 v[68:71], v[104:107], a[4:7], 0
    ds_read_b128 v[124:127], v9 offset:41984
    v_mul_f32 v33, v33, v164
    v_mul_f32 v34, v34, v164
    v_mfma_f32_16x16x32_bf16 v[44:47], v[108:111], a[0:3], 0
    ds_read_b128 v[128:131], v9 offset:43008
    v_mul_f32 v35, v35, v164
    v_fmac_f32 v32, v144, v165
    v_mfma_f32_16x16x32_bf16 v[72:75], v[108:111], a[4:7], 0
    ds_read_b128 v[132:135], v9 offset:44032
    v_fmac_f32 v33, v145, v165
    v_fmac_f32 v34, v146, v165
    v_mfma_f32_16x16x32_bf16 v[40:43], v[112:115], a[8:11], v[40:43]
    v_fmac_f32 v35, v147, v165
    v_cvt_pk_bf16_f32 v92, v32, v33
    v_cvt_pk_bf16_f32 v93, v34, v35
    v_mfma_f32_16x16x32_bf16 v[68:71], v[112:115], a[12:15], v[68:71]
    v_pk_max_i16 v92, v92, v11
    v_pk_max_i16 v93, v93, v11
    v_mul_f32 v36, v36, v164
    v_mfma_f32_16x16x32_bf16 v[44:47], v[116:119], a[8:11], v[44:47]
    buffer_load_dwordx4 v4, s[44:47], s28 offen offset:2048 sc1 lds
    v_mul_f32 v37, v37, v164
    v_mfma_f32_16x16x32_bf16 v[72:75], v[116:119], a[12:15], v[72:75]
    buffer_load_dwordx4 v4, s[44:47], s28 offen offset:3072 sc1 lds
    v_mul_f32 v38, v38, v164
    s_waitcnt lgkmcnt(0)
    v_mfma_f32_16x16x32_bf16 v[40:43], v[120:123], a[16:19], v[40:43]
    ds_read_b128 v[104:107], v9 offset:45056
    v_mul_f32 v39, v39, v164
    v_fmac_f32 v36, v148, v165
    v_mfma_f32_16x16x32_bf16 v[68:71], v[120:123], a[20:23], v[68:71]
    ds_read_b128 v[108:111], v9 offset:46080
    v_fmac_f32 v37, v149, v165
    v_fmac_f32 v38, v150, v165
    v_mfma_f32_16x16x32_bf16 v[44:47], v[124:127], a[16:19], v[44:47]
    ds_read_b128 v[112:115], v9 offset:47104
    v_fmac_f32 v39, v151, v165
    v_cvt_pk_bf16_f32 v94, v36, v37
    v_mfma_f32_16x16x32_bf16 v[72:75], v[124:127], a[20:23], v[72:75]
    ds_read_b128 v[116:119], v9 offset:48128
    v_cvt_pk_bf16_f32 v95, v38, v39
    v_pk_max_i16 v94, v94, v11
    v_mfma_f32_16x16x32_bf16 v[40:43], v[128:131], a[24:27], v[40:43]
    v_pk_max_i16 v95, v95, v11
    buffer_store_dwordx4 v[92:95], v4, s[44:47], s61 offen offset:0 sc1
    v_mul_f32 v60, v60, v168
    v_mfma_f32_16x16x32_bf16 v[68:71], v[128:131], a[28:31], v[68:71]
    v_mul_f32 v61, v61, v168
    v_mul_f32 v62, v62, v168
    v_mul_f32 v63, v63, v168
    v_mfma_f32_16x16x32_bf16 v[44:47], v[132:135], a[24:27], v[44:47]
    s_mul_i32 s75, s60, 5120
    s_add_u32 m0, s75, 45056
    s_nop 0
    buffer_load_dwordx4 v5, s[44:47], s28 offen offset:0 sc1 lds
    v_fmac_f32 v60, v144, v169
    v_mfma_f32_16x16x32_bf16 v[72:75], v[132:135], a[28:31], v[72:75]
    v_fmac_f32 v61, v145, v169
    v_fmac_f32 v62, v146, v169
    v_fmac_f32 v63, v147, v169
    s_waitcnt lgkmcnt(0)
    v_mfma_f32_16x16x32_bf16 v[40:43], v[104:107], a[32:35], v[40:43]
    ds_read_b128 v[120:123], v9 offset:49152
    v_cvt_pk_bf16_f32 v96, v60, v61
    v_cvt_pk_bf16_f32 v97, v62, v63
    v_mfma_f32_16x16x32_bf16 v[68:71], v[104:107], a[36:39], v[68:71]
    ds_read_b128 v[124:127], v9 offset:50176
    v_pk_max_i16 v96, v96, v11
    v_pk_max_i16 v97, v97, v11
    v_mfma_f32_16x16x32_bf16 v[44:47], v[108:111], a[32:35], v[44:47]
    ds_read_b128 v[128:131], v9 offset:51200
    v_mul_f32 v64, v64, v168
    v_mul_f32 v65, v65, v168
    v_mfma_f32_16x16x32_bf16 v[72:75], v[108:111], a[36:39], v[72:75]
    ds_read_b128 v[132:135], v9 offset:52224
    v_mul_f32 v66, v66, v168
    v_mul_f32 v67, v67, v168
    v_mfma_f32_16x16x32_bf16 v[40:43], v[112:115], a[40:43], v[40:43]
    v_fmac_f32 v64, v148, v169
    v_fmac_f32 v65, v149, v169
    v_fmac_f32 v66, v150, v169
    v_mfma_f32_16x16x32_bf16 v[68:71], v[112:115], a[44:47], v[68:71]
    v_fmac_f32 v67, v151, v169
    v_cvt_pk_bf16_f32 v98, v64, v65
    v_cvt_pk_bf16_f32 v99, v66, v67
    v_mfma_f32_16x16x32_bf16 v[44:47], v[116:119], a[40:43], v[44:47]
    v_pk_max_i16 v98, v98, v11
    v_pk_max_i16 v99, v99, v11
    buffer_store_dwordx4 v[96:99], v4, s[44:47], s61 offen offset:1024 sc1
    v_mfma_f32_16x16x32_bf16 v[72:75], v[116:119], a[44:47], v[72:75]
    s_waitcnt lgkmcnt(0)
    v_mfma_f32_16x16x32_bf16 v[40:43], v[120:123], a[48:51], v[40:43]
    ds_read_b128 v[104:107], v9 offset:53248
    v_mfma_f32_16x16x32_bf16 v[68:71], v[120:123], a[52:55], v[68:71]
    ds_read_b128 v[108:111], v9 offset:54272
    v_mfma_f32_16x16x32_bf16 v[44:47], v[124:127], a[48:51], v[44:47]
    ds_read_b128 v[112:115], v9 offset:55296
    v_mfma_f32_16x16x32_bf16 v[72:75], v[124:127], a[52:55], v[72:75]
    ds_read_b128 v[116:119], v9 offset:56320
    v_mfma_f32_16x16x32_bf16 v[40:43], v[128:131], a[56:59], v[40:43]
    v_mfma_f32_16x16x32_bf16 v[68:71], v[128:131], a[60:63], v[68:71]
    v_mfma_f32_16x16x32_bf16 v[44:47], v[132:135], a[56:59], v[44:47]
    v_mfma_f32_16x16x32_bf16 v[72:75], v[132:135], a[60:63], v[72:75]
    s_waitcnt lgkmcnt(0)
    v_mfma_f32_16x16x32_bf16 v[40:43], v[104:107], a[64:67], v[40:43]
    ds_read_b128 v[120:123], v9 offset:57344
    v_mfma_f32_16x16x32_bf16 v[68:71], v[104:107], a[68:71], v[68:71]
    ds_read_b128 v[124:127], v9 offset:58368
    v_mfma_f32_16x16x32_bf16 v[44:47], v[108:111], a[64:67], v[44:47]
    ds_read_b128 v[128:131], v9 offset:59392
    v_mfma_f32_16x16x32_bf16 v[72:75], v[108:111], a[68:71], v[72:75]
    ds_read_b128 v[132:135], v9 offset:60416
    v_mfma_f32_16x16x32_bf16 v[40:43], v[112:115], a[72:75], v[40:43]
    v_mfma_f32_16x16x32_bf16 v[68:71], v[112:115], a[76:79], v[68:71]
    v_mfma_f32_16x16x32_bf16 v[44:47], v[116:119], a[72:75], v[44:47]
    v_mfma_f32_16x16x32_bf16 v[72:75], v[116:119], a[76:79], v[72:75]
    s_waitcnt lgkmcnt(0)
    v_mfma_f32_16x16x32_bf16 v[40:43], v[120:123], a[80:83], v[40:43]
    ds_read_b128 v[104:107], v9 offset:61440
    v_mfma_f32_16x16x32_bf16 v[68:71], v[120:123], a[84:87], v[68:71]
    ds_read_b128 v[108:111], v9 offset:62464
    v_mfma_f32_16x16x32_bf16 v[44:47], v[124:127], a[80:83], v[44:47]
    ds_read_b128 v[112:115], v9 offset:63488
    v_mfma_f32_16x16x32_bf16 v[72:75], v[124:127], a[84:87], v[72:75]
    ds_read_b128 v[116:119], v9 offset:64512
    v_mfma_f32_16x16x32_bf16 v[40:43], v[128:131], a[88:91], v[40:43]
    v_mfma_f32_16x16x32_bf16 v[68:71], v[128:131], a[92:95], v[68:71]
    v_mfma_f32_16x16x32_bf16 v[44:47], v[132:135], a[88:91], v[44:47]
    v_mfma_f32_16x16x32_bf16 v[72:75], v[132:135], a[92:95], v[72:75]
    s_waitcnt lgkmcnt(0)
    v_mfma_f32_16x16x32_bf16 v[40:43], v[104:107], a[96:99], v[40:43]
    ds_read_b128 v[120:123], v22 offset:0
    v_mfma_f32_16x16x32_bf16 v[68:71], v[104:107], a[100:103], v[68:71]
    ds_read_b128 v[124:127], v22 offset:1024
    v_mfma_f32_16x16x32_bf16 v[44:47], v[108:111], a[96:99], v[44:47]
    ds_read_b128 v[128:131], v22 offset:2048
    v_mfma_f32_16x16x32_bf16 v[72:75], v[108:111], a[100:103], v[72:75]
    ds_read_b128 v[132:135], v22 offset:3072
    v_mfma_f32_16x16x32_bf16 v[40:43], v[112:115], a[104:107], v[40:43]
    v_mfma_f32_16x16x32_bf16 v[68:71], v[112:115], a[108:111], v[68:71]
    v_mfma_f32_16x16x32_bf16 v[44:47], v[116:119], a[104:107], v[44:47]
    v_mfma_f32_16x16x32_bf16 v[72:75], v[116:119], a[108:111], v[72:75]
    s_mov_b64 exec, 1
    buffer_load_dword v8, v6, s[44:47], s64 offen offset:128 sc1
    s_mov_b64 exec, -1
    s_waitcnt lgkmcnt(0)
    v_mfma_f32_16x16x32_bf16 v[40:43], v[120:123], a[112:115], v[40:43]
    ds_read_b128 v[104:107], v22 offset:4096
    v_mfma_f32_16x16x32_bf16 v[68:71], v[120:123], a[116:119], v[68:71]
    ds_read_b128 v[108:111], v22 offset:5120
    v_mfma_f32_16x16x32_bf16 v[44:47], v[124:127], a[112:115], v[44:47]
    ds_read_b128 v[112:115], v22 offset:6144
    v_mfma_f32_16x16x32_bf16 v[72:75], v[124:127], a[116:119], v[72:75]
    ds_read_b128 v[116:119], v22 offset:7168
    v_mfma_f32_16x16x32_bf16 v[40:43], v[128:131], a[120:123], v[40:43]
    v_mfma_f32_16x16x32_bf16 v[68:71], v[128:131], a[124:127], v[68:71]
    v_mfma_f32_16x16x32_bf16 v[44:47], v[132:135], a[120:123], v[44:47]
    v_mfma_f32_16x16x32_bf16 v[72:75], v[132:135], a[124:127], v[72:75]
    s_waitcnt lgkmcnt(0)
    v_mfma_f32_16x16x32_bf16 v[40:43], v[104:107], a[128:131], v[40:43]
    ds_read_b128 v[120:123], v22 offset:8192
    v_mfma_f32_16x16x32_bf16 v[68:71], v[104:107], a[132:135], v[68:71]
    ds_read_b128 v[124:127], v22 offset:9216
    v_mfma_f32_16x16x32_bf16 v[44:47], v[108:111], a[128:131], v[44:47]
    ds_read_b128 v[128:131], v22 offset:10240
    v_mfma_f32_16x16x32_bf16 v[72:75], v[108:111], a[132:135], v[72:75]
    ds_read_b128 v[132:135], v22 offset:11264
    v_mfma_f32_16x16x32_bf16 v[40:43], v[112:115], a[136:139], v[40:43]
    v_mfma_f32_16x16x32_bf16 v[68:71], v[112:115], a[140:143], v[68:71]
    v_mfma_f32_16x16x32_bf16 v[44:47], v[116:119], a[136:139], v[44:47]
    v_mfma_f32_16x16x32_bf16 v[72:75], v[116:119], a[140:143], v[72:75]
    s_cmp_lg_u32 s60, 0
    s_cbranch_scc1 Lok_1018
    s_waitcnt vmcnt(0)
    s_mov_b32 s75, 0
    s_mov_b64 exec, 1
Lp_1017:
    v_cmp_gt_u32 vcc, 16, v8
    s_add_u32 s75, s75, 1
    s_cmp_eq_u64 vcc, 0
    s_cbranch_scc1 Lok_1018
    s_cmp_ge_u32 s75, 200000
    s_cbranch_scc1 Lok_1018
    s_sleep 1
    buffer_load_dword v8, v6, s[44:47], s64 offen offset:128 sc1
    s_waitcnt vmcnt(0)
    s_branch Lp_1017
Lok_1018:
    s_mov_b64 exec, -1
    s_barrier
    s_waitcnt vmcnt(1)
    s_barrier
    s_mov_b64 exec, 1
    buffer_atomic_add v10, v11, s[44:47], s5 offen offset:256 sc1
    s_mov_b64 exec, -1
    s_waitcnt lgkmcnt(0)
    v_mfma_f32_16x16x32_bf16 v[40:43], v[120:123], a[144:147], v[40:43]
    v_mfma_f32_16x16x32_bf16 v[68:71], v[120:123], a[148:151], v[68:71]
    v_mfma_f32_16x16x32_bf16 v[44:47], v[124:127], a[144:147], v[44:47]
    v_mfma_f32_16x16x32_bf16 v[72:75], v[124:127], a[148:151], v[72:75]
    v_mfma_f32_16x16x32_bf16 v[40:43], v[128:131], a[152:155], v[40:43]
    v_mfma_f32_16x16x32_bf16 v[68:71], v[128:131], a[156:159], v[68:71]
    v_mfma_f32_16x16x32_bf16 v[44:47], v[132:135], a[152:155], v[44:47]
    s_add_u32 s72, s63, 0
    buffer_load_dwordx4 a[0:3], v172, s[44:47], s72 offen sc1
    v_mfma_f32_16x16x32_bf16 v[72:75], v[132:135], a[156:159], v[72:75]
    buffer_load_dwordx4 a[4:7], v173, s[44:47], s72 offen sc1
    s_add_u32 s61, s61, 65536
    s_nop 0
    v_mul_f32 v40, v40, v164
    v_mul_f32 v41, v41, v164
    buffer_load_dwordx4 a[8:11], v174, s[44:47], s72 offen sc1
    v_mul_f32 v42, v42, v164
    v_mul_f32 v43, v43, v164
    v_fmac_f32 v40, v152, v165
    buffer_load_dwordx4 a[12:15], v175, s[44:47], s72 offen sc1
    v_fmac_f32 v41, v153, v165
    v_fmac_f32 v42, v154, v165
    v_fmac_f32 v43, v155, v165
    s_add_u32 s72, s63, 16384
    buffer_load_dwordx4 a[16:19], v172, s[44:47], s72 offen sc1
    v_cvt_pk_bf16_f32 v80, v40, v41
    v_cvt_pk_bf16_f32 v81, v42, v43
    v_pk_max_i16 v80, v80, v11
    buffer_load_dwordx4 a[20:23], v173, s[44:47], s72 offen sc1
    v_pk_max_i16 v81, v81, v11
    v_mul_f32 v44, v44, v164
    v_mul_f32 v45, v45, v164
    buffer_load_dwordx4 a[24:27], v174, s[44:47], s72 offen sc1
    v_mul_f32 v46, v46, v164
    v_mul_f32 v47, v47, v164
    v_fmac_f32 v44, v156, v165
    buffer_load_dwordx4 a[28:31], v175, s[44:47], s72 offen sc1
    v_fmac_f32 v45, v157, v165
    v_fmac_f32 v46, v158, v165
    v_fmac_f32 v47, v159, v165
    s_add_u32 s72, s63, 32768
    buffer_load_dwordx4 a[32:35], v172, s[44:47], s72 offen sc1
    v_cvt_pk_bf16_f32 v82, v44, v45
    v_cvt_pk_bf16_f32 v83, v46, v47
    v_pk_max_i16 v82, v82, v11
    buffer_load_dwordx4 a[36:39], v173, s[44:47], s72 offen sc1
    s_mul_i32 s65, s60, 5120
    v_add_u32 v7, s65, v4
    v_add_u32 v9, 143360, v7
    s_waitcnt vmcnt(6)
    v_pk_max_i16 v83, v83, v11
    buffer_store_dwordx4 v[80:83], v4, s[44:47], s61 offen offset:0 sc1
    v_mul_f32 v68, v68, v168
    v_mfma_f32_16x16x32_bf16 v[24:27], v[176:179], a[0:3], 0
    v_mul_f32 v69, v69, v168
    v_mul_f32 v70, v70, v168
    v_mul_f32 v71, v71, v168
    v_mfma_f32_16x16x32_bf16 v[28:31], v[180:183], a[0:3], 0
    v_fmac_f32 v68, v152, v169
    v_fmac_f32 v69, v153, v169
    v_fmac_f32 v70, v154, v169
    v_mfma_f32_16x16x32_bf16 v[32:35], v[184:187], a[0:3], 0
    v_fmac_f32 v71, v155, v169
    v_cvt_pk_bf16_f32 v84, v68, v69
    v_cvt_pk_bf16_f32 v85, v70, v71
    v_mfma_f32_16x16x32_bf16 v[36:39], v[188:191], a[0:3], 0
    buffer_load_dwordx4 a[40:43], v174, s[44:47], s72 offen sc1
    v_pk_max_i16 v84, v84, v11
    v_pk_max_i16 v85, v85, v11
    v_mul_f32 v72, v72, v168
    v_mfma_f32_16x16x32_bf16 v[48:51], v[180:183], a[4:7], 0
    v_mul_f32 v73, v73, v168
    v_mul_f32 v74, v74, v168
    v_mul_f32 v75, v75, v168
    v_mfma_f32_16x16x32_bf16 v[52:55], v[184:187], a[4:7], 0
    v_fmac_f32 v72, v156, v169
    v_fmac_f32 v73, v157, v169
    v_fmac_f32 v74, v158, v169
    v_mfma_f32_16x16x32_bf16 v[56:59], v[188:191], a[4:7], 0
    v_fmac_f32 v75, v159, v169
    v_cvt_pk_bf16_f32 v86, v72, v73
    v_cvt_pk_bf16_f32 v87, v74, v75
    v_mfma_f32_16x16x32_bf16 v[60:63], v[192:195], a[4:7], 0
    buffer_load_dwordx4 a[44:47], v175, s[44:47], s72 offen sc1
    v_pk_max_i16 v86, v86, v11
    v_pk_max_i16 v87, v87, v11
    buffer_store_dwordx4 v[84:87], v4, s[44:47], s61 offen offset:1024 sc1
    v_mfma_f32_16x16x32_bf16 v[64:67], v[176:179], a[8:11], 0
    v_mfma_f32_16x16x32_bf16 v[76:79], v[188:191], a[8:11], 0
    v_mfma_f32_16x16x32_bf16 v[88:91], v[180:183], a[12:15], 0
    v_mfma_f32_16x16x32_bf16 v[92:95], v[184:187], a[12:15], 0
    s_add_u32 s72, s63, 49152
    buffer_load_dwordx4 a[48:51], v172, s[44:47], s72 offen sc1
    v_mfma_f32_16x16x32_bf16 v[96:99], v[188:191], a[12:15], 0
    v_mfma_f32_16x16x32_bf16 v[100:103], v[192:195], a[12:15], 0
    v_mfma_f32_16x16x32_bf16 v[40:43], v[192:195], a[0:3], 0
    v_mfma_f32_16x16x32_bf16 v[44:47], v[176:179], a[4:7], 0
    buffer_load_dwordx4 a[52:55], v173, s[44:47], s72 offen sc1
    v_mfma_f32_16x16x32_bf16 v[68:71], v[180:183], a[8:11], 0
    v_mfma_f32_16x16x32_bf16 v[72:75], v[184:187], a[8:11], 0
    v_mfma_f32_16x16x32_bf16 v[80:83], v[192:195], a[8:11], 0
    v_mfma_f32_16x16x32_bf16 v[84:87], v[176:179], a[12:15], 0
    buffer_load_dwordx4 a[56:59], v174, s[44:47], s72 offen sc1
    s_mov_b64 exec, 1
    buffer_load_dword v8, v6, s[44:47], s64 offen offset:256 sc1
    s_mov_b64 exec, -1
    s_waitcnt vmcnt(10)
    v_mfma_f32_16x16x32_bf16 v[24:27], v[196:199], a[16:19], v[24:27]
    v_mfma_f32_16x16x32_bf16 v[28:31], v[200:203], a[16:19], v[28:31]
    v_mfma_f32_16x16x32_bf16 v[32:35], v[204:207], a[16:19], v[32:35]
    v_mfma_f32_16x16x32_bf16 v[36:39], v[208:211], a[16:19], v[36:39]
    buffer_load_dwordx4 a[60:63], v175, s[44:47], s72 offen sc1
    v_mfma_f32_16x16x32_bf16 v[40:43], v[212:215], a[16:19], v[40:43]
    v_mfma_f32_16x16x32_bf16 v[44:47], v[196:199], a[20:23], v[44:47]
    v_mfma_f32_16x16x32_bf16 v[48:51], v[200:203], a[20:23], v[48:51]
    v_mfma_f32_16x16x32_bf16 v[52:55], v[204:207], a[20:23], v[52:55]
    s_add_u32 s72, s63, 65536
    v_sub_u32 v171, v172, v23
    buffer_load_dwordx2 a[64:65], v171, s[44:47], s72 offen sc1
    buffer_load_dwordx2 a[66:67], v171, s[44:47], s72 offen offset:512 sc1
    v_mfma_f32_16x16x32_bf16 v[56:59], v[208:211], a[20:23], v[56:59]
    v_mfma_f32_16x16x32_bf16 v[60:63], v[212:215], a[20:23], v[60:63]
    v_mfma_f32_16x16x32_bf16 v[64:67], v[196:199], a[24:27], v[64:67]
    v_mfma_f32_16x16x32_bf16 v[68:71], v[200:203], a[24:27], v[68:71]
    v_sub_u32 v171, v173, v23
    buffer_load_dwordx2 a[68:69], v171, s[44:47], s72 offen sc1
    buffer_load_dwordx2 a[70:71], v171, s[44:47], s72 offen offset:512 sc1
    v_mfma_f32_16x16x32_bf16 v[72:75], v[204:207], a[24:27], v[72:75]
    v_mfma_f32_16x16x32_bf16 v[76:79], v[208:211], a[24:27], v[76:79]
    v_mfma_f32_16x16x32_bf16 v[80:83], v[212:215], a[24:27], v[80:83]
    v_mfma_f32_16x16x32_bf16 v[84:87], v[196:199], a[28:31], v[84:87]
    v_sub_u32 v171, v174, v23
    buffer_load_dwordx2 a[72:73], v171, s[44:47], s72 offen sc1
    buffer_load_dwordx2 a[74:75], v171, s[44:47], s72 offen offset:512 sc1
    v_mfma_f32_16x16x32_bf16 v[88:91], v[200:203], a[28:31], v[88:91]
    v_mfma_f32_16x16x32_bf16 v[92:95], v[204:207], a[28:31], v[92:95]
    v_mfma_f32_16x16x32_bf16 v[96:99], v[208:211], a[28:31], v[96:99]
    v_mfma_f32_16x16x32_bf16 v[100:103], v[212:215], a[28:31], v[100:103]
    v_sub_u32 v171, v175, v23
    buffer_load_dwordx2 a[76:77], v171, s[44:47], s72 offen sc1
    buffer_load_dwordx2 a[78:79], v171, s[44:47], s72 offen offset:512 sc1
    s_waitcnt vmcnt(13)
    s_barrier
    s_mov_b64 exec, 1
    buffer_atomic_add v10, v11, s[44:47], s5 offen offset:384 sc1
    s_mov_b64 exec, -1
    v_mfma_f32_16x16x32_bf16 v[24:27], v[216:219], a[32:35], v[24:27]
    v_mfma_f32_16x16x32_bf16 v[28:31], v[220:223], a[32:35], v[28:31]
    v_mfma_f32_16x16x32_bf16 v[32:35], v[224:227], a[32:35], v[32:35]
    v_mfma_f32_16x16x32_bf16 v[36:39], v[228:231], a[32:35], v[36:39]
    s_add_u32 s72, s63, 81920
    s_cmp_ge_u32 s60, 2
    s_cselect_b32 s72, 0x7ff00000, s72
    v_sub_u32 v171, v172, v23
    buffer_load_dwordx2 a[80:81], v171, s[44:47], s72 offen sc1
    buffer_load_dwordx2 a[82:83], v171, s[44:47], s72 offen offset:512 sc1
    v_mfma_f32_16x16x32_bf16 v[40:43], v[232:235], a[32:35], v[40:43]
    v_mfma_f32_16x16x32_bf16 v[44:47], v[216:219], a[36:39], v[44:47]
    v_mfma_f32_16x16x32_bf16 v[48:51], v[220:223], a[36:39], v[48:51]
    v_mfma_f32_16x16x32_bf16 v[52:55], v[224:227], a[36:39], v[52:55]
    v_sub_u32 v171, v173, v23
    buffer_load_dwordx2 a[84:85], v171, s[44:47], s72 offen sc1
    buffer_load_dwordx2 a[86:87], v171, s[44:47], s72 offen offset:512 sc1
    v_mfma_f32_16x16x32_bf16 v[56:59], v[228:231], a[36:39], v[56:59]
    v_mfma_f32_16x16x32_bf16 v[60:63], v[232:235], a[36:39], v[60:63]
    v_mfma_f32_16x16x32_bf16 v[64:67], v[216:219], a[40:43], v[64:67]
    v_mfma_f32_16x16x32_bf16 v[68:71], v[220:223], a[40:43], v[68:71]
    v_sub_u32 v171, v174, v23
    buffer_load_dwordx2 a[88:89], v171, s[44:47], s72 offen sc1
    buffer_load_dwordx2 a[90:91], v171, s[44:47], s72 offen offset:512 sc1
    v_mfma_f32_16x16x32_bf16 v[72:75], v[224:227], a[40:43], v[72:75]
    v_mfma_f32_16x16x32_bf16 v[76:79], v[228:231], a[40:43], v[76:79]
    v_mfma_f32_16x16x32_bf16 v[80:83], v[232:235], a[40:43], v[80:83]
    v_mfma_f32_16x16x32_bf16 v[84:87], v[216:219], a[44:47], v[84:87]
    v_sub_u32 v171, v175, v23
    buffer_load_dwordx2 a[92:93], v171, s[44:47], s72 offen sc1
    buffer_load_dwordx2 a[94:95], v171, s[44:47], s72 offen offset:512 sc1
    v_mfma_f32_16x16x32_bf16 v[88:91], v[220:223], a[44:47], v[88:91]
    v_mfma_f32_16x16x32_bf16 v[92:95], v[224:227], a[44:47], v[92:95]
    v_mfma_f32_16x16x32_bf16 v[96:99], v[228:231], a[44:47], v[96:99]
    v_mfma_f32_16x16x32_bf16 v[100:103], v[232:235], a[44:47], v[100:103]
    s_cmp_lg_u32 s60, 0
    s_cbranch_scc1 Lok_1020
    s_waitcnt vmcnt(18)
    s_mov_b32 s75, 0
    s_mov_b64 exec, 1
Lp_1019:
    v_cmp_gt_u32 vcc, 16, v8
    s_add_u32 s75, s75, 1
    s_cmp_eq_u64 vcc, 0
    s_cbranch_scc1 Lok_1020
    s_cmp_ge_u32 s75, 200000
    s_cbranch_scc1 Lok_1020
    s_sleep 1
    buffer_load_dword v8, v6, s[44:47], s64 offen offset:256 sc1
    s_waitcnt vmcnt(0)
    s_branch Lp_1019
Lok_1020:
    s_mov_b64 exec, -1
    s_barrier
    s_waitcnt vmcnt(17)
    v_mfma_f32_16x16x32_bf16 v[24:27], v[236:239], a[48:51], v[24:27]
    v_mfma_f32_16x16x32_bf16 v[28:31], v[240:243], a[48:51], v[28:31]
    v_mfma_f32_16x16x32_bf16 v[32:35], v[244:247], a[48:51], v[32:35]
    v_mfma_f32_16x16x32_bf16 v[36:39], v[248:251], a[48:51], v[36:39]
    s_add_u32 s72, s63, 98304
    buffer_load_dwordx4 a[96:99], v172, s[44:47], s72 offen sc1
    v_mfma_f32_16x16x32_bf16 v[40:43], v[252:255], a[48:51], v[40:43]
    v_mfma_f32_16x16x32_bf16 v[44:47], v[236:239], a[52:55], v[44:47]
    v_mfma_f32_16x16x32_bf16 v[48:51], v[240:243], a[52:55], v[48:51]
    v_mfma_f32_16x16x32_bf16 v[52:55], v[244:247], a[52:55], v[52:55]
    buffer_load_dwordx4 a[100:103], v173, s[44:47], s72 offen sc1
    v_mfma_f32_16x16x32_bf16 v[56:59], v[248:251], a[52:55], v[56:59]
    v_mfma_f32_16x16x32_bf16 v[60:63], v[252:255], a[52:55], v[60:63]
    v_mfma_f32_16x16x32_bf16 v[64:67], v[236:239], a[56:59], v[64:67]
    v_mfma_f32_16x16x32_bf16 v[68:71], v[240:243], a[56:59], v[68:71]
    buffer_load_dwordx4 a[104:107], v174, s[44:47], s72 offen sc1
    v_mfma_f32_16x16x32_bf16 v[72:75], v[244:247], a[56:59], v[72:75]
    v_mfma_f32_16x16x32_bf16 v[76:79], v[248:251], a[56:59], v[76:79]
    v_mfma_f32_16x16x32_bf16 v[80:83], v[252:255], a[56:59], v[80:83]
    v_mfma_f32_16x16x32_bf16 v[84:87], v[236:239], a[60:63], v[84:87]
    buffer_load_dwordx4 a[108:111], v175, s[44:47], s72 offen sc1
    v_mfma_f32_16x16x32_bf16 v[88:91], v[240:243], a[60:63], v[88:91]
    v_mfma_f32_16x16x32_bf16 v[92:95], v[244:247], a[60:63], v[92:95]
    v_mfma_f32_16x16x32_bf16 v[96:99], v[248:251], a[60:63], v[96:99]
    v_mfma_f32_16x16x32_bf16 v[100:103], v[252:255], a[60:63], v[100:103]
    s_add_u32 s72, s63, 114688
    buffer_load_dwordx4 a[112:115], v172, s[44:47], s72 offen sc1
    s_waitcnt vmcnt(14)
    v_mfma_f32_16x16x32_bf16 v[24:27], a[160:163], a[64:67], v[24:27]
    v_mfma_f32_16x16x32_bf16 v[28:31], a[164:167], a[64:67], v[28:31]
    v_mfma_f32_16x16x32_bf16 v[32:35], a[168:171], a[64:67], v[32:35]
    v_mfma_f32_16x16x32_bf16 v[36:39], a[172:175], a[64:67], v[36:39]
    buffer_load_dwordx4 a[116:119], v173, s[44:47], s72 offen sc1
    v_mfma_f32_16x16x32_bf16 v[40:43], a[176:179], a[64:67], v[40:43]
    v_mfma_f32_16x16x32_bf16 v[44:47], a[160:163], a[68:71], v[44:47]
    v_mfma_f32_16x16x32_bf16 v[48:51], a[164:167], a[68:71], v[48:51]
    v_mfma_f32_16x16x32_bf16 v[52:55], a[168:171], a[68:71], v[52:55]
    buffer_load_dwordx4 a[120:123], v174, s[44:47], s72 offen sc1
    v_mfma_f32_16x16x32_bf16 v[56:59], a[172:175], a[68:71], v[56:59]
    v_mfma_f32_16x16x32_bf16 v[60:63], a[176:179], a[68:71], v[60:63]
    v_mfma_f32_16x16x32_bf16 v[64:67], a[160:163], a[72:75], v[64:67]
    v_mfma_f32_16x16x32_bf16 v[68:71], a[164:167], a[72:75], v[68:71]
    buffer_load_dwordx4 a[124:127], v175, s[44:47], s72 offen sc1
    v_mfma_f32_16x16x32_bf16 v[72:75], a[168:171], a[72:75], v[72:75]
    v_mfma_f32_16x16x32_bf16 v[76:79], a[172:175], a[72:75], v[76:79]
    v_mfma_f32_16x16x32_bf16 v[80:83], a[176:179], a[72:75], v[80:83]
    v_mfma_f32_16x16x32_bf16 v[84:87], a[160:163], a[76:79], v[84:87]
    s_add_u32 s72, s63, 131072
    buffer_load_dwordx4 a[128:131], v172, s[44:47], s72 offen sc1
    v_mfma_f32_16x16x32_bf16 v[88:91], a[164:167], a[76:79], v[88:91]
    v_mfma_f32_16x16x32_bf16 v[92:95], a[168:171], a[76:79], v[92:95]
    v_mfma_f32_16x16x32_bf16 v[96:99], a[172:175], a[76:79], v[96:99]
    v_mfma_f32_16x16x32_bf16 v[100:103], a[176:179], a[76:79], v[100:103]
    buffer_load_dwordx4 a[132:135], v173, s[44:47], s72 offen sc1
    s_mov_b64 exec, 1
    buffer_load_dword v8, v6, s[44:47], s64 offen offset:384 sc1
    s_mov_b64 exec, -1
    s_waitcnt vmcnt(11)
    v_mfma_f32_16x16x32_bf16 v[24:27], a[180:183], a[80:83], v[24:27]
    v_mfma_f32_16x16x32_bf16 v[28:31], a[184:187], a[80:83], v[28:31]
    v_mfma_f32_16x16x32_bf16 v[32:35], a[188:191], a[80:83], v[32:35]
    v_mfma_f32_16x16x32_bf16 v[36:39], a[192:195], a[80:83], v[36:39]
    buffer_load_dwordx4 a[136:139], v174, s[44:47], s72 offen sc1
    v_mfma_f32_16x16x32_bf16 v[40:43], a[196:199], a[80:83], v[40:43]
    v_mfma_f32_16x16x32_bf16 v[44:47], a[180:183], a[84:87], v[44:47]
    v_mfma_f32_16x16x32_bf16 v[48:51], a[184:187], a[84:87], v[48:51]
    v_mfma_f32_16x16x32_bf16 v[52:55], a[188:191], a[84:87], v[52:55]
    buffer_load_dwordx4 a[140:143], v175, s[44:47], s72 offen sc1
    v_mfma_f32_16x16x32_bf16 v[56:59], a[192:195], a[84:87], v[56:59]
    v_mfma_f32_16x16x32_bf16 v[60:63], a[196:199], a[84:87], v[60:63]
    v_mfma_f32_16x16x32_bf16 v[64:67], a[180:183], a[88:91], v[64:67]
    v_mfma_f32_16x16x32_bf16 v[68:71], a[184:187], a[88:91], v[68:71]
    s_add_u32 s72, s63, 147456
    buffer_load_dwordx4 a[144:147], v172, s[44:47], s72 offen sc1
    v_mfma_f32_16x16x32_bf16 v[72:75], a[188:191], a[88:91], v[72:75]
    v_mfma_f32_16x16x32_bf16 v[76:79], a[192:195], a[88:91], v[76:79]
    v_mfma_f32_16x16x32_bf16 v[80:83], a[196:199], a[88:91], v[80:83]
    v_mfma_f32_16x16x32_bf16 v[84:87], a[180:183], a[92:95], v[84:87]
    buffer_load_dwordx4 a[148:151], v173, s[44:47], s72 offen sc1
    v_mfma_f32_16x16x32_bf16 v[88:91], a[184:187], a[92:95], v[88:91]
    v_mfma_f32_16x16x32_bf16 v[92:95], a[188:191], a[92:95], v[92:95]
    v_mfma_f32_16x16x32_bf16 v[96:99], a[192:195], a[92:95], v[96:99]
    v_mfma_f32_16x16x32_bf16 v[100:103], a[196:199], a[92:95], v[100:103]
    buffer_load_dwordx4 a[152:155], v174, s[44:47], s72 offen sc1
    s_waitcnt vmcnt(12)
    v_mfma_f32_16x16x32_bf16 v[24:27], a[200:203], a[96:99], v[24:27]
    ds_read_b128 v[104:107], v9 offset:0
    v_mfma_f32_16x16x32_bf16 v[28:31], a[204:207], a[96:99], v[28:31]
    ds_read_b128 v[108:111], v9 offset:1024
    v_mfma_f32_16x16x32_bf16 v[32:35], a[208:211], a[96:99], v[32:35]
    ds_read_b128 v[112:115], v9 offset:2048
    v_mfma_f32_16x16x32_bf16 v[36:39], a[212:215], a[96:99], v[36:39]
    buffer_load_dwordx4 a[156:159], v175, s[44:47], s72 offen sc1
    v_mfma_f32_16x16x32_bf16 v[40:43], a[216:219], a[96:99], v[40:43]
    ds_read_b128 v[116:119], v9 offset:3072
    v_mfma_f32_16x16x32_bf16 v[44:47], a[200:203], a[100:103], v[44:47]
    ds_read_b128 v[120:123], v9 offset:4096
    v_mfma_f32_16x16x32_bf16 v[48:51], a[204:207], a[100:103], v[48:51]
    v_mfma_f32_16x16x32_bf16 v[52:55], a[208:211], a[100:103], v[52:55]
    s_add_u32 s28, s35, 245760
    buffer_load_dwordx4 v[176:179], v4, s[44:47], s28 offen offset:0 sc1
    v_mfma_f32_16x16x32_bf16 v[56:59], a[212:215], a[100:103], v[56:59]
    v_mfma_f32_16x16x32_bf16 v[60:63], a[216:219], a[100:103], v[60:63]
    v_mfma_f32_16x16x32_bf16 v[64:67], a[200:203], a[104:107], v[64:67]
    v_mfma_f32_16x16x32_bf16 v[68:71], a[204:207], a[104:107], v[68:71]
    buffer_load_dwordx4 v[180:183], v4, s[44:47], s28 offen offset:1024 sc1
    v_mfma_f32_16x16x32_bf16 v[72:75], a[208:211], a[104:107], v[72:75]
    v_mfma_f32_16x16x32_bf16 v[76:79], a[212:215], a[104:107], v[76:79]
    v_mfma_f32_16x16x32_bf16 v[80:83], a[216:219], a[104:107], v[80:83]
    v_mfma_f32_16x16x32_bf16 v[84:87], a[200:203], a[108:111], v[84:87]
    buffer_load_dwordx4 v[184:187], v4, s[44:47], s28 offen offset:2048 sc1
    v_mfma_f32_16x16x32_bf16 v[88:91], a[204:207], a[108:111], v[88:91]
    v_mfma_f32_16x16x32_bf16 v[92:95], a[208:211], a[108:111], v[92:95]
    v_mfma_f32_16x16x32_bf16 v[96:99], a[212:215], a[108:111], v[96:99]
    v_mfma_f32_16x16x32_bf16 v[100:103], a[216:219], a[108:111], v[100:103]
    buffer_load_dwordx4 v[188:191], v4, s[44:47], s28 offen offset:3072 sc1
    s_cmp_lg_u32 s60, 0
    s_cbranch_scc1 Lok_1022
    s_waitcnt vmcnt(10)
    s_mov_b32 s75, 0
    s_mov_b64 exec, 1
Lp_1021:
    v_cmp_gt_u32 vcc, 16, v8
    s_add_u32 s75, s75, 1
    s_cmp_eq_u64 vcc, 0
    s_cbranch_scc1 Lok_1022
    s_cmp_ge_u32 s75, 200000
    s_cbranch_scc1 Lok_1022
    s_sleep 1
    buffer_load_dword v8, v6, s[44:47], s64 offen offset:384 sc1
    s_waitcnt vmcnt(0)
    s_branch Lp_1021
Lok_1022:
    s_mov_b64 exec, -1
    s_barrier
    s_waitcnt vmcnt(13)
    v_mfma_f32_16x16x32_bf16 v[24:27], a[220:223], a[112:115], v[24:27]
    ds_read_b128 v[124:127], v7 offset:0
    v_mfma_f32_16x16x32_bf16 v[28:31], a[224:227], a[112:115], v[28:31]
    ds_read_b128 v[128:131], v7 offset:1024
    v_mfma_f32_16x16x32_bf16 v[32:35], a[228:231], a[112:115], v[32:35]
    ds_read_b128 v[132:135], v7 offset:2048
    v_mfma_f32_16x16x32_bf16 v[36:39], a[232:235], a[112:115], v[36:39]
    buffer_load_dwordx4 v[192:195], v5, s[44:47], s28 offen offset:0 sc1
    v_mfma_f32_16x16x32_bf16 v[40:43], a[236:239], a[112:115], v[40:43]
    ds_read_b128 v[136:139], v7 offset:3072
    v_mfma_f32_16x16x32_bf16 v[44:47], a[220:223], a[116:119], v[44:47]
    ds_read_b128 v[140:143], v7 offset:4096
    v_mfma_f32_16x16x32_bf16 v[48:51], a[224:227], a[116:119], v[48:51]
    v_mfma_f32_16x16x32_bf16 v[52:55], a[228:231], a[116:119], v[52:55]
    s_add_u32 s72, s63, 163840
    buffer_load_dwordx4 a[0:3], v172, s[44:47], s72 offen sc1
    v_mfma_f32_16x16x32_bf16 v[56:59], a[232:235], a[116:119], v[56:59]
    v_mfma_f32_16x16x32_bf16 v[60:63], a[236:239], a[116:119], v[60:63]
    v_mfma_f32_16x16x32_bf16 v[64:67], a[220:223], a[120:123], v[64:67]
    v_mfma_f32_16x16x32_bf16 v[68:71], a[224:227], a[120:123], v[68:71]
    buffer_load_dwordx4 a[4:7], v173, s[44:47], s72 offen sc1
    v_mfma_f32_16x16x32_bf16 v[72:75], a[228:231], a[120:123], v[72:75]
    v_mfma_f32_16x16x32_bf16 v[76:79], a[232:235], a[120:123], v[76:79]
    v_mfma_f32_16x16x32_bf16 v[80:83], a[236:239], a[120:123], v[80:83]
    v_mfma_f32_16x16x32_bf16 v[84:87], a[220:223], a[124:127], v[84:87]
    buffer_load_dwordx4 a[8:11], v174, s[44:47], s72 offen sc1
    v_mfma_f32_16x16x32_bf16 v[88:91], a[224:227], a[124:127], v[88:91]
    v_mfma_f32_16x16x32_bf16 v[92:95], a[228:231], a[124:127], v[92:95]
    v_mfma_f32_16x16x32_bf16 v[96:99], a[232:235], a[124:127], v[96:99]
    v_mfma_f32_16x16x32_bf16 v[100:103], a[236:239], a[124:127], v[100:103]
    buffer_load_dwordx4 a[12:15], v175, s[44:47], s72 offen sc1
    s_waitcnt vmcnt(13)
    s_waitcnt lgkmcnt(0)
    v_mfma_f32_16x16x32_bf16 v[24:27], v[104:107], a[128:131], v[24:27]
    ds_read_b128 v[144:147], v7 offset:20480
    v_mfma_f32_16x16x32_bf16 v[28:31], v[108:111], a[128:131], v[28:31]
    ds_read_b128 v[148:151], v7 offset:21504
    v_mfma_f32_16x16x32_bf16 v[32:35], v[112:115], a[128:131], v[32:35]
    ds_read_b128 v[152:155], v7 offset:22528
    v_mfma_f32_16x16x32_bf16 v[36:39], v[116:119], a[128:131], v[36:39]
    s_add_u32 s72, s63, 180224
    buffer_load_dwordx4 a[16:19], v172, s[44:47], s72 offen sc1
    v_mfma_f32_16x16x32_bf16 v[40:43], v[120:123], a[128:131], v[40:43]
    ds_read_b128 v[156:159], v7 offset:23552
    v_mfma_f32_16x16x32_bf16 v[44:47], v[104:107], a[132:135], v[44:47]
    ds_read_b128 v[160:163], v7 offset:24576
    v_mfma_f32_16x16x32_bf16 v[48:51], v[108:111], a[132:135], v[48:51]
    v_mfma_f32_16x16x32_bf16 v[52:55], v[112:115], a[132:135], v[52:55]
    buffer_load_dwordx4 a[20:23], v173, s[44:47], s72 offen sc1
    v_mfma_f32_16x16x32_bf16 v[56:59], v[116:119], a[132:135], v[56:59]
    v_mfma_f32_16x16x32_bf16 v[60:63], v[120:123], a[132:135], v[60:63]
    v_mfma_f32_16x16x32_bf16 v[64:67], v[104:107], a[136:139], v[64:67]
    v_mfma_f32_16x16x32_bf16 v[68:71], v[108:111], a[136:139], v[68:71]
    buffer_load_dwordx4 a[24:27], v174, s[44:47], s72 offen sc1
    v_mfma_f32_16x16x32_bf16 v[72:75], v[112:115], a[136:139], v[72:75]
    v_mfma_f32_16x16x32_bf16 v[76:79], v[116:119], a[136:139], v[76:79]
    v_mfma_f32_16x16x32_bf16 v[80:83], v[120:123], a[136:139], v[80:83]
    v_mfma_f32_16x16x32_bf16 v[84:87], v[104:107], a[140:143], v[84:87]
    buffer_load_dwordx4 a[28:31], v175, s[44:47], s72 offen sc1
    v_mfma_f32_16x16x32_bf16 v[88:91], v[108:111], a[140:143], v[88:91]
    v_mfma_f32_16x16x32_bf16 v[92:95], v[112:115], a[140:143], v[92:95]
    v_mfma_f32_16x16x32_bf16 v[96:99], v[116:119], a[140:143], v[96:99]
    v_mfma_f32_16x16x32_bf16 v[100:103], v[120:123], a[140:143], v[100:103]
    s_add_u32 s72, s63, 196608
    buffer_load_dwordx4 a[32:35], v172, s[44:47], s72 offen sc1
    s_waitcnt vmcnt(14)
    s_waitcnt lgkmcnt(0)
    v_mfma_f32_16x16x32_bf16 v[24:27], v[124:127], a[144:147], v[24:27]
    ds_read_b128 v[104:107], v7 offset:40960
    v_mfma_f32_16x16x32_bf16 v[28:31], v[128:131], a[144:147], v[28:31]
    ds_read_b128 v[108:111], v7 offset:41984
    v_mfma_f32_16x16x32_bf16 v[32:35], v[132:135], a[144:147], v[32:35]
    ds_read_b128 v[112:115], v7 offset:43008
    v_mfma_f32_16x16x32_bf16 v[36:39], v[136:139], a[144:147], v[36:39]
    buffer_load_dwordx4 a[36:39], v173, s[44:47], s72 offen sc1
    v_mfma_f32_16x16x32_bf16 v[40:43], v[140:143], a[144:147], v[40:43]
    ds_read_b128 v[116:119], v7 offset:44032
    v_mfma_f32_16x16x32_bf16 v[44:47], v[124:127], a[148:151], v[44:47]
    ds_read_b128 v[120:123], v7 offset:45056
    v_mfma_f32_16x16x32_bf16 v[48:51], v[128:131], a[148:151], v[48:51]
    v_mfma_f32_16x16x32_bf16 v[52:55], v[132:135], a[148:151], v[52:55]
    buffer_load_dwordx4 a[40:43], v174, s[44:47], s72 offen sc1
    v_mfma_f32_16x16x32_bf16 v[56:59], v[136:139], a[148:151], v[56:59]
    v_mfma_f32_16x16x32_bf16 v[60:63], v[140:143], a[148:151], v[60:63]
    v_mfma_f32_16x16x32_bf16 v[64:67], v[124:127], a[152:155], v[64:67]
    v_mfma_f32_16x16x32_bf16 v[68:71], v[128:131], a[152:155], v[68:71]
    buffer_load_dwordx4 a[44:47], v175, s[44:47], s72 offen sc1
    v_mfma_f32_16x16x32_bf16 v[72:75], v[132:135], a[152:155], v[72:75]
    v_mfma_f32_16x16x32_bf16 v[76:79], v[136:139], a[152:155], v[76:79]
    v_mfma_f32_16x16x32_bf16 v[80:83], v[140:143], a[152:155], v[80:83]
    v_mfma_f32_16x16x32_bf16 v[84:87], v[124:127], a[156:159], v[84:87]
    s_add_u32 s72, s63, 212992
    buffer_load_dwordx4 a[48:51], v172, s[44:47], s72 offen sc1
    v_mfma_f32_16x16x32_bf16 v[88:91], v[128:131], a[156:159], v[88:91]
    v_mfma_f32_16x16x32_bf16 v[92:95], v[132:135], a[156:159], v[92:95]
    v_mfma_f32_16x16x32_bf16 v[96:99], v[136:139], a[156:159], v[96:99]
    v_mfma_f32_16x16x32_bf16 v[100:103], v[140:143], a[156:159], v[100:103]
    buffer_load_dwordx4 a[52:55], v173, s[44:47], s72 offen sc1
    s_waitcnt vmcnt(10)
    s_waitcnt lgkmcnt(0)
    v_mfma_f32_16x16x32_bf16 v[24:27], v[144:147], a[0:3], v[24:27]
    v_mfma_f32_16x16x32_bf16 v[28:31], v[148:151], a[0:3], v[28:31]
    v_mfma_f32_16x16x32_bf16 v[32:35], v[152:155], a[0:3], v[32:35]
    v_mfma_f32_16x16x32_bf16 v[36:39], v[156:159], a[0:3], v[36:39]
    buffer_load_dwordx4 a[56:59], v174, s[44:47], s72 offen sc1
    v_mfma_f32_16x16x32_bf16 v[40:43], v[160:163], a[0:3], v[40:43]
    v_mfma_f32_16x16x32_bf16 v[44:47], v[144:147], a[4:7], v[44:47]
    v_mfma_f32_16x16x32_bf16 v[48:51], v[148:151], a[4:7], v[48:51]
    v_mfma_f32_16x16x32_bf16 v[52:55], v[152:155], a[4:7], v[52:55]
    buffer_load_dwordx4 a[60:63], v175, s[44:47], s72 offen sc1
    v_mfma_f32_16x16x32_bf16 v[56:59], v[156:159], a[4:7], v[56:59]
    v_mfma_f32_16x16x32_bf16 v[60:63], v[160:163], a[4:7], v[60:63]
    v_mfma_f32_16x16x32_bf16 v[64:67], v[144:147], a[8:11], v[64:67]
    v_mfma_f32_16x16x32_bf16 v[68:71], v[148:151], a[8:11], v[68:71]
    s_add_u32 s28, s35, 266240
    buffer_load_dwordx4 v[196:199], v4, s[44:47], s28 offen offset:0 sc1
    v_mfma_f32_16x16x32_bf16 v[72:75], v[152:155], a[8:11], v[72:75]
    v_mfma_f32_16x16x32_bf16 v[76:79], v[156:159], a[8:11], v[76:79]
    v_mfma_f32_16x16x32_bf16 v[80:83], v[160:163], a[8:11], v[80:83]
    v_mfma_f32_16x16x32_bf16 v[84:87], v[144:147], a[12:15], v[84:87]
    buffer_load_dwordx4 v[200:203], v4, s[44:47], s28 offen offset:1024 sc1
    v_mfma_f32_16x16x32_bf16 v[88:91], v[148:151], a[12:15], v[88:91]
    v_mfma_f32_16x16x32_bf16 v[92:95], v[152:155], a[12:15], v[92:95]
    v_mfma_f32_16x16x32_bf16 v[96:99], v[156:159], a[12:15], v[96:99]
    v_mfma_f32_16x16x32_bf16 v[100:103], v[160:163], a[12:15], v[100:103]
    buffer_load_dwordx4 v[204:207], v4, s[44:47], s28 offen offset:2048 sc1
    s_waitcnt vmcnt(11)
    s_waitcnt lgkmcnt(0)
    v_mfma_f32_16x16x32_bf16 v[24:27], v[104:107], a[16:19], v[24:27]
    v_mfma_f32_16x16x32_bf16 v[28:31], v[108:111], a[16:19], v[28:31]
    v_mfma_f32_16x16x32_bf16 v[32:35], v[112:115], a[16:19], v[32:35]
    v_mfma_f32_16x16x32_bf16 v[36:39], v[116:119], a[16:19], v[36:39]
    buffer_load_dwordx4 v[208:211], v4, s[44:47], s28 offen offset:3072 sc1
    v_mfma_f32_16x16x32_bf16 v[40:43], v[120:123], a[16:19], v[40:43]
    v_mfma_f32_16x16x32_bf16 v[44:47], v[104:107], a[20:23], v[44:47]
    v_mfma_f32_16x16x32_bf16 v[48:51], v[108:111], a[20:23], v[48:51]
    v_mfma_f32_16x16x32_bf16 v[52:55], v[112:115], a[20:23], v[52:55]
    buffer_load_dwordx4 v[212:215], v5, s[44:47], s28 offen offset:0 sc1
    v_mfma_f32_16x16x32_bf16 v[56:59], v[116:119], a[20:23], v[56:59]
    v_mfma_f32_16x16x32_bf16 v[60:63], v[120:123], a[20:23], v[60:63]
    v_mfma_f32_16x16x32_bf16 v[64:67], v[104:107], a[24:27], v[64:67]
    v_mfma_f32_16x16x32_bf16 v[68:71], v[108:111], a[24:27], v[68:71]
    v_mfma_f32_16x16x32_bf16 v[72:75], v[112:115], a[24:27], v[72:75]
    v_mfma_f32_16x16x32_bf16 v[76:79], v[116:119], a[24:27], v[76:79]
    v_mfma_f32_16x16x32_bf16 v[80:83], v[120:123], a[24:27], v[80:83]
    v_mfma_f32_16x16x32_bf16 v[84:87], v[104:107], a[28:31], v[84:87]
    v_mfma_f32_16x16x32_bf16 v[88:91], v[108:111], a[28:31], v[88:91]
    v_mfma_f32_16x16x32_bf16 v[92:95], v[112:115], a[28:31], v[92:95]
    v_mfma_f32_16x16x32_bf16 v[96:99], v[116:119], a[28:31], v[96:99]
    v_mfma_f32_16x16x32_bf16 v[100:103], v[120:123], a[28:31], v[100:103]
    s_waitcnt vmcnt(9)
    v_mfma_f32_16x16x32_bf16 v[24:27], v[176:179], a[32:35], v[24:27]
    s_add_u32 s65, s60, 1
    v_mfma_f32_16x16x32_bf16 v[28:31], v[180:183], a[32:35], v[28:31]
    s_and_b32 s65, s65, 3
    v_mfma_f32_16x16x32_bf16 v[32:35], v[184:187], a[32:35], v[32:35]
    s_mul_i32 s65, s65, 15360
    v_mfma_f32_16x16x32_bf16 v[36:39], v[188:191], a[32:35], v[36:39]
    s_add_u32 s65, s65, 61440
    v_mfma_f32_16x16x32_bf16 v[40:43], v[192:195], a[32:35], v[40:43]
    v_add_u32 v164, s65, v4
    v_mfma_f32_16x16x32_bf16 v[44:47], v[176:179], a[36:39], v[44:47]
    s_add_u32 s65, s60, 2
    v_mfma_f32_16x16x32_bf16 v[48:51], v[180:183], a[36:39], v[48:51]
    s_and_b32 s65, s65, 3
    v_mfma_f32_16x16x32_bf16 v[52:55], v[184:187], a[36:39], v[52:55]
    s_mul_i32 s65, s65, 15360
    v_mfma_f32_16x16x32_bf16 v[56:59], v[188:191], a[36:39], v[56:59]
    s_add_u32 s65, s65, 66560
    v_mfma_f32_16x16x32_bf16 v[60:63], v[192:195], a[36:39], v[60:63]
    v_add_u32 v165, s65, v4
    v_mfma_f32_16x16x32_bf16 v[64:67], v[176:179], a[40:43], v[64:67]
    s_add_u32 s65, s60, 3
    v_mfma_f32_16x16x32_bf16 v[68:71], v[180:183], a[40:43], v[68:71]
    s_and_b32 s65, s65, 3
    v_mfma_f32_16x16x32_bf16 v[72:75], v[184:187], a[40:43], v[72:75]
    s_mul_i32 s65, s65, 15360
    v_mfma_f32_16x16x32_bf16 v[76:79], v[188:191], a[40:43], v[76:79]
    s_add_u32 s65, s65, 71680
    v_mfma_f32_16x16x32_bf16 v[80:83], v[192:195], a[40:43], v[80:83]
    v_add_u32 v166, s65, v4
    v_mfma_f32_16x16x32_bf16 v[84:87], v[176:179], a[44:47], v[84:87]
    v_mul_u32_u24 v168, 1280, v3
    v_mfma_f32_16x16x32_bf16 v[88:91], v[180:183], a[44:47], v[88:91]
    v_lshl_add_u32 v168, v2, 4, v168
    v_mfma_f32_16x16x32_bf16 v[92:95], v[184:187], a[44:47], v[92:95]
    v_mfma_f32_16x16x32_bf16 v[96:99], v[188:191], a[44:47], v[96:99]
    v_mfma_f32_16x16x32_bf16 v[100:103], v[192:195], a[44:47], v[100:103]
    s_waitcnt vmcnt(5)
    s_waitcnt vmcnt(0)
    v_mfma_f32_16x16x32_bf16 v[24:27], v[196:199], a[48:51], v[24:27]
    v_mfma_f32_16x16x32_bf16 v[28:31], v[200:203], a[48:51], v[28:31]
    v_mfma_f32_16x16x32_bf16 v[32:35], v[204:207], a[48:51], v[32:35]
    v_mfma_f32_16x16x32_bf16 v[36:39], v[208:211], a[48:51], v[36:39]
    v_mfma_f32_16x16x32_bf16 v[40:43], v[212:215], a[48:51], v[40:43]
    v_mfma_f32_16x16x32_bf16 v[44:47], v[196:199], a[52:55], v[44:47]
    v_mfma_f32_16x16x32_bf16 v[48:51], v[200:203], a[52:55], v[48:51]
    v_mfma_f32_16x16x32_bf16 v[52:55], v[204:207], a[52:55], v[52:55]
    v_mfma_f32_16x16x32_bf16 v[56:59], v[208:211], a[52:55], v[56:59]
    ds_write_b128 v164, v[24:27] offset:0
    v_mfma_f32_16x16x32_bf16 v[60:63], v[212:215], a[52:55], v[60:63]
    ds_write_b128 v164, v[28:31] offset:1024
    v_mfma_f32_16x16x32_bf16 v[64:67], v[196:199], a[56:59], v[64:67]
    ds_write_b128 v164, v[32:35] offset:2048
    v_mfma_f32_16x16x32_bf16 v[68:71], v[200:203], a[56:59], v[68:71]
    ds_write_b128 v164, v[36:39] offset:3072
    v_mfma_f32_16x16x32_bf16 v[72:75], v[204:207], a[56:59], v[72:75]
    ds_write_b128 v164, v[40:43] offset:4096
    v_mfma_f32_16x16x32_bf16 v[76:79], v[208:211], a[56:59], v[76:79]
    ds_write_b128 v165, v[44:47] offset:0
    v_mfma_f32_16x16x32_bf16 v[80:83], v[212:215], a[56:59], v[80:83]
    ds_write_b128 v165, v[48:51] offset:1024
    v_mfma_f32_16x16x32_bf16 v[84:87], v[196:199], a[60:63], v[84:87]
    ds_write_b128 v165, v[52:55] offset:2048
    v_mfma_f32_16x16x32_bf16 v[88:91], v[200:203], a[60:63], v[88:91]
    ds_write_b128 v165, v[56:59] offset:3072
    v_mfma_f32_16x16x32_bf16 v[92:95], v[204:207], a[60:63], v[92:95]
    ds_write_b128 v165, v[60:63] offset:4096
    v_mfma_f32_16x16x32_bf16 v[96:99], v[208:211], a[60:63], v[96:99]
    ds_write_b128 v166, v[64:67] offset:0
    v_mfma_f32_16x16x32_bf16 v[100:103], v[212:215], a[60:63], v[100:103]
    ds_write_b128 v166, v[68:71] offset:1024
    ds_write_b128 v166, v[72:75] offset:2048
    ds_write_b128 v166, v[76:79] offset:3072
    ds_write_b128 v166, v[80:83] offset:4096
    s_waitcnt lgkmcnt(0)
    s_barrier
    s_mul_i32 s65, s60, 15360
    s_add_u32 s65, s65, 61440
    v_add_u32 v7, s65, v4
    ds_read_b128 v[24:27], v7 offset:0
    ds_read_b128 v[28:31], v7 offset:1024
    ds_read_b128 v[32:35], v7 offset:2048
    ds_read_b128 v[36:39], v7 offset:3072
    ds_read_b128 v[40:43], v7 offset:4096
    ds_read_b128 v[44:47], v7 offset:5120
    ds_read_b128 v[48:51], v7 offset:6144
    ds_read_b128 v[52:55], v7 offset:7168
    ds_read_b128 v[56:59], v7 offset:8192
    ds_read_b128 v[60:63], v7 offset:9216
    ds_read_b128 v[64:67], v7 offset:10240
    ds_read_b128 v[68:71], v7 offset:11264
    ds_read_b128 v[72:75], v7 offset:12288
    ds_read_b128 v[76:79], v7 offset:13312
    ds_read_b128 v[80:83], v7 offset:14336
    s_waitcnt lgkmcnt(10)
    v_pk_add_f32 v[84:85], v[84:85], v[24:25]
    v_pk_add_f32 v[86:87], v[86:87], v[26:27]
    v_pk_add_f32 v[88:89], v[88:89], v[28:29]
    v_pk_add_f32 v[90:91], v[90:91], v[30:31]
    v_pk_add_f32 v[92:93], v[92:93], v[32:33]
    v_pk_add_f32 v[94:95], v[94:95], v[34:35]
    v_pk_add_f32 v[96:97], v[96:97], v[36:37]
    v_pk_add_f32 v[98:99], v[98:99], v[38:39]
    v_pk_add_f32 v[100:101], v[100:101], v[40:41]
    v_pk_add_f32 v[102:103], v[102:103], v[42:43]
    s_waitcnt lgkmcnt(5)
    v_pk_add_f32 v[84:85], v[84:85], v[44:45]
    v_pk_add_f32 v[86:87], v[86:87], v[46:47]
    v_pk_add_f32 v[88:89], v[88:89], v[48:49]
    v_pk_add_f32 v[90:91], v[90:91], v[50:51]
    v_pk_add_f32 v[92:93], v[92:93], v[52:53]
    v_pk_add_f32 v[94:95], v[94:95], v[54:55]
    v_pk_add_f32 v[96:97], v[96:97], v[56:57]
    v_pk_add_f32 v[98:99], v[98:99], v[58:59]
    v_pk_add_f32 v[100:101], v[100:101], v[60:61]
    v_pk_add_f32 v[102:103], v[102:103], v[62:63]
    s_waitcnt lgkmcnt(0)
    v_pk_add_f32 v[84:85], v[84:85], v[64:65]
    v_pk_add_f32 v[86:87], v[86:87], v[66:67]
    v_pk_add_f32 v[88:89], v[88:89], v[68:69]
    v_pk_add_f32 v[90:91], v[90:91], v[70:71]
    v_pk_add_f32 v[92:93], v[92:93], v[72:73]
    v_pk_add_f32 v[94:95], v[94:95], v[74:75]
    v_pk_add_f32 v[96:97], v[96:97], v[76:77]
    v_pk_add_f32 v[98:99], v[98:99], v[78:79]
    v_pk_add_f32 v[100:101], v[100:101], v[80:81]
    v_pk_add_f32 v[102:103], v[102:103], v[82:83]
    v_cvt_pk_bf16_f32 v132, v84, v85
    v_cvt_pk_bf16_f32 v138, v86, v87
    v_cvt_pk_bf16_f32 v144, v88, v89
    v_cvt_pk_bf16_f32 v150, v90, v91
    v_lshlrev_b32 v130, 16, v12
    v_lshlrev_b32 v136, 16, v13
    v_lshlrev_b32 v142, 16, v14
    v_lshlrev_b32 v148, 16, v15
    v_and_b32 v131, 0xffff0000, v12
    v_and_b32 v137, 0xffff0000, v13
    v_and_b32 v143, 0xffff0000, v14
    v_and_b32 v149, 0xffff0000, v15
    v_lshlrev_b32 v128, 16, v132
    v_lshlrev_b32 v134, 16, v138
    v_lshlrev_b32 v140, 16, v144
    v_lshlrev_b32 v146, 16, v150
    v_and_b32 v129, 0xffff0000, v132
    v_and_b32 v135, 0xffff0000, v138
    v_and_b32 v141, 0xffff0000, v144
    v_and_b32 v147, 0xffff0000, v150
    v_pk_add_f32 v[128:129], v[128:129], v[130:131]
    v_pk_add_f32 v[134:135], v[134:135], v[136:137]
    v_pk_add_f32 v[140:141], v[140:141], v[142:143]
    v_pk_add_f32 v[146:147], v[146:147], v[148:149]
    v_cvt_pk_bf16_f32 v112, v128, v129
    v_cvt_pk_bf16_f32 v113, v134, v135
    v_cvt_pk_bf16_f32 v114, v140, v141
    v_cvt_pk_bf16_f32 v115, v146, v147
    v_cvt_pk_bf16_f32 v132, v92, v93
    v_cvt_pk_bf16_f32 v138, v94, v95
    v_cvt_pk_bf16_f32 v144, v96, v97
    v_cvt_pk_bf16_f32 v150, v98, v99
    v_lshlrev_b32 v130, 16, v16
    v_lshlrev_b32 v136, 16, v17
    v_lshlrev_b32 v142, 16, v18
    v_lshlrev_b32 v148, 16, v19
    v_and_b32 v131, 0xffff0000, v16
    v_and_b32 v137, 0xffff0000, v17
    v_and_b32 v143, 0xffff0000, v18
    v_and_b32 v149, 0xffff0000, v19
    v_lshlrev_b32 v128, 16, v132
    v_lshlrev_b32 v134, 16, v138
    v_lshlrev_b32 v140, 16, v144
    v_lshlrev_b32 v146, 16, v150
    v_and_b32 v129, 0xffff0000, v132
    v_and_b32 v135, 0xffff0000, v138
    v_and_b32 v141, 0xffff0000, v144
    v_and_b32 v147, 0xffff0000, v150
    v_pk_add_f32 v[128:129], v[128:129], v[130:131]
    v_pk_add_f32 v[134:135], v[134:135], v[136:137]
    v_pk_add_f32 v[140:141], v[140:141], v[142:143]
    v_pk_add_f32 v[146:147], v[146:147], v[148:149]
    v_cvt_pk_bf16_f32 v116, v128, v129
    v_cvt_pk_bf16_f32 v117, v134, v135
    v_cvt_pk_bf16_f32 v118, v140, v141
    v_cvt_pk_bf16_f32 v119, v146, v147
    v_cvt_pk_bf16_f32 v132, v100, v101
    v_cvt_pk_bf16_f32 v138, v102, v103
    v_lshlrev_b32 v130, 16, v20
    v_lshlrev_b32 v136, 16, v21
    v_and_b32 v131, 0xffff0000, v20
    v_and_b32 v137, 0xffff0000, v21
    v_lshlrev_b32 v128, 16, v132
    v_lshlrev_b32 v134, 16, v138
    v_and_b32 v129, 0xffff0000, v132
    v_and_b32 v135, 0xffff0000, v138
    v_pk_add_f32 v[128:129], v[128:129], v[130:131]
    v_pk_add_f32 v[134:135], v[134:135], v[136:137]
    v_cvt_pk_bf16_f32 v120, v128, v129
    v_cvt_pk_bf16_f32 v121, v134, v135
    buffer_store_dwordx4 v[112:115], v168, s[48:51], s58 offen
    buffer_store_dwordx4 v[116:119], v168, s[48:51], s58 offen offset:64
    buffer_store_dwordx2 v[120:121], v168, s[48:51], s59 offen
sequential_preLN__linear_attn_block__dense_activation_relu__prompt_kernel_end:
    s_endpgm
.p2align 6
.type sequential_preLN__linear_attn_block__dense_activation_relu__prompt_kernel_tab,@object
sequential_preLN__linear_attn_block__dense_activation_relu__prompt_kernel_tab:
.long 0, 2752512, 0, 110592, 221184, 331776, 6881280, 6883328, 6885376, 6887424, 3866624, 0, 0, 0, 0, 0
.long 0, 2753536, 0, 110592, 221184, 331776, 6882304, 6884352, 6886400, 6888448, 3866752, 0, 0, 0, 0, 0
.long 0, 2754560, 0, 110592, 221184, 331776, 6942720, 6944768, 6946816, 6948864, 3866880, 0, 0, 0, 0, 0
.long 0, 2755584, 0, 110592, 221184, 331776, 6943744, 6945792, 6947840, 6949888, 3867008, 0, 0, 0, 0, 0
.long 128, 2756608, 128, 110720, 221312, 331904, 6983680, 6985728, 6987776, 6989824, 3867136, 0, 0, 0, 0, 0
.long 128, 2859008, 128, 110720, 221312, 331904, 6984704, 6986752, 6988800, 6990848, 3867264, 0, 0, 0, 0, 0
.long 128, 2854912, 128, 110720, 221312, 331904, 6922240, 6923264, 6924288, 6925312, 3867392, 0, 0, 0, 0, 0
.long 128, 2855936, 128, 110720, 221312, 331904, 7065600, 7066624, 7067648, 7068672, 3868288, 0, 0, 0, 0, 0
.long 256, 2856960, 256, 110848, 221440, 332032, 7024640, 7026688, 7028736, 7030784, 3867520, 0, 0, 0, 0, 0
.long 256, 2857984, 256, 110848, 221440, 332032, 7025664, 7027712, 7029760, 7031808, 3867648, 0, 0, 0, 0, 0
.long 256, 2957312, 256, 110848, 221440, 332032, 7086080, 7088128, 7090176, 7092224, 3867776, 0, 0, 0, 0, 0
.long 256, 2958336, 256, 110848, 221440, 332032, 7087104, 7089152, 7091200, 7093248, 3867904, 0, 0, 0, 0, 0
.long 384, 2959360, 384, 110976, 221568, 332160, 7127040, 7129088, 7131136, 7133184, 3868032, 0, 0, 0, 0, 0
.long 384, 2960384, 384, 110976, 221568, 332160, 7128064, 7130112, 7132160, 7134208, 3868160, 0, 0, 0, 0, 0
.long 384, 2961408, 384, 110976, 221568, 332160, 7168000, 7170048, 7172096, 7174144, 3868416, 0, 0, 0, 0, 0
.long 384, 3063808, 384, 110976, 221568, 332160, 7169024, 7171072, 7173120, 7175168, 3868544, 0, 0, 0, 0, 0
.long 512, 3059712, 512, 111104, 221696, 332288, 7229440, 7231488, 7233536, 7235584, 3868672, 0, 0, 0, 0, 0
.long 512, 3060736, 512, 111104, 221696, 332288, 7230464, 7232512, 7234560, 7236608, 3868800, 0, 0, 0, 0, 0
.long 512, 3061760, 512, 111104, 221696, 332288, 7270400, 7272448, 7274496, 7276544, 3868928, 0, 0, 0, 0, 0
.long 512, 3062784, 512, 111104, 221696, 332288, 7271424, 7273472, 7275520, 7277568, 3869056, 0, 0, 0, 0, 0
.long 640, 3162112, 640, 111232, 221824, 332416, 7208960, 7209984, 7211008, 7212032, 3869184, 0, 0, 0, 0, 0
.long 640, 3163136, 640, 111232, 221824, 332416, 7352320, 7353344, 7354368, 7355392, 3870080, 0, 0, 0, 0, 0
.long 640, 3164160, 640, 111232, 221824, 332416, 7311360, 7313408, 7315456, 7317504, 3869312, 0, 0, 0, 0, 0
.long 640, 3165184, 640, 111232, 221824, 332416, 7312384, 7314432, 7316480, 7318528, 3869440, 0, 0, 0, 0, 0
.long 768, 3166208, 768, 111360, 221952, 332544, 7372800, 7374848, 7376896, 7378944, 3869568, 0, 0, 0, 0, 0
.long 768, 3268608, 768, 111360, 221952, 332544, 7373824, 7375872, 7377920, 7379968, 3869696, 0, 0, 0, 0, 0
.long 768, 3264512, 768, 111360, 221952, 332544, 7413760, 7415808, 7417856, 7419904, 3869824, 0, 0, 0, 0, 0
.long 768, 3265536, 768, 111360, 221952, 332544, 7414784, 7416832, 7418880, 7420928, 3869952, 0, 0, 0, 0, 0
.long 896, 3266560, 896, 111488, 222080, 332672, 7454720, 7456768, 7458816, 7460864, 3870208, 0, 0, 0, 0, 0
.long 896, 3267584, 896, 111488, 222080, 332672, 7455744, 7457792, 7459840, 7461888, 3870336, 0, 0, 0, 0, 0
.long 896, 3366912, 896, 111488, 222080, 332672, 7516160, 7518208, 7520256, 7522304, 3870464, 0, 0, 0, 0, 0
.long 896, 3367936, 896, 111488, 222080, 332672, 7517184, 7519232, 7521280, 7523328, 3870592, 0, 0, 0, 0, 0
.long 1024, 3368960, 1024, 111616, 222208, 332800, 7557120, 7559168, 7561216, 7563264, 3870720, 0, 0, 0, 0, 0
.long 1024, 3369984, 1024, 111616, 222208, 332800, 7558144, 7560192, 7562240, 7564288, 3870848, 0, 0, 0, 0, 0
.long 1024, 3371008, 1024, 111616, 222208, 332800, 7495680, 7496704, 7497728, 7498752, 3870976, 0, 0, 0, 0, 0
.long 1024, 3473408, 1024, 111616, 222208, 332800, 7639040, 7640064, 7641088, 7642112, 3871872, 0, 0, 0, 0, 0
.long 1152, 3469312, 1152, 111744, 222336, 332928, 7598080, 7600128, 7602176, 7604224, 3871104, 0, 0, 0, 0, 0
.long 1152, 3470336, 1152, 111744, 222336, 332928, 7599104, 7601152, 7603200, 7605248, 3871232, 0, 0, 0, 0, 0
.long 1152, 3471360, 1152, 111744, 222336, 332928, 7659520, 7661568, 7663616, 7665664, 3871360, 0, 0, 0, 0, 0
.long 1152, 3472384, 1152, 111744, 222336, 332928, 7660544, 7662592, 7664640, 7666688, 3871488, 0, 0, 0, 0, 0
.long 40960, 2757632, 1280, 111872, 222464, 333056, 7700480, 7702528, 7704576, 7706624, 3871616, 0, 0, 0, 0, 0
.long 40960, 2758656, 1280, 111872, 222464, 333056, 7701504, 7703552, 7705600, 7707648, 3871744, 0, 0, 0, 0, 0
.long 40960, 2759680, 1280, 111872, 222464, 333056, 7741440, 7743488, 7745536, 7747584, 3872000, 0, 0, 0, 0, 0
.long 40960, 2760704, 1280, 111872, 222464, 333056, 7742464, 7744512, 7746560, 7748608, 3872128, 0, 0, 0, 0, 0
.long 41088, 2761728, 1408, 112000, 222592, 333184, 7802880, 7804928, 7806976, 7809024, 3872256, 0, 0, 0, 0, 0
.long 41088, 2864128, 1408, 112000, 222592, 333184, 7803904, 7805952, 7808000, 7810048, 3872384, 0, 0, 0, 0, 0
.long 41088, 2860032, 1408, 112000, 222592, 333184, 7843840, 7845888, 7847936, 7849984, 3872512, 0, 0, 0, 0, 0
.long 41088, 2861056, 1408, 112000, 222592, 333184, 7844864, 7846912, 7848960, 7851008, 3872640, 0, 0, 0, 0, 0
.long 41216, 2862080, 1536, 112128, 222720, 333312, 7884800, 7886848, 7888896, 7890944, 3872896, 0, 0, 0, 0, 0
.long 41216, 2863104, 1536, 112128, 222720, 333312, 7885824, 7887872, 7889920, 7891968, 3873024, 0, 0, 0, 0, 0
.long 41216, 2962432, 1536, 112128, 222720, 333312, 7946240, 7948288, 7950336, 7952384, 3873152, 0, 0, 0, 0, 0
.long 41216, 2963456, 1536, 112128, 222720, 333312, 7947264, 7949312, 7951360, 7953408, 3873280, 0, 0, 0, 0, 0
.long 41344, 2964480, 1664, 112256, 222848, 333440, 7987200, 7989248, 7991296, 7993344, 3873408, 0, 0, 0, 0, 0
.long 41344, 2965504, 1664, 112256, 222848, 333440, 7988224, 7990272, 7992320, 7994368, 3873536, 0, 0, 0, 0, 0
.long 41344, 2966528, 1664, 112256, 222848, 333440, 8028160, 8030208, 8032256, 8034304, 3873792, 0, 0, 0, 0, 0
.long 41344, 3068928, 1664, 112256, 222848, 333440, 8029184, 8031232, 8033280, 8035328, 3873920, 0, 0, 0, 0, 0
.long 41472, 3064832, 1792, 112384, 222976, 333568, 8089600, 8091648, 8093696, 8095744, 3874048, 0, 0, 0, 0, 0
.long 41472, 3065856, 1792, 112384, 222976, 333568, 8090624, 8092672, 8094720, 8096768, 3874176, 0, 0, 0, 0, 0
.long 41472, 3066880, 1792, 112384, 222976, 333568, 8130560, 8132608, 8134656, 8136704, 3874304, 0, 0, 0, 0, 0
.long 41472, 3067904, 1792, 112384, 222976, 333568, 8131584, 8133632, 8135680, 8137728, 3874432, 0, 0, 0, 0, 0
.long 41600, 3167232, 1920, 112512, 223104, 333696, 8069120, 8070144, 8071168, 8072192, 3874560, 0, 0, 0, 0, 0
.long 41600, 3168256, 1920, 112512, 223104, 333696, 8212480, 8213504, 8214528, 8215552, 3875456, 0, 0, 0, 0, 0
.long 41600, 3169280, 1920, 112512, 223104, 333696, 8171520, 8173568, 8175616, 8177664, 3874688, 0, 0, 0, 0, 0
.long 41600, 3170304, 1920, 112512, 223104, 333696, 8172544, 8174592, 8176640, 8178688, 3874816, 0, 0, 0, 0, 0
.long 41728, 3171328, 2048, 112640, 223232, 333824, 8232960, 8235008, 8237056, 8239104, 3874944, 0, 0, 0, 0, 0
.long 41728, 3273728, 2048, 112640, 223232, 333824, 8233984, 8236032, 8238080, 8240128, 3875072, 0, 0, 0, 0, 0
.long 41728, 3269632, 2048, 112640, 223232, 333824, 8273920, 8275968, 8278016, 8280064, 3875200, 0, 0, 0, 0, 0
.long 41728, 3270656, 2048, 112640, 223232, 333824, 8274944, 8276992, 8279040, 8281088, 3875328, 0, 0, 0, 0, 0
.long 41856, 3271680, 2176, 112768, 223360, 333952, 8314880, 8316928, 8318976, 8321024, 3875584, 0, 0, 0, 0, 0
.long 41856, 3272704, 2176, 112768, 223360, 333952, 8315904, 8317952, 8320000, 8322048, 3875712, 0, 0, 0, 0, 0
.long 41856, 3372032, 2176, 112768, 223360, 333952, 8376320, 8378368, 8380416, 8382464, 3875840, 0, 0, 0, 0, 0
.long 41856, 3373056, 2176, 112768, 223360, 333952, 8377344, 8379392, 8381440, 8383488, 3875968, 0, 0, 0, 0, 0
.long 41984, 3374080, 2304, 112896, 223488, 334080, 8417280, 8419328, 8421376, 8423424, 3876096, 0, 0, 0, 0, 0
.long 41984, 3375104, 2304, 112896, 223488, 334080, 8418304, 8420352, 8422400, 8424448, 3876224, 0, 0, 0, 0, 0
.long 41984, 3376128, 2304, 112896, 223488, 334080, 8355840, 8356864, 8357888, 8358912, 3876352, 0, 0, 0, 0, 0
.long 41984, 3478528, 2304, 112896, 223488, 334080, 8499200, 8500224, 8501248, 8502272, 3877248, 0, 0, 0, 0, 0
.long 42112, 3474432, 2432, 113024, 223616, 334208, 8458240, 8460288, 8462336, 8464384, 3876480, 0, 0, 0, 0, 0
.long 42112, 3475456, 2432, 113024, 223616, 334208, 8459264, 8461312, 8463360, 8465408, 3876608, 0, 0, 0, 0, 0
.long 42112, 3476480, 2432, 113024, 223616, 334208, 8519680, 8521728, 8523776, 8525824, 3876736, 0, 0, 0, 0, 0
.long 42112, 3477504, 2432, 113024, 223616, 334208, 8520704, 8522752, 8524800, 8526848, 3876864, 0, 0, 0, 0, 0
.long 81920, 2762752, 2560, 113152, 223744, 334336, 8560640, 8562688, 8564736, 8566784, 3876992, 0, 0, 0, 0, 0
.long 81920, 2763776, 2560, 113152, 223744, 334336, 8561664, 8563712, 8565760, 8567808, 3877120, 0, 0, 0, 0, 0
.long 81920, 2764800, 2560, 113152, 223744, 334336, 8601600, 8603648, 8605696, 8607744, 3877376, 0, 0, 0, 0, 0
.long 81920, 2765824, 2560, 113152, 223744, 334336, 8602624, 8604672, 8606720, 8608768, 3877504, 0, 0, 0, 0, 0
.long 82048, 2766848, 2688, 113280, 223872, 334464, 8663040, 8665088, 8667136, 8669184, 3877632, 0, 0, 0, 0, 0
.long 82048, 2869248, 2688, 113280, 223872, 334464, 8664064, 8666112, 8668160, 8670208, 3877760, 0, 0, 0, 0, 0
.long 82048, 2865152, 2688, 113280, 223872, 334464, 8704000, 8706048, 8708096, 8710144, 3877888, 0, 0, 0, 0, 0
.long 82048, 2866176, 2688, 113280, 223872, 334464, 8705024, 8707072, 8709120, 8711168, 3878016, 0, 0, 0, 0, 0
.long 82176, 2867200, 2816, 113408, 224000, 334592, 8642560, 8643584, 8644608, 8645632, 3878144, 0, 0, 0, 0, 0
.long 82176, 2868224, 2816, 113408, 224000, 334592, 8785920, 8786944, 8787968, 8788992, 3879040, 0, 0, 0, 0, 0
.long 82176, 2967552, 2816, 113408, 224000, 334592, 8744960, 8747008, 8749056, 8751104, 3878272, 0, 0, 0, 0, 0
.long 82176, 2968576, 2816, 113408, 224000, 334592, 8745984, 8748032, 8750080, 8752128, 3878400, 0, 0, 0, 0, 0
.long 82304, 2969600, 2944, 113536, 224128, 334720, 8806400, 8808448, 8810496, 8812544, 3878528, 0, 0, 0, 0, 0
.long 82304, 2970624, 2944, 113536, 224128, 334720, 8807424, 8809472, 8811520, 8813568, 3878656, 0, 0, 0, 0, 0
.long 82304, 2971648, 2944, 113536, 224128, 334720, 8847360, 8849408, 8851456, 8853504, 3878784, 0, 0, 0, 0, 0
.long 82304, 3074048, 2944, 113536, 224128, 334720, 8848384, 8850432, 8852480, 8854528, 3878912, 0, 0, 0, 0, 0
.long 82432, 3069952, 3072, 113664, 224256, 334848, 8888320, 8890368, 8892416, 8894464, 3879168, 0, 0, 0, 0, 0
.long 82432, 3070976, 3072, 113664, 224256, 334848, 8889344, 8891392, 8893440, 8895488, 3879296, 0, 0, 0, 0, 0
.long 82432, 3072000, 3072, 113664, 224256, 334848, 8949760, 8951808, 8953856, 8955904, 3879424, 0, 0, 0, 0, 0
.long 82432, 3073024, 3072, 113664, 224256, 334848, 8950784, 8952832, 8954880, 8956928, 3879552, 0, 0, 0, 0, 0
.long 82560, 3172352, 3200, 113792, 224384, 334976, 8990720, 8992768, 8994816, 8996864, 3879680, 0, 0, 0, 0, 0
.long 82560, 3173376, 3200, 113792, 224384, 334976, 8991744, 8993792, 8995840, 8997888, 3879808, 0, 0, 0, 0, 0
.long 82560, 3174400, 3200, 113792, 224384, 334976, 9031680, 9033728, 9035776, 9037824, 3880064, 0, 0, 0, 0, 0
.long 82560, 3175424, 3200, 113792, 224384, 334976, 9032704, 9034752, 9036800, 9038848, 3880192, 0, 0, 0, 0, 0
.long 82688, 3176448, 3328, 113920, 224512, 335104, 9093120, 9095168, 9097216, 9099264, 3880320, 0, 0, 0, 0, 0
.long 82688, 3278848, 3328, 113920, 224512, 335104, 9094144, 9096192, 9098240, 9100288, 3880448, 0, 0, 0, 0, 0
.long 82688, 3274752, 3328, 113920, 224512, 335104, 9134080, 9136128, 9138176, 9140224, 3880576, 0, 0, 0, 0, 0
.long 82688, 3275776, 3328, 113920, 224512, 335104, 9135104, 9137152, 9139200, 9141248, 3880704, 0, 0, 0, 0, 0
.long 82816, 3276800, 442368, 552960, 663552, 774144, 6889472, 6891520, 6893568, 6895616, 3880960, 0, 0, 0, 0, 0
.long 82816, 3277824, 442368, 552960, 663552, 774144, 6890496, 6892544, 6894592, 6896640, 3881088, 0, 0, 0, 0, 0
.long 82816, 3377152, 442368, 552960, 663552, 774144, 6950912, 6952960, 6955008, 6957056, 3881216, 0, 0, 0, 0, 0
.long 82816, 3378176, 442368, 552960, 663552, 774144, 6951936, 6953984, 6956032, 6958080, 3881344, 0, 0, 0, 0, 0
.long 82944, 3379200, 442496, 553088, 663680, 774272, 6991872, 6993920, 6995968, 6998016, 3881472, 0, 0, 0, 0, 0
.long 82944, 3380224, 442496, 553088, 663680, 774272, 6992896, 6994944, 6996992, 6999040, 3881600, 0, 0, 0, 0, 0
.long 82944, 3381248, 442496, 553088, 663680, 774272, 6926336, 6927360, 6928384, 6929408, 3881728, 0, 0, 0, 0, 0
.long 82944, 3483648, 442496, 553088, 663680, 774272, 7069696, 7070720, 7071744, 7072768, 3882624, 0, 0, 0, 0, 0
.long 83072, 3479552, 442624, 553216, 663808, 774400, 7032832, 7034880, 7036928, 7038976, 3881856, 0, 0, 0, 0, 0
.long 83072, 3480576, 442624, 553216, 663808, 774400, 7033856, 7035904, 7037952, 7040000, 3881984, 0, 0, 0, 0, 0
.long 83072, 3481600, 442624, 553216, 663808, 774400, 7094272, 7096320, 7098368, 7100416, 3882112, 0, 0, 0, 0, 0
.long 83072, 3482624, 442624, 553216, 663808, 774400, 7095296, 7097344, 7099392, 7101440, 3882240, 0, 0, 0, 0, 0
.long 122880, 2767872, 442752, 553344, 663936, 774528, 7135232, 7137280, 7139328, 7141376, 3882368, 0, 0, 0, 0, 0
.long 122880, 2768896, 442752, 553344, 663936, 774528, 7136256, 7138304, 7140352, 7142400, 3882496, 0, 0, 0, 0, 0
.long 122880, 2769920, 442752, 553344, 663936, 774528, 7176192, 7178240, 7180288, 7182336, 3882752, 0, 0, 0, 0, 0
.long 122880, 2770944, 442752, 553344, 663936, 774528, 7177216, 7179264, 7181312, 7183360, 3882880, 0, 0, 0, 0, 0
.long 123008, 2771968, 442880, 553472, 664064, 774656, 7237632, 7239680, 7241728, 7243776, 3883008, 0, 0, 0, 0, 0
.long 123008, 2874368, 442880, 553472, 664064, 774656, 7238656, 7240704, 7242752, 7244800, 3883136, 0, 0, 0, 0, 0
.long 123008, 2870272, 442880, 553472, 664064, 774656, 7278592, 7280640, 7282688, 7284736, 3883264, 0, 0, 0, 0, 0
.long 123008, 2871296, 442880, 553472, 664064, 774656, 7279616, 7281664, 7283712, 7285760, 3883392, 0, 0, 0, 0, 0
.long 123136, 2872320, 443008, 553600, 664192, 774784, 7213056, 7214080, 7215104, 7216128, 3883520, 0, 0, 0, 0, 0
.long 123136, 2873344, 443008, 553600, 664192, 774784, 7356416, 7357440, 7358464, 7359488, 3884416, 0, 0, 0, 0, 0
.long 123136, 2972672, 443008, 553600, 664192, 774784, 7319552, 7321600, 7323648, 7325696, 3883648, 0, 0, 0, 0, 0
.long 123136, 2973696, 443008, 553600, 664192, 774784, 7320576, 7322624, 7324672, 7326720, 3883776, 0, 0, 0, 0, 0
.long 123264, 2974720, 443136, 553728, 664320, 774912, 7380992, 7383040, 7385088, 7387136, 3883904, 0, 0, 0, 0, 0
.long 123264, 2975744, 443136, 553728, 664320, 774912, 7382016, 7384064, 7386112, 7388160, 3884032, 0, 0, 0, 0, 0
.long 123264, 2976768, 443136, 553728, 664320, 774912, 7421952, 7424000, 7426048, 7428096, 3884160, 0, 0, 0, 0, 0
.long 123264, 3079168, 443136, 553728, 664320, 774912, 7422976, 7425024, 7427072, 7429120, 3884288, 0, 0, 0, 0, 0
.long 123392, 3075072, 443264, 553856, 664448, 775040, 7462912, 7464960, 7467008, 7469056, 3884544, 0, 0, 0, 0, 0
.long 123392, 3076096, 443264, 553856, 664448, 775040, 7463936, 7465984, 7468032, 7470080, 3884672, 0, 0, 0, 0, 0
.long 123392, 3077120, 443264, 553856, 664448, 775040, 7524352, 7526400, 7528448, 7530496, 3884800, 0, 0, 0, 0, 0
.long 123392, 3078144, 443264, 553856, 664448, 775040, 7525376, 7527424, 7529472, 7531520, 3884928, 0, 0, 0, 0, 0
.long 123520, 3177472, 443392, 553984, 664576, 775168, 7565312, 7567360, 7569408, 7571456, 3885056, 0, 0, 0, 0, 0
.long 123520, 3178496, 443392, 553984, 664576, 775168, 7566336, 7568384, 7570432, 7572480, 3885184, 0, 0, 0, 0, 0
.long 123520, 3179520, 443392, 553984, 664576, 775168, 7499776, 7500800, 7501824, 7502848, 3885312, 0, 0, 0, 0, 0
.long 123520, 3180544, 443392, 553984, 664576, 775168, 7643136, 7644160, 7645184, 7646208, 3886208, 0, 0, 0, 0, 0
.long 123648, 3181568, 443520, 554112, 664704, 775296, 7606272, 7608320, 7610368, 7612416, 3885440, 0, 0, 0, 0, 0
.long 123648, 3283968, 443520, 554112, 664704, 775296, 7607296, 7609344, 7611392, 7613440, 3885568, 0, 0, 0, 0, 0
.long 123648, 3279872, 443520, 554112, 664704, 775296, 7667712, 7669760, 7671808, 7673856, 3885696, 0, 0, 0, 0, 0
.long 123648, 3280896, 443520, 554112, 664704, 775296, 7668736, 7670784, 7672832, 7674880, 3885824, 0, 0, 0, 0, 0
.long 123776, 3281920, 443648, 554240, 664832, 775424, 7708672, 7710720, 7712768, 7714816, 3885952, 0, 0, 0, 0, 0
.long 123776, 3282944, 443648, 554240, 664832, 775424, 7709696, 7711744, 7713792, 7715840, 3886080, 0, 0, 0, 0, 0
.long 123776, 3382272, 443648, 554240, 664832, 775424, 7749632, 7751680, 7753728, 7755776, 3886336, 0, 0, 0, 0, 0
.long 123776, 3383296, 443648, 554240, 664832, 775424, 7750656, 7752704, 7754752, 7756800, 3886464, 0, 0, 0, 0, 0
.long 123904, 3384320, 443776, 554368, 664960, 775552, 7811072, 7813120, 7815168, 7817216, 3886592, 0, 0, 0, 0, 0
.long 123904, 3385344, 443776, 554368, 664960, 775552, 7812096, 7814144, 7816192, 7818240, 3886720, 0, 0, 0, 0, 0
.long 123904, 3386368, 443776, 554368, 664960, 775552, 7852032, 7854080, 7856128, 7858176, 3886848, 0, 0, 0, 0, 0
.long 123904, 3488768, 443776, 554368, 664960, 775552, 7853056, 7855104, 7857152, 7859200, 3886976, 0, 0, 0, 0, 0
.long 124032, 3484672, 443904, 554496, 665088, 775680, 7892992, 7895040, 7897088, 7899136, 3887232, 0, 0, 0, 0, 0
.long 124032, 3485696, 443904, 554496, 665088, 775680, 7894016, 7896064, 7898112, 7900160, 3887360, 0, 0, 0, 0, 0
.long 124032, 3486720, 443904, 554496, 665088, 775680, 7954432, 7956480, 7958528, 7960576, 3887488, 0, 0, 0, 0, 0
.long 124032, 3487744, 443904, 554496, 665088, 775680, 7955456, 7957504, 7959552, 7961600, 3887616, 0, 0, 0, 0, 0
.long 163840, 2772992, 444032, 554624, 665216, 775808, 7995392, 7997440, 7999488, 8001536, 3887744, 0, 0, 0, 0, 0
.long 163840, 2774016, 444032, 554624, 665216, 775808, 7996416, 7998464, 8000512, 8002560, 3887872, 0, 0, 0, 0, 0
.long 163840, 2775040, 444032, 554624, 665216, 775808, 8036352, 8038400, 8040448, 8042496, 3888128, 0, 0, 0, 0, 0
.long 163840, 2776064, 444032, 554624, 665216, 775808, 8037376, 8039424, 8041472, 8043520, 3888256, 0, 0, 0, 0, 0
.long 163968, 2777088, 444160, 554752, 665344, 775936, 8097792, 8099840, 8101888, 8103936, 3888384, 0, 0, 0, 0, 0
.long 163968, 2879488, 444160, 554752, 665344, 775936, 8098816, 8100864, 8102912, 8104960, 3888512, 0, 0, 0, 0, 0
.long 163968, 2875392, 444160, 554752, 665344, 775936, 8138752, 8140800, 8142848, 8144896, 3888640, 0, 0, 0, 0, 0
.long 163968, 2876416, 444160, 554752, 665344, 775936, 8139776, 8141824, 8143872, 8145920, 3888768, 0, 0, 0, 0, 0
.long 164096, 2877440, 444288, 554880, 665472, 776064, 8073216, 8074240, 8075264, 8076288, 3888896, 0, 0, 0, 0, 0
.long 164096, 2878464, 444288, 554880, 665472, 776064, 8216576, 8217600, 8218624, 8219648, 3889792, 0, 0, 0, 0, 0
.long 164096, 2977792, 444288, 554880, 665472, 776064, 8179712, 8181760, 8183808, 8185856, 3889024, 0, 0, 0, 0, 0
.long 164096, 2978816, 444288, 554880, 665472, 776064, 8180736, 8182784, 8184832, 8186880, 3889152, 0, 0, 0, 0, 0
.long 164224, 2979840, 444416, 555008, 665600, 776192, 8241152, 8243200, 8245248, 8247296, 3889280, 0, 0, 0, 0, 0
.long 164224, 2980864, 444416, 555008, 665600, 776192, 8242176, 8244224, 8246272, 8248320, 3889408, 0, 0, 0, 0, 0
.long 164224, 2981888, 444416, 555008, 665600, 776192, 8282112, 8284160, 8286208, 8288256, 3889536, 0, 0, 0, 0, 0
.long 164224, 3084288, 444416, 555008, 665600, 776192, 8283136, 8285184, 8287232, 8289280, 3889664, 0, 0, 0, 0, 0
.long 164352, 3080192, 444544, 555136, 665728, 776320, 8323072, 8325120, 8327168, 8329216, 3889920, 0, 0, 0, 0, 0
.long 164352, 3081216, 444544, 555136, 665728, 776320, 8324096, 8326144, 8328192, 8330240, 3890048, 0, 0, 0, 0, 0
.long 164352, 3082240, 444544, 555136, 665728, 776320, 8384512, 8386560, 8388608, 8390656, 3890176, 0, 0, 0, 0, 0
.long 164352, 3083264, 444544, 555136, 665728, 776320, 8385536, 8387584, 8389632, 8391680, 3890304, 0, 0, 0, 0, 0
.long 164480, 3182592, 444672, 555264, 665856, 776448, 8425472, 8427520, 8429568, 8431616, 3890432, 0, 0, 0, 0, 0
.long 164480, 3183616, 444672, 555264, 665856, 776448, 8426496, 8428544, 8430592, 8432640, 3890560, 0, 0, 0, 0, 0
.long 164480, 3184640, 444672, 555264, 665856, 776448, 8359936, 8360960, 8361984, 8363008, 3890688, 0, 0, 0, 0, 0
.long 164480, 3185664, 444672, 555264, 665856, 776448, 8503296, 8504320, 8505344, 8506368, 3891584, 0, 0, 0, 0, 0
.long 164608, 3186688, 444800, 555392, 665984, 776576, 8466432, 8468480, 8470528, 8472576, 3890816, 0, 0, 0, 0, 0
.long 164608, 3289088, 444800, 555392, 665984, 776576, 8467456, 8469504, 8471552, 8473600, 3890944, 0, 0, 0, 0, 0
.long 164608, 3284992, 444800, 555392, 665984, 776576, 8527872, 8529920, 8531968, 8534016, 3891072, 0, 0, 0, 0, 0
.long 164608, 3286016, 444800, 555392, 665984, 776576, 8528896, 8530944, 8532992, 8535040, 3891200, 0, 0, 0, 0, 0
.long 164736, 3287040, 444928, 555520, 666112, 776704, 8568832, 8570880, 8572928, 8574976, 3891328, 0, 0, 0, 0, 0
.long 164736, 3288064, 444928, 555520, 666112, 776704, 8569856, 8571904, 8573952, 8576000, 3891456, 0, 0, 0, 0, 0
.long 164736, 3387392, 444928, 555520, 666112, 776704, 8609792, 8611840, 8613888, 8615936, 3891712, 0, 0, 0, 0, 0
.long 164736, 3388416, 444928, 555520, 666112, 776704, 8610816, 8612864, 8614912, 8616960, 3891840, 0, 0, 0, 0, 0
.long 164864, 3389440, 445056, 555648, 666240, 776832, 8671232, 8673280, 8675328, 8677376, 3891968, 0, 0, 0, 0, 0
.long 164864, 3390464, 445056, 555648, 666240, 776832, 8672256, 8674304, 8676352, 8678400, 3892096, 0, 0, 0, 0, 0
.long 164864, 3391488, 445056, 555648, 666240, 776832, 8712192, 8714240, 8716288, 8718336, 3892224, 0, 0, 0, 0, 0
.long 164864, 3493888, 445056, 555648, 666240, 776832, 8713216, 8715264, 8717312, 8719360, 3892352, 0, 0, 0, 0, 0
.long 164992, 3489792, 445184, 555776, 666368, 776960, 8646656, 8647680, 8648704, 8649728, 3892480, 0, 0, 0, 0, 0
.long 164992, 3490816, 445184, 555776, 666368, 776960, 8790016, 8791040, 8792064, 8793088, 3893376, 0, 0, 0, 0, 0
.long 164992, 3491840, 445184, 555776, 666368, 776960, 8753152, 8755200, 8757248, 8759296, 3892608, 0, 0, 0, 0, 0
.long 164992, 3492864, 445184, 555776, 666368, 776960, 8754176, 8756224, 8758272, 8760320, 3892736, 0, 0, 0, 0, 0
.long 204800, 2778112, 445312, 555904, 666496, 777088, 8814592, 8816640, 8818688, 8820736, 3892864, 0, 0, 0, 0, 0
.long 204800, 2779136, 445312, 555904, 666496, 777088, 8815616, 8817664, 8819712, 8821760, 3892992, 0, 0, 0, 0, 0
.long 204800, 2780160, 445312, 555904, 666496, 777088, 8855552, 8857600, 8859648, 8861696, 3893120, 0, 0, 0, 0, 0
.long 204800, 2781184, 445312, 555904, 666496, 777088, 8856576, 8858624, 8860672, 8862720, 3893248, 0, 0, 0, 0, 0
.long 204928, 2782208, 445440, 556032, 666624, 777216, 8896512, 8898560, 8900608, 8902656, 3893504, 0, 0, 0, 0, 0
.long 204928, 2884608, 445440, 556032, 666624, 777216, 8897536, 8899584, 8901632, 8903680, 3893632, 0, 0, 0, 0, 0
.long 204928, 2880512, 445440, 556032, 666624, 777216, 8957952, 8960000, 8962048, 8964096, 3893760, 0, 0, 0, 0, 0
.long 204928, 2881536, 445440, 556032, 666624, 777216, 8958976, 8961024, 8963072, 8965120, 3893888, 0, 0, 0, 0, 0
.long 205056, 2882560, 445568, 556160, 666752, 777344, 8998912, 9000960, 9003008, 9005056, 3894016, 0, 0, 0, 0, 0
.long 205056, 2883584, 445568, 556160, 666752, 777344, 8999936, 9001984, 9004032, 9006080, 3894144, 0, 0, 0, 0, 0
.long 205056, 2982912, 445568, 556160, 666752, 777344, 9039872, 9041920, 9043968, 9046016, 3894400, 0, 0, 0, 0, 0
.long 205056, 2983936, 445568, 556160, 666752, 777344, 9040896, 9042944, 9044992, 9047040, 3894528, 0, 0, 0, 0, 0
.long 205184, 2984960, 445696, 556288, 666880, 777472, 9101312, 9103360, 9105408, 9107456, 3894656, 0, 0, 0, 0, 0
.long 205184, 2985984, 445696, 556288, 666880, 777472, 9102336, 9104384, 9106432, 9108480, 3894784, 0, 0, 0, 0, 0
.long 205184, 2987008, 445696, 556288, 666880, 777472, 9142272, 9144320, 9146368, 9148416, 3894912, 0, 0, 0, 0, 0
.long 205184, 3089408, 445696, 556288, 666880, 777472, 9143296, 9145344, 9147392, 9149440, 3895040, 0, 0, 0, 0, 0
.long 205312, 3085312, 884736, 995328, 1105920, 1216512, 6897664, 6899712, 6901760, 6903808, 3895296, 0, 0, 0, 0, 0
.long 205312, 3086336, 884736, 995328, 1105920, 1216512, 6898688, 6900736, 6902784, 6904832, 3895424, 0, 0, 0, 0, 0
.long 205312, 3087360, 884736, 995328, 1105920, 1216512, 6959104, 6961152, 6963200, 6965248, 3895552, 0, 0, 0, 0, 0
.long 205312, 3088384, 884736, 995328, 1105920, 1216512, 6960128, 6962176, 6964224, 6966272, 3895680, 0, 0, 0, 0, 0
.long 205440, 3187712, 884864, 995456, 1106048, 1216640, 7000064, 7002112, 7004160, 7006208, 3895808, 0, 0, 0, 0, 0
.long 205440, 3188736, 884864, 995456, 1106048, 1216640, 7001088, 7003136, 7005184, 7007232, 3895936, 0, 0, 0, 0, 0
.long 205440, 3189760, 884864, 995456, 1106048, 1216640, 6930432, 6931456, 6932480, 6933504, 3896064, 0, 0, 0, 0, 0
.long 205440, 3190784, 884864, 995456, 1106048, 1216640, 7073792, 7074816, 7075840, 7076864, 3896960, 0, 0, 0, 0, 0
.long 205568, 3191808, 884992, 995584, 1106176, 1216768, 7041024, 7043072, 7045120, 7047168, 3896192, 0, 0, 0, 0, 0
.long 205568, 3294208, 884992, 995584, 1106176, 1216768, 7042048, 7044096, 7046144, 7048192, 3896320, 0, 0, 0, 0, 0
.long 205568, 3290112, 884992, 995584, 1106176, 1216768, 7102464, 7104512, 7106560, 7108608, 3896448, 0, 0, 0, 0, 0
.long 205568, 3291136, 884992, 995584, 1106176, 1216768, 7103488, 7105536, 7107584, 7109632, 3896576, 0, 0, 0, 0, 0
.long 205696, 3292160, 885120, 995712, 1106304, 1216896, 7143424, 7145472, 7147520, 7149568, 3896704, 0, 0, 0, 0, 0
.long 205696, 3293184, 885120, 995712, 1106304, 1216896, 7144448, 7146496, 7148544, 7150592, 3896832, 0, 0, 0, 0, 0
.long 205696, 3392512, 885120, 995712, 1106304, 1216896, 7184384, 7186432, 7188480, 7190528, 3897088, 0, 0, 0, 0, 0
.long 205696, 3393536, 885120, 995712, 1106304, 1216896, 7185408, 7187456, 7189504, 7191552, 3897216, 0, 0, 0, 0, 0
.long 205824, 3394560, 885248, 995840, 1106432, 1217024, 7245824, 7247872, 7249920, 7251968, 3897344, 0, 0, 0, 0, 0
.long 205824, 3395584, 885248, 995840, 1106432, 1217024, 7246848, 7248896, 7250944, 7252992, 3897472, 0, 0, 0, 0, 0
.long 205824, 3396608, 885248, 995840, 1106432, 1217024, 7286784, 7288832, 7290880, 7292928, 3897600, 0, 0, 0, 0, 0
.long 205824, 3499008, 885248, 995840, 1106432, 1217024, 7287808, 7289856, 7291904, 7293952, 3897728, 0, 0, 0, 0, 0
.long 205952, 3494912, 885376, 995968, 1106560, 1217152, 7217152, 7218176, 7219200, 7220224, 3897856, 0, 0, 0, 0, 0
.long 205952, 3495936, 885376, 995968, 1106560, 1217152, 7360512, 7361536, 7362560, 7363584, 3898752, 0, 0, 0, 0, 0
.long 205952, 3496960, 885376, 995968, 1106560, 1217152, 7327744, 7329792, 7331840, 7333888, 3897984, 0, 0, 0, 0, 0
.long 205952, 3497984, 885376, 995968, 1106560, 1217152, 7328768, 7330816, 7332864, 7334912, 3898112, 0, 0, 0, 0, 0
.long 245760, 2783232, 885504, 996096, 1106688, 1217280, 7389184, 7391232, 7393280, 7395328, 3898240, 0, 0, 0, 0, 0
.long 245760, 2784256, 885504, 996096, 1106688, 1217280, 7390208, 7392256, 7394304, 7396352, 3898368, 0, 0, 0, 0, 0
.long 245760, 2785280, 885504, 996096, 1106688, 1217280, 7430144, 7432192, 7434240, 7436288, 3898496, 0, 0, 0, 0, 0
.long 245760, 2786304, 885504, 996096, 1106688, 1217280, 7431168, 7433216, 7435264, 7437312, 3898624, 0, 0, 0, 0, 0
.long 245888, 2787328, 885632, 996224, 1106816, 1217408, 7471104, 7473152, 7475200, 7477248, 3898880, 0, 0, 0, 0, 0
.long 245888, 2889728, 885632, 996224, 1106816, 1217408, 7472128, 7474176, 7476224, 7478272, 3899008, 0, 0, 0, 0, 0
.long 245888, 2885632, 885632, 996224, 1106816, 1217408, 7532544, 7534592, 7536640, 7538688, 3899136, 0, 0, 0, 0, 0
.long 245888, 2886656, 885632, 996224, 1106816, 1217408, 7533568, 7535616, 7537664, 7539712, 3899264, 0, 0, 0, 0, 0
.long 246016, 2887680, 885760, 996352, 1106944, 1217536, 7573504, 7575552, 7577600, 7579648, 3899392, 0, 0, 0, 0, 0
.long 246016, 2888704, 885760, 996352, 1106944, 1217536, 7574528, 7576576, 7578624, 7580672, 3899520, 0, 0, 0, 0, 0
.long 246016, 2988032, 885760, 996352, 1106944, 1217536, 7503872, 7504896, 7505920, 7506944, 3899648, 0, 0, 0, 0, 0
.long 246016, 2989056, 885760, 996352, 1106944, 1217536, 7647232, 7648256, 7649280, 7650304, 3900544, 0, 0, 0, 0, 0
.long 246144, 2990080, 885888, 996480, 1107072, 1217664, 7614464, 7616512, 7618560, 7620608, 3899776, 0, 0, 0, 0, 0
.long 246144, 2991104, 885888, 996480, 1107072, 1217664, 7615488, 7617536, 7619584, 7621632, 3899904, 0, 0, 0, 0, 0
.long 246144, 2992128, 885888, 996480, 1107072, 1217664, 7675904, 7677952, 7680000, 7682048, 3900032, 0, 0, 0, 0, 0
.long 246144, 3094528, 885888, 996480, 1107072, 1217664, 7676928, 7678976, 7681024, 7683072, 3900160, 0, 0, 0, 0, 0
.long 246272, 3090432, 886016, 996608, 1107200, 1217792, 7716864, 7718912, 7720960, 7723008, 3900288, 0, 0, 0, 0, 0
.long 246272, 3091456, 886016, 996608, 1107200, 1217792, 7717888, 7719936, 7721984, 7724032, 3900416, 0, 0, 0, 0, 0
.long 246272, 3092480, 886016, 996608, 1107200, 1217792, 7757824, 7759872, 7761920, 7763968, 3900672, 0, 0, 0, 0, 0
.long 246272, 3093504, 886016, 996608, 1107200, 1217792, 7758848, 7760896, 7762944, 7764992, 3900800, 0, 0, 0, 0, 0
.long 246400, 3192832, 886144, 996736, 1107328, 1217920, 7819264, 7821312, 7823360, 7825408, 3900928, 0, 0, 0, 0, 0
.long 246400, 3193856, 886144, 996736, 1107328, 1217920, 7820288, 7822336, 7824384, 7826432, 3901056, 0, 0, 0, 0, 0
.long 246400, 3194880, 886144, 996736, 1107328, 1217920, 7860224, 7862272, 7864320, 7866368, 3901184, 0, 0, 0, 0, 0
.long 246400, 3195904, 886144, 996736, 1107328, 1217920, 7861248, 7863296, 7865344, 7867392, 3901312, 0, 0, 0, 0, 0
.long 246528, 3196928, 886272, 996864, 1107456, 1218048, 7901184, 7903232, 7905280, 7907328, 3901568, 0, 0, 0, 0, 0
.long 246528, 3299328, 886272, 996864, 1107456, 1218048, 7902208, 7904256, 7906304, 7908352, 3901696, 0, 0, 0, 0, 0
.long 246528, 3295232, 886272, 996864, 1107456, 1218048, 7962624, 7964672, 7966720, 7968768, 3901824, 0, 0, 0, 0, 0
.long 246528, 3296256, 886272, 996864, 1107456, 1218048, 7963648, 7965696, 7967744, 7969792, 3901952, 0, 0, 0, 0, 0
.long 246656, 3297280, 886400, 996992, 1107584, 1218176, 8003584, 8005632, 8007680, 8009728, 3902080, 0, 0, 0, 0, 0
.long 246656, 3298304, 886400, 996992, 1107584, 1218176, 8004608, 8006656, 8008704, 8010752, 3902208, 0, 0, 0, 0, 0
.long 246656, 3397632, 886400, 996992, 1107584, 1218176, 8044544, 8046592, 8048640, 8050688, 3902464, 0, 0, 0, 0, 0
.long 246656, 3398656, 886400, 996992, 1107584, 1218176, 8045568, 8047616, 8049664, 8051712, 3902592, 0, 0, 0, 0, 0
.long 246784, 3399680, 886528, 997120, 1107712, 1218304, 8105984, 8108032, 8110080, 8112128, 3902720, 0, 0, 0, 0, 0
.long 246784, 3400704, 886528, 997120, 1107712, 1218304, 8107008, 8109056, 8111104, 8113152, 3902848, 0, 0, 0, 0, 0
.long 246784, 3401728, 886528, 997120, 1107712, 1218304, 8146944, 8148992, 8151040, 8153088, 3902976, 0, 0, 0, 0, 0
.long 246784, 3504128, 886528, 997120, 1107712, 1218304, 8147968, 8150016, 8152064, 8154112, 3903104, 0, 0, 0, 0, 0
.long 246912, 3500032, 886656, 997248, 1107840, 1218432, 8077312, 8078336, 8079360, 8080384, 3903232, 0, 0, 0, 0, 0
.long 246912, 3501056, 886656, 997248, 1107840, 1218432, 8220672, 8221696, 8222720, 8223744, 3904128, 0, 0, 0, 0, 0
.long 246912, 3502080, 886656, 997248, 1107840, 1218432, 8187904, 8189952, 8192000, 8194048, 3903360, 0, 0, 0, 0, 0
.long 246912, 3503104, 886656, 997248, 1107840, 1218432, 8188928, 8190976, 8193024, 8195072, 3903488, 0, 0, 0, 0, 0
.long 286720, 2788352, 886784, 997376, 1107968, 1218560, 8249344, 8251392, 8253440, 8255488, 3903616, 0, 0, 0, 0, 0
.long 286720, 2789376, 886784, 997376, 1107968, 1218560, 8250368, 8252416, 8254464, 8256512, 3903744, 0, 0, 0, 0, 0
.long 286720, 2790400, 886784, 997376, 1107968, 1218560, 8290304, 8292352, 8294400, 8296448, 3903872, 0, 0, 0, 0, 0
.long 286720, 2791424, 886784, 997376, 1107968, 1218560, 8291328, 8293376, 8295424, 8297472, 3904000, 0, 0, 0, 0, 0
.long 286848, 2792448, 886912, 997504, 1108096, 1218688, 8331264, 8333312, 8335360, 8337408, 3904256, 0, 0, 0, 0, 0
.long 286848, 2894848, 886912, 997504, 1108096, 1218688, 8332288, 8334336, 8336384, 8338432, 3904384, 0, 0, 0, 0, 0
.long 286848, 2890752, 886912, 997504, 1108096, 1218688, 8392704, 8394752, 8396800, 8398848, 3904512, 0, 0, 0, 0, 0
.long 286848, 2891776, 886912, 997504, 1108096, 1218688, 8393728, 8395776, 8397824, 8399872, 3904640, 0, 0, 0, 0, 0
.long 286976, 2892800, 887040, 997632, 1108224, 1218816, 8433664, 8435712, 8437760, 8439808, 3904768, 0, 0, 0, 0, 0
.long 286976, 2893824, 887040, 997632, 1108224, 1218816, 8434688, 8436736, 8438784, 8440832, 3904896, 0, 0, 0, 0, 0
.long 286976, 2993152, 887040, 997632, 1108224, 1218816, 8364032, 8365056, 8366080, 8367104, 3905024, 0, 0, 0, 0, 0
.long 286976, 2994176, 887040, 997632, 1108224, 1218816, 8507392, 8508416, 8509440, 8510464, 3905920, 0, 0, 0, 0, 0
.long 287104, 2995200, 887168, 997760, 1108352, 1218944, 8474624, 8476672, 8478720, 8480768, 3905152, 0, 0, 0, 0, 0
.long 287104, 2996224, 887168, 997760, 1108352, 1218944, 8475648, 8477696, 8479744, 8481792, 3905280, 0, 0, 0, 0, 0
.long 287104, 2997248, 887168, 997760, 1108352, 1218944, 8536064, 8538112, 8540160, 8542208, 3905408, 0, 0, 0, 0, 0
.long 287104, 3099648, 887168, 997760, 1108352, 1218944, 8537088, 8539136, 8541184, 8543232, 3905536, 0, 0, 0, 0, 0
.long 287232, 3095552, 887296, 997888, 1108480, 1219072, 8577024, 8579072, 8581120, 8583168, 3905664, 0, 0, 0, 0, 0
.long 287232, 3096576, 887296, 997888, 1108480, 1219072, 8578048, 8580096, 8582144, 8584192, 3905792, 0, 0, 0, 0, 0
.long 287232, 3097600, 887296, 997888, 1108480, 1219072, 8617984, 8620032, 8622080, 8624128, 3906048, 0, 0, 0, 0, 0
.long 287232, 3098624, 887296, 997888, 1108480, 1219072, 8619008, 8621056, 8623104, 8625152, 3906176, 0, 0, 0, 0, 0
.long 287360, 3197952, 887424, 998016, 1108608, 1219200, 8679424, 8681472, 8683520, 8685568, 3906304, 0, 0, 0, 0, 0
.long 287360, 3198976, 887424, 998016, 1108608, 1219200, 8680448, 8682496, 8684544, 8686592, 3906432, 0, 0, 0, 0, 0
.long 287360, 3200000, 887424, 998016, 1108608, 1219200, 8720384, 8722432, 8724480, 8726528, 3906560, 0, 0, 0, 0, 0
.long 287360, 3201024, 887424, 998016, 1108608, 1219200, 8721408, 8723456, 8725504, 8727552, 3906688, 0, 0, 0, 0, 0
.long 287488, 3202048, 887552, 998144, 1108736, 1219328, 8650752, 8651776, 8652800, 8653824, 3906816, 0, 0, 0, 0, 0
.long 287488, 3304448, 887552, 998144, 1108736, 1219328, 8794112, 8795136, 8796160, 8797184, 3907712, 0, 0, 0, 0, 0
.long 287488, 3300352, 887552, 998144, 1108736, 1219328, 8761344, 8763392, 8765440, 8767488, 3906944, 0, 0, 0, 0, 0
.long 287488, 3301376, 887552, 998144, 1108736, 1219328, 8762368, 8764416, 8766464, 8768512, 3907072, 0, 0, 0, 0, 0
.long 287616, 3302400, 887680, 998272, 1108864, 1219456, 8822784, 8824832, 8826880, 8828928, 3907200, 0, 0, 0, 0, 0
.long 287616, 3303424, 887680, 998272, 1108864, 1219456, 8823808, 8825856, 8827904, 8829952, 3907328, 0, 0, 0, 0, 0
.long 287616, 3402752, 887680, 998272, 1108864, 1219456, 8863744, 8865792, 8867840, 8869888, 3907456, 0, 0, 0, 0, 0
.long 287616, 3403776, 887680, 998272, 1108864, 1219456, 8864768, 8866816, 8868864, 8870912, 3907584, 0, 0, 0, 0, 0
.long 287744, 3404800, 887808, 998400, 1108992, 1219584, 8904704, 8906752, 8908800, 8910848, 3907840, 0, 0, 0, 0, 0
.long 287744, 3405824, 887808, 998400, 1108992, 1219584, 8905728, 8907776, 8909824, 8911872, 3907968, 0, 0, 0, 0, 0
.long 287744, 3406848, 887808, 998400, 1108992, 1219584, 8966144, 8968192, 8970240, 8972288, 3908096, 0, 0, 0, 0, 0
.long 287744, 3509248, 887808, 998400, 1108992, 1219584, 8967168, 8969216, 8971264, 8973312, 3908224, 0, 0, 0, 0, 0
.long 287872, 3505152, 887936, 998528, 1109120, 1219712, 9007104, 9009152, 9011200, 9013248, 3908352, 0, 0, 0, 0, 0
.long 287872, 3506176, 887936, 998528, 1109120, 1219712, 9008128, 9010176, 9012224, 9014272, 3908480, 0, 0, 0, 0, 0
.long 287872, 3507200, 887936, 998528, 1109120, 1219712, 9048064, 9050112, 9052160, 9054208, 3908736, 0, 0, 0, 0, 0
.long 287872, 3508224, 887936, 998528, 1109120, 1219712, 9049088, 9051136, 9053184, 9055232, 3908864, 0, 0, 0, 0, 0
.long 327680, 2793472, 888064, 998656, 1109248, 1219840, 9109504, 9111552, 9113600, 9115648, 3908992, 0, 0, 0, 0, 0
.long 327680, 2794496, 888064, 998656, 1109248, 1219840, 9110528, 9112576, 9114624, 9116672, 3909120, 0, 0, 0, 0, 0
.long 327680, 2795520, 888064, 998656, 1109248, 1219840, 9150464, 9152512, 9154560, 9156608, 3909248, 0, 0, 0, 0, 0
.long 327680, 2796544, 888064, 998656, 1109248, 1219840, 9151488, 9153536, 9155584, 9157632, 3909376, 0, 0, 0, 0, 0
.long 327808, 2797568, 1327104, 1437696, 1548288, 1658880, 6905856, 6907904, 6909952, 6912000, 3909632, 0, 0, 0, 0, 0
.long 327808, 2899968, 1327104, 1437696, 1548288, 1658880, 6906880, 6908928, 6910976, 6913024, 3909760, 0, 0, 0, 0, 0
.long 327808, 2895872, 1327104, 1437696, 1548288, 1658880, 6967296, 6969344, 6971392, 6973440, 3909888, 0, 0, 0, 0, 0
.long 327808, 2896896, 1327104, 1437696, 1548288, 1658880, 6968320, 6970368, 6972416, 6974464, 3910016, 0, 0, 0, 0, 0
.long 327936, 2897920, 1327232, 1437824, 1548416, 1659008, 7008256, 7010304, 7012352, 7014400, 3910144, 0, 0, 0, 0, 0
.long 327936, 2898944, 1327232, 1437824, 1548416, 1659008, 7009280, 7011328, 7013376, 7015424, 3910272, 0, 0, 0, 0, 0
.long 327936, 2998272, 1327232, 1437824, 1548416, 1659008, 6934528, 6935552, 6936576, 6937600, 3910400, 0, 0, 0, 0, 0
.long 327936, 2999296, 1327232, 1437824, 1548416, 1659008, 7077888, 7078912, 7079936, 7080960, 3911296, 0, 0, 0, 0, 0
.long 328064, 3000320, 1327360, 1437952, 1548544, 1659136, 7049216, 7051264, 7053312, 7055360, 3910528, 0, 0, 0, 0, 0
.long 328064, 3001344, 1327360, 1437952, 1548544, 1659136, 7050240, 7052288, 7054336, 7056384, 3910656, 0, 0, 0, 0, 0
.long 328064, 3002368, 1327360, 1437952, 1548544, 1659136, 7110656, 7112704, 7114752, 7116800, 3910784, 0, 0, 0, 0, 0
.long 328064, 3104768, 1327360, 1437952, 1548544, 1659136, 7111680, 7113728, 7115776, 7117824, 3910912, 0, 0, 0, 0, 0
.long 328192, 3100672, 1327488, 1438080, 1548672, 1659264, 7151616, 7153664, 7155712, 7157760, 3911040, 0, 0, 0, 0, 0
.long 328192, 3101696, 1327488, 1438080, 1548672, 1659264, 7152640, 7154688, 7156736, 7158784, 3911168, 0, 0, 0, 0, 0
.long 328192, 3102720, 1327488, 1438080, 1548672, 1659264, 7192576, 7194624, 7196672, 7198720, 3911424, 0, 0, 0, 0, 0
.long 328192, 3103744, 1327488, 1438080, 1548672, 1659264, 7193600, 7195648, 7197696, 7199744, 3911552, 0, 0, 0, 0, 0
.long 328320, 3203072, 1327616, 1438208, 1548800, 1659392, 7254016, 7256064, 7258112, 7260160, 3911680, 0, 0, 0, 0, 0
.long 328320, 3204096, 1327616, 1438208, 1548800, 1659392, 7255040, 7257088, 7259136, 7261184, 3911808, 0, 0, 0, 0, 0
.long 328320, 3205120, 1327616, 1438208, 1548800, 1659392, 7294976, 7297024, 7299072, 7301120, 3911936, 0, 0, 0, 0, 0
.long 328320, 3206144, 1327616, 1438208, 1548800, 1659392, 7296000, 7298048, 7300096, 7302144, 3912064, 0, 0, 0, 0, 0
.long 328448, 3207168, 1327744, 1438336, 1548928, 1659520, 7221248, 7222272, 7223296, 7224320, 3912192, 0, 0, 0, 0, 0
.long 328448, 3309568, 1327744, 1438336, 1548928, 1659520, 7364608, 7365632, 7366656, 7367680, 3913088, 0, 0, 0, 0, 0
.long 328448, 3305472, 1327744, 1438336, 1548928, 1659520, 7335936, 7337984, 7340032, 7342080, 3912320, 0, 0, 0, 0, 0
.long 328448, 3306496, 1327744, 1438336, 1548928, 1659520, 7336960, 7339008, 7341056, 7343104, 3912448, 0, 0, 0, 0, 0
.long 328576, 3307520, 1327872, 1438464, 1549056, 1659648, 7397376, 7399424, 7401472, 7403520, 3912576, 0, 0, 0, 0, 0
.long 328576, 3308544, 1327872, 1438464, 1549056, 1659648, 7398400, 7400448, 7402496, 7404544, 3912704, 0, 0, 0, 0, 0
.long 328576, 3407872, 1327872, 1438464, 1549056, 1659648, 7438336, 7440384, 7442432, 7444480, 3912832, 0, 0, 0, 0, 0
.long 328576, 3408896, 1327872, 1438464, 1549056, 1659648, 7439360, 7441408, 7443456, 7445504, 3912960, 0, 0, 0, 0, 0
.long 328704, 3409920, 1328000, 1438592, 1549184, 1659776, 7479296, 7481344, 7483392, 7485440, 3913216, 0, 0, 0, 0, 0
.long 328704, 3410944, 1328000, 1438592, 1549184, 1659776, 7480320, 7482368, 7484416, 7486464, 3913344, 0, 0, 0, 0, 0
.long 328704, 3411968, 1328000, 1438592, 1549184, 1659776, 7540736, 7542784, 7544832, 7546880, 3913472, 0, 0, 0, 0, 0
.long 328704, 3514368, 1328000, 1438592, 1549184, 1659776, 7541760, 7543808, 7545856, 7547904, 3913600, 0, 0, 0, 0, 0
.long 328832, 3510272, 1328128, 1438720, 1549312, 1659904, 7581696, 7583744, 7585792, 7587840, 3913728, 0, 0, 0, 0, 0
.long 328832, 3511296, 1328128, 1438720, 1549312, 1659904, 7582720, 7584768, 7586816, 7588864, 3913856, 0, 0, 0, 0, 0
.long 328832, 3512320, 1328128, 1438720, 1549312, 1659904, 7507968, 7508992, 7510016, 7511040, 3913984, 0, 0, 0, 0, 0
.long 328832, 3513344, 1328128, 1438720, 1549312, 1659904, 7651328, 7652352, 7653376, 7654400, 3914880, 0, 0, 0, 0, 0
.long 368640, 2798592, 1328256, 1438848, 1549440, 1660032, 7622656, 7624704, 7626752, 7628800, 3914112, 0, 0, 0, 0, 0
.long 368640, 2799616, 1328256, 1438848, 1549440, 1660032, 7623680, 7625728, 7627776, 7629824, 3914240, 0, 0, 0, 0, 0
.long 368640, 2800640, 1328256, 1438848, 1549440, 1660032, 7684096, 7686144, 7688192, 7690240, 3914368, 0, 0, 0, 0, 0
.long 368640, 2801664, 1328256, 1438848, 1549440, 1660032, 7685120, 7687168, 7689216, 7691264, 3914496, 0, 0, 0, 0, 0
.long 368768, 2802688, 1328384, 1438976, 1549568, 1660160, 7725056, 7727104, 7729152, 7731200, 3914624, 0, 0, 0, 0, 0
.long 368768, 2905088, 1328384, 1438976, 1549568, 1660160, 7726080, 7728128, 7730176, 7732224, 3914752, 0, 0, 0, 0, 0
.long 368768, 2900992, 1328384, 1438976, 1549568, 1660160, 7766016, 7768064, 7770112, 7772160, 3915008, 0, 0, 0, 0, 0
.long 368768, 2902016, 1328384, 1438976, 1549568, 1660160, 7767040, 7769088, 7771136, 7773184, 3915136, 0, 0, 0, 0, 0
.long 368896, 2903040, 1328512, 1439104, 1549696, 1660288, 7827456, 7829504, 7831552, 7833600, 3915264, 0, 0, 0, 0, 0
.long 368896, 2904064, 1328512, 1439104, 1549696, 1660288, 7828480, 7830528, 7832576, 7834624, 3915392, 0, 0, 0, 0, 0
.long 368896, 3003392, 1328512, 1439104, 1549696, 1660288, 7868416, 7870464, 7872512, 7874560, 3915520, 0, 0, 0, 0, 0
.long 368896, 3004416, 1328512, 1439104, 1549696, 1660288, 7869440, 7871488, 7873536, 7875584, 3915648, 0, 0, 0, 0, 0
.long 369024, 3005440, 1328640, 1439232, 1549824, 1660416, 7909376, 7911424, 7913472, 7915520, 3915904, 0, 0, 0, 0, 0
.long 369024, 3006464, 1328640, 1439232, 1549824, 1660416, 7910400, 7912448, 7914496, 7916544, 3916032, 0, 0, 0, 0, 0
.long 369024, 3007488, 1328640, 1439232, 1549824, 1660416, 7970816, 7972864, 7974912, 7976960, 3916160, 0, 0, 0, 0, 0
.long 369024, 3109888, 1328640, 1439232, 1549824, 1660416, 7971840, 7973888, 7975936, 7977984, 3916288, 0, 0, 0, 0, 0
.long 369152, 3105792, 1328768, 1439360, 1549952, 1660544, 8011776, 8013824, 8015872, 8017920, 3916416, 0, 0, 0, 0, 0
.long 369152, 3106816, 1328768, 1439360, 1549952, 1660544, 8012800, 8014848, 8016896, 8018944, 3916544, 0, 0, 0, 0, 0
.long 369152, 3107840, 1328768, 1439360, 1549952, 1660544, 8052736, 8054784, 8056832, 8058880, 3916800, 0, 0, 0, 0, 0
.long 369152, 3108864, 1328768, 1439360, 1549952, 1660544, 8053760, 8055808, 8057856, 8059904, 3916928, 0, 0, 0, 0, 0
.long 369280, 3208192, 1328896, 1439488, 1550080, 1660672, 8114176, 8116224, 8118272, 8120320, 3917056, 0, 0, 0, 0, 0
.long 369280, 3209216, 1328896, 1439488, 1550080, 1660672, 8115200, 8117248, 8119296, 8121344, 3917184, 0, 0, 0, 0, 0
.long 369280, 3210240, 1328896, 1439488, 1550080, 1660672, 8155136, 8157184, 8159232, 8161280, 3917312, 0, 0, 0, 0, 0
.long 369280, 3211264, 1328896, 1439488, 1550080, 1660672, 8156160, 8158208, 8160256, 8162304, 3917440, 0, 0, 0, 0, 0
.long 369408, 3212288, 1329024, 1439616, 1550208, 1660800, 8081408, 8082432, 8083456, 8084480, 3917568, 0, 0, 0, 0, 0
.long 369408, 3314688, 1329024, 1439616, 1550208, 1660800, 8224768, 8225792, 8226816, 8227840, 3918464, 0, 0, 0, 0, 0
.long 369408, 3310592, 1329024, 1439616, 1550208, 1660800, 8196096, 8198144, 8200192, 8202240, 3917696, 0, 0, 0, 0, 0
.long 369408, 3311616, 1329024, 1439616, 1550208, 1660800, 8197120, 8199168, 8201216, 8203264, 3917824, 0, 0, 0, 0, 0
.long 369536, 3312640, 1329152, 1439744, 1550336, 1660928, 8257536, 8259584, 8261632, 8263680, 3917952, 0, 0, 0, 0, 0
.long 369536, 3313664, 1329152, 1439744, 1550336, 1660928, 8258560, 8260608, 8262656, 8264704, 3918080, 0, 0, 0, 0, 0
.long 369536, 3412992, 1329152, 1439744, 1550336, 1660928, 8298496, 8300544, 8302592, 8304640, 3918208, 0, 0, 0, 0, 0
.long 369536, 3414016, 1329152, 1439744, 1550336, 1660928, 8299520, 8301568, 8303616, 8305664, 3918336, 0, 0, 0, 0, 0
.long 369664, 3415040, 1329280, 1439872, 1550464, 1661056, 8339456, 8341504, 8343552, 8345600, 3918592, 0, 0, 0, 0, 0
.long 369664, 3416064, 1329280, 1439872, 1550464, 1661056, 8340480, 8342528, 8344576, 8346624, 3918720, 0, 0, 0, 0, 0
.long 369664, 3417088, 1329280, 1439872, 1550464, 1661056, 8400896, 8402944, 8404992, 8407040, 3918848, 0, 0, 0, 0, 0
.long 369664, 3519488, 1329280, 1439872, 1550464, 1661056, 8401920, 8403968, 8406016, 8408064, 3918976, 0, 0, 0, 0, 0
.long 369792, 3515392, 1329408, 1440000, 1550592, 1661184, 8441856, 8443904, 8445952, 8448000, 3919104, 0, 0, 0, 0, 0
.long 369792, 3516416, 1329408, 1440000, 1550592, 1661184, 8442880, 8444928, 8446976, 8449024, 3919232, 0, 0, 0, 0, 0
.long 369792, 3517440, 1329408, 1440000, 1550592, 1661184, 8368128, 8369152, 8370176, 8371200, 3919360, 0, 0, 0, 0, 0
.long 369792, 3518464, 1329408, 1440000, 1550592, 1661184, 8511488, 8512512, 8513536, 8514560, 3920256, 0, 0, 0, 0, 0
.long 409600, 2803712, 1329536, 1440128, 1550720, 1661312, 8482816, 8484864, 8486912, 8488960, 3919488, 0, 0, 0, 0, 0
.long 409600, 2804736, 1329536, 1440128, 1550720, 1661312, 8483840, 8485888, 8487936, 8489984, 3919616, 0, 0, 0, 0, 0
.long 409600, 2805760, 1329536, 1440128, 1550720, 1661312, 8544256, 8546304, 8548352, 8550400, 3919744, 0, 0, 0, 0, 0
.long 409600, 2806784, 1329536, 1440128, 1550720, 1661312, 8545280, 8547328, 8549376, 8551424, 3919872, 0, 0, 0, 0, 0
.long 409728, 2807808, 1329664, 1440256, 1550848, 1661440, 8585216, 8587264, 8589312, 8591360, 3920000, 0, 0, 0, 0, 0
.long 409728, 2910208, 1329664, 1440256, 1550848, 1661440, 8586240, 8588288, 8590336, 8592384, 3920128, 0, 0, 0, 0, 0
.long 409728, 2906112, 1329664, 1440256, 1550848, 1661440, 8626176, 8628224, 8630272, 8632320, 3920384, 0, 0, 0, 0, 0
.long 409728, 2907136, 1329664, 1440256, 1550848, 1661440, 8627200, 8629248, 8631296, 8633344, 3920512, 0, 0, 0, 0, 0
.long 409856, 2908160, 1329792, 1440384, 1550976, 1661568, 8687616, 8689664, 8691712, 8693760, 3920640, 0, 0, 0, 0, 0
.long 409856, 2909184, 1329792, 1440384, 1550976, 1661568, 8688640, 8690688, 8692736, 8694784, 3920768, 0, 0, 0, 0, 0
.long 409856, 3008512, 1329792, 1440384, 1550976, 1661568, 8728576, 8730624, 8732672, 8734720, 3920896, 0, 0, 0, 0, 0
.long 409856, 3009536, 1329792, 1440384, 1550976, 1661568, 8729600, 8731648, 8733696, 8735744, 3921024, 0, 0, 0, 0, 0
.long 409984, 3010560, 1329920, 1440512, 1551104, 1661696, 8654848, 8655872, 8656896, 8657920, 3921152, 0, 0, 0, 0, 0
.long 409984, 3011584, 1329920, 1440512, 1551104, 1661696, 8798208, 8799232, 8800256, 8801280, 3922048, 0, 0, 0, 0, 0
.long 409984, 3012608, 1329920, 1440512, 1551104, 1661696, 8769536, 8771584, 8773632, 8775680, 3921280, 0, 0, 0, 0, 0
.long 409984, 3115008, 1329920, 1440512, 1551104, 1661696, 8770560, 8772608, 8774656, 8776704, 3921408, 0, 0, 0, 0, 0
.long 410112, 3110912, 1330048, 1440640, 1551232, 1661824, 8830976, 8833024, 8835072, 8837120, 3921536, 0, 0, 0, 0, 0
.long 410112, 3111936, 1330048, 1440640, 1551232, 1661824, 8832000, 8834048, 8836096, 8838144, 3921664, 0, 0, 0, 0, 0
.long 410112, 3112960, 1330048, 1440640, 1551232, 1661824, 8871936, 8873984, 8876032, 8878080, 3921792, 0, 0, 0, 0, 0
.long 410112, 3113984, 1330048, 1440640, 1551232, 1661824, 8872960, 8875008, 8877056, 8879104, 3921920, 0, 0, 0, 0, 0
.long 410240, 3213312, 1330176, 1440768, 1551360, 1661952, 8912896, 8914944, 8916992, 8919040, 3922176, 0, 0, 0, 0, 0
.long 410240, 3214336, 1330176, 1440768, 1551360, 1661952, 8913920, 8915968, 8918016, 8920064, 3922304, 0, 0, 0, 0, 0
.long 410240, 3215360, 1330176, 1440768, 1551360, 1661952, 8974336, 8976384, 8978432, 8980480, 3922432, 0, 0, 0, 0, 0
.long 410240, 3216384, 1330176, 1440768, 1551360, 1661952, 8975360, 8977408, 8979456, 8981504, 3922560, 0, 0, 0, 0, 0
.long 410368, 3217408, 1330304, 1440896, 1551488, 1662080, 9015296, 9017344, 9019392, 9021440, 3922688, 0, 0, 0, 0, 0
.long 410368, 3319808, 1330304, 1440896, 1551488, 1662080, 9016320, 9018368, 9020416, 9022464, 3922816, 0, 0, 0, 0, 0
.long 410368, 3315712, 1330304, 1440896, 1551488, 1662080, 9056256, 9058304, 9060352, 9062400, 3923072, 0, 0, 0, 0, 0
.long 410368, 3316736, 1330304, 1440896, 1551488, 1662080, 9057280, 9059328, 9061376, 9063424, 3923200, 0, 0, 0, 0, 0
.long 410496, 3317760, 1330432, 1441024, 1551616, 1662208, 9117696, 9119744, 9121792, 9123840, 3923328, 0, 0, 0, 0, 0
.long 410496, 3318784, 1330432, 1441024, 1551616, 1662208, 9118720, 9120768, 9122816, 9124864, 3923456, 0, 0, 0, 0, 0
.long 410496, 3418112, 1330432, 1441024, 1551616, 1662208, 9158656, 9160704, 9162752, 9164800, 3923584, 0, 0, 0, 0, 0
.long 410496, 3419136, 1330432, 1441024, 1551616, 1662208, 9159680, 9161728, 9163776, 9165824, 3923712, 0, 0, 0, 0, 0
.long 410624, 3420160, 1769472, 1880064, 1990656, 2101248, 6914048, 6916096, 6918144, 6920192, 3923968, 0, 0, 0, 0, 0
.long 410624, 3421184, 1769472, 1880064, 1990656, 2101248, 6915072, 6917120, 6919168, 6921216, 3924096, 0, 0, 0, 0, 0
.long 410624, 3422208, 1769472, 1880064, 1990656, 2101248, 6975488, 6977536, 6979584, 6981632, 3924224, 0, 0, 0, 0, 0
.long 410624, 3524608, 1769472, 1880064, 1990656, 2101248, 6976512, 6978560, 6980608, 6982656, 3924352, 0, 0, 0, 0, 0
.long 410752, 3520512, 1769600, 1880192, 1990784, 2101376, 7016448, 7018496, 7020544, 7022592, 3924480, 0, 0, 0, 0, 0
.long 410752, 3521536, 1769600, 1880192, 1990784, 2101376, 7017472, 7019520, 7021568, 7023616, 3924608, 0, 0, 0, 0, 0
.long 410752, 3522560, 1769600, 1880192, 1990784, 2101376, 6938624, 6939648, 6940672, 6941696, 3924736, 0, 0, 0, 0, 0
.long 410752, 3523584, 1769600, 1880192, 1990784, 2101376, 7081984, 7083008, 7084032, 7085056, 3925632, 0, 0, 0, 0, 0
.long 450560, 2808832, 1769728, 1880320, 1990912, 2101504, 7057408, 7059456, 7061504, 7063552, 3924864, 0, 0, 0, 0, 0
.long 450560, 2809856, 1769728, 1880320, 1990912, 2101504, 7058432, 7060480, 7062528, 7064576, 3924992, 0, 0, 0, 0, 0
.long 450560, 2810880, 1769728, 1880320, 1990912, 2101504, 7118848, 7120896, 7122944, 7124992, 3925120, 0, 0, 0, 0, 0
.long 450560, 2811904, 1769728, 1880320, 1990912, 2101504, 7119872, 7121920, 7123968, 7126016, 3925248, 0, 0, 0, 0, 0
.long 450688, 2812928, 1769856, 1880448, 1991040, 2101632, 7159808, 7161856, 7163904, 7165952, 3925376, 0, 0, 0, 0, 0
.long 450688, 2915328, 1769856, 1880448, 1991040, 2101632, 7160832, 7162880, 7164928, 7166976, 3925504, 0, 0, 0, 0, 0
.long 450688, 2911232, 1769856, 1880448, 1991040, 2101632, 7200768, 7202816, 7204864, 7206912, 3925760, 0, 0, 0, 0, 0
.long 450688, 2912256, 1769856, 1880448, 1991040, 2101632, 7201792, 7203840, 7205888, 7207936, 3925888, 0, 0, 0, 0, 0
.long 450816, 2913280, 1769984, 1880576, 1991168, 2101760, 7262208, 7264256, 7266304, 7268352, 3926016, 0, 0, 0, 0, 0
.long 450816, 2914304, 1769984, 1880576, 1991168, 2101760, 7263232, 7265280, 7267328, 7269376, 3926144, 0, 0, 0, 0, 0
.long 450816, 3013632, 1769984, 1880576, 1991168, 2101760, 7303168, 7305216, 7307264, 7309312, 3926272, 0, 0, 0, 0, 0
.long 450816, 3014656, 1769984, 1880576, 1991168, 2101760, 7304192, 7306240, 7308288, 7310336, 3926400, 0, 0, 0, 0, 0
.long 450944, 3015680, 1770112, 1880704, 1991296, 2101888, 7225344, 7226368, 7227392, 7228416, 3926528, 0, 0, 0, 0, 0
.long 450944, 3016704, 1770112, 1880704, 1991296, 2101888, 7368704, 7369728, 7370752, 7371776, 3927424, 0, 0, 0, 0, 0
.long 450944, 3017728, 1770112, 1880704, 1991296, 2101888, 7344128, 7346176, 7348224, 7350272, 3926656, 0, 0, 0, 0, 0
.long 450944, 3120128, 1770112, 1880704, 1991296, 2101888, 7345152, 7347200, 7349248, 7351296, 3926784, 0, 0, 0, 0, 0
.long 451072, 3116032, 1770240, 1880832, 1991424, 2102016, 7405568, 7407616, 7409664, 7411712, 3926912, 0, 0, 0, 0, 0
.long 451072, 3117056, 1770240, 1880832, 1991424, 2102016, 7406592, 7408640, 7410688, 7412736, 3927040, 0, 0, 0, 0, 0
.long 451072, 3118080, 1770240, 1880832, 1991424, 2102016, 7446528, 7448576, 7450624, 7452672, 3927168, 0, 0, 0, 0, 0
.long 451072, 3119104, 1770240, 1880832, 1991424, 2102016, 7447552, 7449600, 7451648, 7453696, 3927296, 0, 0, 0, 0, 0
.long 451200, 3218432, 1770368, 1880960, 1991552, 2102144, 7487488, 7489536, 7491584, 7493632, 3927552, 0, 0, 0, 0, 0
.long 451200, 3219456, 1770368, 1880960, 1991552, 2102144, 7488512, 7490560, 7492608, 7494656, 3927680, 0, 0, 0, 0, 0
.long 451200, 3220480, 1770368, 1880960, 1991552, 2102144, 7548928, 7550976, 7553024, 7555072, 3927808, 0, 0, 0, 0, 0
.long 451200, 3221504, 1770368, 1880960, 1991552, 2102144, 7549952, 7552000, 7554048, 7556096, 3927936, 0, 0, 0, 0, 0
.long 451328, 3222528, 1770496, 1881088, 1991680, 2102272, 7589888, 7591936, 7593984, 7596032, 3928064, 0, 0, 0, 0, 0
.long 451328, 3324928, 1770496, 1881088, 1991680, 2102272, 7590912, 7592960, 7595008, 7597056, 3928192, 0, 0, 0, 0, 0
.long 451328, 3320832, 1770496, 1881088, 1991680, 2102272, 7512064, 7513088, 7514112, 7515136, 3928320, 0, 0, 0, 0, 0
.long 451328, 3321856, 1770496, 1881088, 1991680, 2102272, 7655424, 7656448, 7657472, 7658496, 3929216, 0, 0, 0, 0, 0
.long 451456, 3322880, 1770624, 1881216, 1991808, 2102400, 7630848, 7632896, 7634944, 7636992, 3928448, 0, 0, 0, 0, 0
.long 451456, 3323904, 1770624, 1881216, 1991808, 2102400, 7631872, 7633920, 7635968, 7638016, 3928576, 0, 0, 0, 0, 0
.long 451456, 3423232, 1770624, 1881216, 1991808, 2102400, 7692288, 7694336, 7696384, 7698432, 3928704, 0, 0, 0, 0, 0
.long 451456, 3424256, 1770624, 1881216, 1991808, 2102400, 7693312, 7695360, 7697408, 7699456, 3928832, 0, 0, 0, 0, 0
.long 451584, 3425280, 1770752, 1881344, 1991936, 2102528, 7733248, 7735296, 7737344, 7739392, 3928960, 0, 0, 0, 0, 0
.long 451584, 3426304, 1770752, 1881344, 1991936, 2102528, 7734272, 7736320, 7738368, 7740416, 3929088, 0, 0, 0, 0, 0
.long 451584, 3427328, 1770752, 1881344, 1991936, 2102528, 7774208, 7776256, 7778304, 7780352, 3929344, 0, 0, 0, 0, 0
.long 451584, 3529728, 1770752, 1881344, 1991936, 2102528, 7775232, 7777280, 7779328, 7781376, 3929472, 0, 0, 0, 0, 0
.long 451712, 3525632, 1770880, 1881472, 1992064, 2102656, 7835648, 7837696, 7839744, 7841792, 3929600, 0, 0, 0, 0, 0
.long 451712, 3526656, 1770880, 1881472, 1992064, 2102656, 7836672, 7838720, 7840768, 7842816, 3929728, 0, 0, 0, 0, 0
.long 451712, 3527680, 1770880, 1881472, 1992064, 2102656, 7876608, 7878656, 7880704, 7882752, 3929856, 0, 0, 0, 0, 0
.long 451712, 3528704, 1770880, 1881472, 1992064, 2102656, 7877632, 7879680, 7881728, 7883776, 3929984, 0, 0, 0, 0, 0
.long 491520, 2813952, 1771008, 1881600, 1992192, 2102784, 7917568, 7919616, 7921664, 7923712, 3930240, 0, 0, 0, 0, 0
.long 491520, 2814976, 1771008, 1881600, 1992192, 2102784, 7918592, 7920640, 7922688, 7924736, 3930368, 0, 0, 0, 0, 0
.long 491520, 2816000, 1771008, 1881600, 1992192, 2102784, 7979008, 7981056, 7983104, 7985152, 3930496, 0, 0, 0, 0, 0
.long 491520, 2817024, 1771008, 1881600, 1992192, 2102784, 7980032, 7982080, 7984128, 7986176, 3930624, 0, 0, 0, 0, 0
.long 491648, 2818048, 1771136, 1881728, 1992320, 2102912, 8019968, 8022016, 8024064, 8026112, 3930752, 0, 0, 0, 0, 0
.long 491648, 2920448, 1771136, 1881728, 1992320, 2102912, 8020992, 8023040, 8025088, 8027136, 3930880, 0, 0, 0, 0, 0
.long 491648, 2916352, 1771136, 1881728, 1992320, 2102912, 8060928, 8062976, 8065024, 8067072, 3931136, 0, 0, 0, 0, 0
.long 491648, 2917376, 1771136, 1881728, 1992320, 2102912, 8061952, 8064000, 8066048, 8068096, 3931264, 0, 0, 0, 0, 0
.long 491776, 2918400, 1771264, 1881856, 1992448, 2103040, 8122368, 8124416, 8126464, 8128512, 3931392, 0, 0, 0, 0, 0
.long 491776, 2919424, 1771264, 1881856, 1992448, 2103040, 8123392, 8125440, 8127488, 8129536, 3931520, 0, 0, 0, 0, 0
.long 491776, 3018752, 1771264, 1881856, 1992448, 2103040, 8163328, 8165376, 8167424, 8169472, 3931648, 0, 0, 0, 0, 0
.long 491776, 3019776, 1771264, 1881856, 1992448, 2103040, 8164352, 8166400, 8168448, 8170496, 3931776, 0, 0, 0, 0, 0
.long 491904, 3020800, 1771392, 1881984, 1992576, 2103168, 8085504, 8086528, 8087552, 8088576, 3931904, 0, 0, 0, 0, 0
.long 491904, 3021824, 1771392, 1881984, 1992576, 2103168, 8228864, 8229888, 8230912, 8231936, 3932800, 0, 0, 0, 0, 0
.long 491904, 3022848, 1771392, 1881984, 1992576, 2103168, 8204288, 8206336, 8208384, 8210432, 3932032, 0, 0, 0, 0, 0
.long 491904, 3125248, 1771392, 1881984, 1992576, 2103168, 8205312, 8207360, 8209408, 8211456, 3932160, 0, 0, 0, 0, 0
.long 492032, 3121152, 1771520, 1882112, 1992704, 2103296, 8265728, 8267776, 8269824, 8271872, 3932288, 0, 0, 0, 0, 0
.long 492032, 3122176, 1771520, 1882112, 1992704, 2103296, 8266752, 8268800, 8270848, 8272896, 3932416, 0, 0, 0, 0, 0
.long 492032, 3123200, 1771520, 1882112, 1992704, 2103296, 8306688, 8308736, 8310784, 8312832, 3932544, 0, 0, 0, 0, 0
.long 492032, 3124224, 1771520, 1882112, 1992704, 2103296, 8307712, 8309760, 8311808, 8313856, 3932672, 0, 0, 0, 0, 0
.long 492160, 3223552, 1771648, 1882240, 1992832, 2103424, 8347648, 8349696, 8351744, 8353792, 3932928, 0, 0, 0, 0, 0
.long 492160, 3224576, 1771648, 1882240, 1992832, 2103424, 8348672, 8350720, 8352768, 8354816, 3933056, 0, 0, 0, 0, 0
.long 492160, 3225600, 1771648, 1882240, 1992832, 2103424, 8409088, 8411136, 8413184, 8415232, 3933184, 0, 0, 0, 0, 0
.long 492160, 3226624, 1771648, 1882240, 1992832, 2103424, 8410112, 8412160, 8414208, 8416256, 3933312, 0, 0, 0, 0, 0
.long 492288, 3227648, 1771776, 1882368, 1992960, 2103552, 8450048, 8452096, 8454144, 8456192, 3933440, 0, 0, 0, 0, 0
.long 492288, 3330048, 1771776, 1882368, 1992960, 2103552, 8451072, 8453120, 8455168, 8457216, 3933568, 0, 0, 0, 0, 0
.long 492288, 3325952, 1771776, 1882368, 1992960, 2103552, 8372224, 8373248, 8374272, 8375296, 3933696, 0, 0, 0, 0, 0
.long 492288, 3326976, 1771776, 1882368, 1992960, 2103552, 8515584, 8516608, 8517632, 8518656, 3934592, 0, 0, 0, 0, 0
.long 492416, 3328000, 1771904, 1882496, 1993088, 2103680, 8491008, 8493056, 8495104, 8497152, 3933824, 0, 0, 0, 0, 0
.long 492416, 3329024, 1771904, 1882496, 1993088, 2103680, 8492032, 8494080, 8496128, 8498176, 3933952, 0, 0, 0, 0, 0
.long 492416, 3428352, 1771904, 1882496, 1993088, 2103680, 8552448, 8554496, 8556544, 8558592, 3934080, 0, 0, 0, 0, 0
.long 492416, 3429376, 1771904, 1882496, 1993088, 2103680, 8553472, 8555520, 8557568, 8559616, 3934208, 0, 0, 0, 0, 0
.long 492544, 3430400, 1772032, 1882624, 1993216, 2103808, 8593408, 8595456, 8597504, 8599552, 3934336, 0, 0, 0, 0, 0
.long 492544, 3431424, 1772032, 1882624, 1993216, 2103808, 8594432, 8596480, 8598528, 8600576, 3934464, 0, 0, 0, 0, 0
.long 492544, 3432448, 1772032, 1882624, 1993216, 2103808, 8634368, 8636416, 8638464, 8640512, 3934720, 0, 0, 0, 0, 0
.long 492544, 3534848, 1772032, 1882624, 1993216, 2103808, 8635392, 8637440, 8639488, 8641536, 3934848, 0, 0, 0, 0, 0
.long 492672, 3530752, 1772160, 1882752, 1993344, 2103936, 8695808, 8697856, 8699904, 8701952, 3934976, 0, 0, 0, 0, 0
.long 492672, 3531776, 1772160, 1882752, 1993344, 2103936, 8696832, 8698880, 8700928, 8702976, 3935104, 0, 0, 0, 0, 0
.long 492672, 3532800, 1772160, 1882752, 1993344, 2103936, 8736768, 8738816, 8740864, 8742912, 3935232, 0, 0, 0, 0, 0
.long 492672, 3533824, 1772160, 1882752, 1993344, 2103936, 8737792, 8739840, 8741888, 8743936, 3935360, 0, 0, 0, 0, 0
.long 532480, 2819072, 1772288, 1882880, 1993472, 2104064, 8658944, 8659968, 8660992, 8662016, 3935488, 0, 0, 0, 0, 0
.long 532480, 2820096, 1772288, 1882880, 1993472, 2104064, 8802304, 8803328, 8804352, 8805376, 3936384, 0, 0, 0, 0, 0
.long 532480, 2821120, 1772288, 1882880, 1993472, 2104064, 8777728, 8779776, 8781824, 8783872, 3935616, 0, 0, 0, 0, 0
.long 532480, 2822144, 1772288, 1882880, 1993472, 2104064, 8778752, 8780800, 8782848, 8784896, 3935744, 0, 0, 0, 0, 0
.long 532608, 2823168, 1772416, 1883008, 1993600, 2104192, 8839168, 8841216, 8843264, 8845312, 3935872, 0, 0, 0, 0, 0
.long 532608, 2925568, 1772416, 1883008, 1993600, 2104192, 8840192, 8842240, 8844288, 8846336, 3936000, 0, 0, 0, 0, 0
.long 532608, 2921472, 1772416, 1883008, 1993600, 2104192, 8880128, 8882176, 8884224, 8886272, 3936128, 0, 0, 0, 0, 0
.long 532608, 2922496, 1772416, 1883008, 1993600, 2104192, 8881152, 8883200, 8885248, 8887296, 3936256, 0, 0, 0, 0, 0
.long 532736, 2923520, 1772544, 1883136, 1993728, 2104320, 8921088, 8923136, 8925184, 8927232, 3936512, 0, 0, 0, 0, 0
.long 532736, 2924544, 1772544, 1883136, 1993728, 2104320, 8922112, 8924160, 8926208, 8928256, 3936640, 0, 0, 0, 0, 0
.long 532736, 3023872, 1772544, 1883136, 1993728, 2104320, 8982528, 8984576, 8986624, 8988672, 3936768, 0, 0, 0, 0, 0
.long 532736, 3024896, 1772544, 1883136, 1993728, 2104320, 8983552, 8985600, 8987648, 8989696, 3936896, 0, 0, 0, 0, 0
.long 532864, 3025920, 1772672, 1883264, 1993856, 2104448, 9023488, 9025536, 9027584, 9029632, 3937024, 0, 0, 0, 0, 0
.long 532864, 3026944, 1772672, 1883264, 1993856, 2104448, 9024512, 9026560, 9028608, 9030656, 3937152, 0, 0, 0, 0, 0
.long 532864, 3027968, 1772672, 1883264, 1993856, 2104448, 9064448, 9066496, 9068544, 9070592, 3937408, 0, 0, 0, 0, 0
.long 532864, 3130368, 1772672, 1883264, 1993856, 2104448, 9065472, 9067520, 9069568, 9071616, 3937536, 0, 0, 0, 0, 0
.long 532992, 3126272, 1772800, 1883392, 1993984, 2104576, 9125888, 9127936, 9129984, 9132032, 3937664, 0, 0, 0, 0, 0
.long 532992, 3127296, 1772800, 1883392, 1993984, 2104576, 9126912, 9128960, 9131008, 9133056, 3937792, 0, 0, 0, 0, 0
.long 532992, 3128320, 1772800, 1883392, 1993984, 2104576, 9166848, 9168896, 9170944, 9172992, 3937920, 0, 0, 0, 0, 0
.long 532992, 3129344, 1772800, 1883392, 1993984, 2104576, 9167872, 9169920, 9171968, 9174016, 3938048, 0, 0, 0, 0, 0
.long 533120, 3228672, 0, 128, 256, 384, 9240576, 9244672, 9529344, 9816064, 2146435072, 0, 0, 0, 0, 0
.long 533120, 3229696, 0, 128, 256, 384, 9241600, 9531392, 9530368, 9817088, 2146435072, 0, 0, 0, 0, 0
.long 533120, 3230720, 0, 128, 256, 384, 9242624, 9527296, 9814016, 9818112, 2146435072, 0, 0, 0, 0, 0
.long 533120, 3231744, 0, 128, 256, 384, 9243648, 9528320, 9815040, 10104832, 2146435072, 0, 0, 0, 0, 0
.long 533248, 3232768, 512, 640, 768, 896, 10100736, 10387456, 10391552, 10676224, 2146435072, 0, 0, 0, 0, 0
.long 533248, 3335168, 512, 640, 768, 896, 10101760, 10388480, 10678272, 10677248, 2146435072, 0, 0, 0, 0, 0
.long 533248, 3331072, 512, 640, 768, 896, 10102784, 10389504, 10674176, 10960896, 2146435072, 0, 0, 0, 0, 0
.long 533248, 3332096, 512, 640, 768, 896, 10103808, 10390528, 10675200, 10961920, 2146435072, 0, 0, 0, 0, 0
.long 533376, 3333120, 1024, 1152, 40960, 41088, 10962944, 11247616, 9363456, 9367552, 2146435072, 0, 0, 0, 0, 0
.long 533376, 3334144, 1024, 1152, 40960, 41088, 10963968, 11248640, 9364480, 9654272, 2146435072, 0, 0, 0, 0, 0
.long 533376, 3433472, 1024, 1152, 40960, 41088, 10964992, 11249664, 9365504, 9650176, 2146435072, 0, 0, 0, 0, 0
.long 533376, 3434496, 1024, 1152, 40960, 41088, 11251712, 11250688, 9366528, 9651200, 2146435072, 0, 0, 0, 0, 0
.long 533504, 3435520, 41216, 41344, 41472, 41600, 9652224, 9938944, 10223616, 10510336, 2146435072, 0, 0, 0, 0, 0
.long 533504, 3436544, 41216, 41344, 41472, 41600, 9653248, 9939968, 10224640, 10511360, 2146435072, 0, 0, 0, 0, 0
.long 533504, 3437568, 41216, 41344, 41472, 41600, 9936896, 9940992, 10225664, 10512384, 2146435072, 0, 0, 0, 0, 0
.long 533504, 3539968, 41216, 41344, 41472, 41600, 9937920, 10227712, 10226688, 10513408, 2146435072, 0, 0, 0, 0, 0
.long 533632, 3535872, 41728, 41856, 41984, 42112, 10514432, 10799104, 11085824, 11370496, 2146435072, 0, 0, 0, 0, 0
.long 533632, 3536896, 41728, 41856, 41984, 42112, 10801152, 10800128, 11086848, 11371520, 2146435072, 0, 0, 0, 0, 0
.long 533632, 3537920, 41728, 41856, 41984, 42112, 10797056, 11083776, 11087872, 11372544, 2146435072, 0, 0, 0, 0, 0
.long 533632, 3538944, 41728, 41856, 41984, 42112, 10798080, 11084800, 11374592, 11373568, 2146435072, 0, 0, 0, 0, 0
.long 573440, 2824192, 81920, 82048, 82176, 82304, 9445376, 9449472, 9734144, 10020864, 2146435072, 0, 0, 0, 0, 0
.long 573440, 2825216, 81920, 82048, 82176, 82304, 9446400, 9736192, 9735168, 10021888, 2146435072, 0, 0, 0, 0, 0
.long 573440, 2826240, 81920, 82048, 82176, 82304, 9447424, 9732096, 10018816, 10022912, 2146435072, 0, 0, 0, 0, 0
.long 573440, 2827264, 81920, 82048, 82176, 82304, 9448448, 9733120, 10019840, 10309632, 2146435072, 0, 0, 0, 0, 0
.long 573568, 2828288, 82432, 82560, 82688, 82816, 10305536, 10592256, 10596352, 10881024, 2146435072, 0, 0, 0, 0, 0
.long 573568, 2930688, 82432, 82560, 82688, 82816, 10306560, 10593280, 10883072, 10882048, 2146435072, 0, 0, 0, 0, 0
.long 573568, 2926592, 82432, 82560, 82688, 82816, 10307584, 10594304, 10878976, 11165696, 2146435072, 0, 0, 0, 0, 0
.long 573568, 2927616, 82432, 82560, 82688, 82816, 10308608, 10595328, 10880000, 11166720, 2146435072, 0, 0, 0, 0, 0
.long 573696, 2928640, 82944, 83072, 122880, 123008, 11167744, 11452416, 9322496, 9326592, 2146435072, 0, 0, 0, 0, 0
.long 573696, 2929664, 82944, 83072, 122880, 123008, 11168768, 11453440, 9323520, 9613312, 2146435072, 0, 0, 0, 0, 0
.long 573696, 3028992, 82944, 83072, 122880, 123008, 11169792, 11454464, 9324544, 9609216, 2146435072, 0, 0, 0, 0, 0
.long 573696, 3030016, 82944, 83072, 122880, 123008, 11456512, 11455488, 9325568, 9610240, 2146435072, 0, 0, 0, 0, 0
.long 573824, 3031040, 123136, 123264, 123392, 123520, 9611264, 9897984, 10182656, 10469376, 2146435072, 0, 0, 0, 0, 0
.long 573824, 3032064, 123136, 123264, 123392, 123520, 9612288, 9899008, 10183680, 10470400, 2146435072, 0, 0, 0, 0, 0
.long 573824, 3033088, 123136, 123264, 123392, 123520, 9895936, 9900032, 10184704, 10471424, 2146435072, 0, 0, 0, 0, 0
.long 573824, 3135488, 123136, 123264, 123392, 123520, 9896960, 10186752, 10185728, 10472448, 2146435072, 0, 0, 0, 0, 0
.long 573952, 3131392, 123648, 123776, 123904, 124032, 10473472, 10758144, 11044864, 11329536, 2146435072, 0, 0, 0, 0, 0
.long 573952, 3132416, 123648, 123776, 123904, 124032, 10760192, 10759168, 11045888, 11330560, 2146435072, 0, 0, 0, 0, 0
.long 573952, 3133440, 123648, 123776, 123904, 124032, 10756096, 11042816, 11046912, 11331584, 2146435072, 0, 0, 0, 0, 0
.long 573952, 3134464, 123648, 123776, 123904, 124032, 10757120, 11043840, 11333632, 11332608, 2146435072, 0, 0, 0, 0, 0
.long 574080, 3233792, 163840, 163968, 164096, 164224, 9245696, 9249792, 9534464, 9821184, 2146435072, 0, 0, 0, 0, 0
.long 574080, 3234816, 163840, 163968, 164096, 164224, 9246720, 9536512, 9535488, 9822208, 2146435072, 0, 0, 0, 0, 0
.long 574080, 3235840, 163840, 163968, 164096, 164224, 9247744, 9532416, 9819136, 9823232, 2146435072, 0, 0, 0, 0, 0
.long 574080, 3236864, 163840, 163968, 164096, 164224, 9248768, 9533440, 9820160, 10109952, 2146435072, 0, 0, 0, 0, 0
.long 574208, 3237888, 164352, 164480, 164608, 164736, 10105856, 10392576, 10396672, 10681344, 2146435072, 0, 0, 0, 0, 0
.long 574208, 3340288, 164352, 164480, 164608, 164736, 10106880, 10393600, 10683392, 10682368, 2146435072, 0, 0, 0, 0, 0
.long 574208, 3336192, 164352, 164480, 164608, 164736, 10107904, 10394624, 10679296, 10966016, 2146435072, 0, 0, 0, 0, 0
.long 574208, 3337216, 164352, 164480, 164608, 164736, 10108928, 10395648, 10680320, 10967040, 2146435072, 0, 0, 0, 0, 0
.long 574336, 3338240, 164864, 164992, 204800, 204928, 10968064, 11252736, 9368576, 9372672, 2146435072, 0, 0, 0, 0, 0
.long 574336, 3339264, 164864, 164992, 204800, 204928, 10969088, 11253760, 9369600, 9659392, 2146435072, 0, 0, 0, 0, 0
.long 574336, 3438592, 164864, 164992, 204800, 204928, 10970112, 11254784, 9370624, 9655296, 2146435072, 0, 0, 0, 0, 0
.long 574336, 3439616, 164864, 164992, 204800, 204928, 11256832, 11255808, 9371648, 9656320, 2146435072, 0, 0, 0, 0, 0
.long 574464, 3440640, 205056, 205184, 205312, 205440, 9657344, 9944064, 10228736, 10515456, 2146435072, 0, 0, 0, 0, 0
.long 574464, 3441664, 205056, 205184, 205312, 205440, 9658368, 9945088, 10229760, 10516480, 2146435072, 0, 0, 0, 0, 0
.long 574464, 3442688, 205056, 205184, 205312, 205440, 9942016, 9946112, 10230784, 10517504, 2146435072, 0, 0, 0, 0, 0
.long 574464, 3545088, 205056, 205184, 205312, 205440, 9943040, 10232832, 10231808, 10518528, 2146435072, 0, 0, 0, 0, 0
.long 574592, 3540992, 205568, 205696, 205824, 205952, 10519552, 10804224, 11090944, 11375616, 2146435072, 0, 0, 0, 0, 0
.long 574592, 3542016, 205568, 205696, 205824, 205952, 10806272, 10805248, 11091968, 11376640, 2146435072, 0, 0, 0, 0, 0
.long 574592, 3543040, 205568, 205696, 205824, 205952, 10802176, 11088896, 11092992, 11377664, 2146435072, 0, 0, 0, 0, 0
.long 574592, 3544064, 205568, 205696, 205824, 205952, 10803200, 11089920, 11379712, 11378688, 2146435072, 0, 0, 0, 0, 0
.long 614400, 2829312, 245760, 245888, 246016, 246144, 9450496, 9454592, 9739264, 10025984, 2146435072, 0, 0, 0, 0, 0
.long 614400, 2830336, 245760, 245888, 246016, 246144, 9451520, 9741312, 9740288, 10027008, 2146435072, 0, 0, 0, 0, 0
.long 614400, 2831360, 245760, 245888, 246016, 246144, 9452544, 9737216, 10023936, 10028032, 2146435072, 0, 0, 0, 0, 0
.long 614400, 2832384, 245760, 245888, 246016, 246144, 9453568, 9738240, 10024960, 10314752, 2146435072, 0, 0, 0, 0, 0
.long 614528, 2833408, 246272, 246400, 246528, 246656, 10310656, 10597376, 10601472, 10886144, 2146435072, 0, 0, 0, 0, 0
.long 614528, 2935808, 246272, 246400, 246528, 246656, 10311680, 10598400, 10888192, 10887168, 2146435072, 0, 0, 0, 0, 0
.long 614528, 2931712, 246272, 246400, 246528, 246656, 10312704, 10599424, 10884096, 11170816, 2146435072, 0, 0, 0, 0, 0
.long 614528, 2932736, 246272, 246400, 246528, 246656, 10313728, 10600448, 10885120, 11171840, 2146435072, 0, 0, 0, 0, 0
.long 614656, 2933760, 246784, 246912, 286720, 286848, 11172864, 11457536, 9250816, 9254912, 2146435072, 0, 0, 0, 0, 0
.long 614656, 2934784, 246784, 246912, 286720, 286848, 11173888, 11458560, 9251840, 9541632, 2146435072, 0, 0, 0, 0, 0
.long 614656, 3034112, 246784, 246912, 286720, 286848, 11174912, 11459584, 9252864, 9537536, 2146435072, 0, 0, 0, 0, 0
.long 614656, 3035136, 246784, 246912, 286720, 286848, 11461632, 11460608, 9253888, 9538560, 2146435072, 0, 0, 0, 0, 0
.long 614784, 3036160, 286976, 287104, 287232, 287360, 9539584, 9826304, 10110976, 10397696, 2146435072, 0, 0, 0, 0, 0
.long 614784, 3037184, 286976, 287104, 287232, 287360, 9540608, 9827328, 10112000, 10398720, 2146435072, 0, 0, 0, 0, 0
.long 614784, 3038208, 286976, 287104, 287232, 287360, 9824256, 9828352, 10113024, 10399744, 2146435072, 0, 0, 0, 0, 0
.long 614784, 3140608, 286976, 287104, 287232, 287360, 9825280, 10115072, 10114048, 10400768, 2146435072, 0, 0, 0, 0, 0
.long 614912, 3136512, 287488, 287616, 287744, 287872, 10401792, 10686464, 10973184, 11257856, 2146435072, 0, 0, 0, 0, 0
.long 614912, 3137536, 287488, 287616, 287744, 287872, 10688512, 10687488, 10974208, 11258880, 2146435072, 0, 0, 0, 0, 0
.long 614912, 3138560, 287488, 287616, 287744, 287872, 10684416, 10971136, 10975232, 11259904, 2146435072, 0, 0, 0, 0, 0
.long 614912, 3139584, 287488, 287616, 287744, 287872, 10685440, 10972160, 11261952, 11260928, 2146435072, 0, 0, 0, 0, 0
.long 615040, 3238912, 327680, 327808, 327936, 328064, 9373696, 9377792, 9662464, 9949184, 2146435072, 0, 0, 0, 0, 0
.long 615040, 3239936, 327680, 327808, 327936, 328064, 9374720, 9664512, 9663488, 9950208, 2146435072, 0, 0, 0, 0, 0
.long 615040, 3240960, 327680, 327808, 327936, 328064, 9375744, 9660416, 9947136, 9951232, 2146435072, 0, 0, 0, 0, 0
.long 615040, 3241984, 327680, 327808, 327936, 328064, 9376768, 9661440, 9948160, 10237952, 2146435072, 0, 0, 0, 0, 0
.long 615168, 3243008, 328192, 328320, 328448, 328576, 10233856, 10520576, 10524672, 10809344, 2146435072, 0, 0, 0, 0, 0
.long 615168, 3345408, 328192, 328320, 328448, 328576, 10234880, 10521600, 10811392, 10810368, 2146435072, 0, 0, 0, 0, 0
.long 615168, 3341312, 328192, 328320, 328448, 328576, 10235904, 10522624, 10807296, 11094016, 2146435072, 0, 0, 0, 0, 0
.long 615168, 3342336, 328192, 328320, 328448, 328576, 10236928, 10523648, 10808320, 11095040, 2146435072, 0, 0, 0, 0, 0
.long 615296, 3343360, 328704, 328832, 368640, 368768, 11096064, 11380736, 9455616, 9459712, 2146435072, 0, 0, 0, 0, 0
.long 615296, 3344384, 328704, 328832, 368640, 368768, 11097088, 11381760, 9456640, 9746432, 2146435072, 0, 0, 0, 0, 0
.long 615296, 3443712, 328704, 328832, 368640, 368768, 11098112, 11382784, 9457664, 9742336, 2146435072, 0, 0, 0, 0, 0
.long 615296, 3444736, 328704, 328832, 368640, 368768, 11384832, 11383808, 9458688, 9743360, 2146435072, 0, 0, 0, 0, 0
.long 615424, 3445760, 368896, 369024, 369152, 369280, 9744384, 10031104, 10315776, 10602496, 2146435072, 0, 0, 0, 0, 0
.long 615424, 3446784, 368896, 369024, 369152, 369280, 9745408, 10032128, 10316800, 10603520, 2146435072, 0, 0, 0, 0, 0
.long 615424, 3447808, 368896, 369024, 369152, 369280, 10029056, 10033152, 10317824, 10604544, 2146435072, 0, 0, 0, 0, 0
.long 615424, 3550208, 368896, 369024, 369152, 369280, 10030080, 10319872, 10318848, 10605568, 2146435072, 0, 0, 0, 0, 0
.long 615552, 3546112, 369408, 369536, 369664, 369792, 10606592, 10891264, 11177984, 11462656, 2146435072, 0, 0, 0, 0, 0
.long 615552, 3547136, 369408, 369536, 369664, 369792, 10893312, 10892288, 11179008, 11463680, 2146435072, 0, 0, 0, 0, 0
.long 615552, 3548160, 369408, 369536, 369664, 369792, 10889216, 11175936, 11180032, 11464704, 2146435072, 0, 0, 0, 0, 0
.long 615552, 3549184, 369408, 369536, 369664, 369792, 10890240, 11176960, 11466752, 11465728, 2146435072, 0, 0, 0, 0, 0
.long 655360, 2834432, 409600, 409728, 409856, 409984, 9327616, 9331712, 9616384, 9903104, 2146435072, 0, 0, 0, 0, 0
.long 655360, 2835456, 409600, 409728, 409856, 409984, 9328640, 9618432, 9617408, 9904128, 2146435072, 0, 0, 0, 0, 0
.long 655360, 2836480, 409600, 409728, 409856, 409984, 9329664, 9614336, 9901056, 9905152, 2146435072, 0, 0, 0, 0, 0
.long 655360, 2837504, 409600, 409728, 409856, 409984, 9330688, 9615360, 9902080, 10191872, 2146435072, 0, 0, 0, 0, 0
.long 655488, 2838528, 410112, 410240, 410368, 410496, 10187776, 10474496, 10478592, 10763264, 2146435072, 0, 0, 0, 0, 0
.long 655488, 2940928, 410112, 410240, 410368, 410496, 10188800, 10475520, 10765312, 10764288, 2146435072, 0, 0, 0, 0, 0
.long 655488, 2936832, 410112, 410240, 410368, 410496, 10189824, 10476544, 10761216, 11047936, 2146435072, 0, 0, 0, 0, 0
.long 655488, 2937856, 410112, 410240, 410368, 410496, 10190848, 10477568, 10762240, 11048960, 2146435072, 0, 0, 0, 0, 0
.long 655616, 2938880, 410624, 410752, 450560, 450688, 11049984, 11334656, 9255936, 9260032, 2146435072, 0, 0, 0, 0, 0
.long 655616, 2939904, 410624, 410752, 450560, 450688, 11051008, 11335680, 9256960, 9546752, 2146435072, 0, 0, 0, 0, 0
.long 655616, 3039232, 410624, 410752, 450560, 450688, 11052032, 11336704, 9257984, 9542656, 2146435072, 0, 0, 0, 0, 0
.long 655616, 3040256, 410624, 410752, 450560, 450688, 11338752, 11337728, 9259008, 9543680, 2146435072, 0, 0, 0, 0, 0
.long 655744, 3041280, 450816, 450944, 451072, 451200, 9544704, 9831424, 10116096, 10402816, 2146435072, 0, 0, 0, 0, 0
.long 655744, 3042304, 450816, 450944, 451072, 451200, 9545728, 9832448, 10117120, 10403840, 2146435072, 0, 0, 0, 0, 0
.long 655744, 3043328, 450816, 450944, 451072, 451200, 9829376, 9833472, 10118144, 10404864, 2146435072, 0, 0, 0, 0, 0
.long 655744, 3145728, 450816, 450944, 451072, 451200, 9830400, 10120192, 10119168, 10405888, 2146435072, 0, 0, 0, 0, 0
.long 655872, 3141632, 451328, 451456, 451584, 451712, 10406912, 10691584, 10978304, 11262976, 2146435072, 0, 0, 0, 0, 0
.long 655872, 3142656, 451328, 451456, 451584, 451712, 10693632, 10692608, 10979328, 11264000, 2146435072, 0, 0, 0, 0, 0
.long 655872, 3143680, 451328, 451456, 451584, 451712, 10689536, 10976256, 10980352, 11265024, 2146435072, 0, 0, 0, 0, 0
.long 655872, 3144704, 451328, 451456, 451584, 451712, 10690560, 10977280, 11267072, 11266048, 2146435072, 0, 0, 0, 0, 0
.long 656000, 3244032, 491520, 491648, 491776, 491904, 9378816, 9382912, 9667584, 9954304, 2146435072, 0, 0, 0, 0, 0
.long 656000, 3245056, 491520, 491648, 491776, 491904, 9379840, 9669632, 9668608, 9955328, 2146435072, 0, 0, 0, 0, 0
.long 656000, 3246080, 491520, 491648, 491776, 491904, 9380864, 9665536, 9952256, 9956352, 2146435072, 0, 0, 0, 0, 0
.long 656000, 3247104, 491520, 491648, 491776, 491904, 9381888, 9666560, 9953280, 10243072, 2146435072, 0, 0, 0, 0, 0
.long 656128, 3248128, 492032, 492160, 492288, 492416, 10238976, 10525696, 10529792, 10814464, 2146435072, 0, 0, 0, 0, 0
.long 656128, 3350528, 492032, 492160, 492288, 492416, 10240000, 10526720, 10816512, 10815488, 2146435072, 0, 0, 0, 0, 0
.long 656128, 3346432, 492032, 492160, 492288, 492416, 10241024, 10527744, 10812416, 11099136, 2146435072, 0, 0, 0, 0, 0
.long 656128, 3347456, 492032, 492160, 492288, 492416, 10242048, 10528768, 10813440, 11100160, 2146435072, 0, 0, 0, 0, 0
.long 656256, 3348480, 492544, 492672, 532480, 532608, 11101184, 11385856, 9460736, 9464832, 2146435072, 0, 0, 0, 0, 0
.long 656256, 3349504, 492544, 492672, 532480, 532608, 11102208, 11386880, 9461760, 9751552, 2146435072, 0, 0, 0, 0, 0
.long 656256, 3448832, 492544, 492672, 532480, 532608, 11103232, 11387904, 9462784, 9747456, 2146435072, 0, 0, 0, 0, 0
.long 656256, 3449856, 492544, 492672, 532480, 532608, 11389952, 11388928, 9463808, 9748480, 2146435072, 0, 0, 0, 0, 0
.long 656384, 3450880, 532736, 532864, 532992, 533120, 9749504, 10036224, 10320896, 10607616, 2146435072, 0, 0, 0, 0, 0
.long 656384, 3451904, 532736, 532864, 532992, 533120, 9750528, 10037248, 10321920, 10608640, 2146435072, 0, 0, 0, 0, 0
.long 656384, 3452928, 532736, 532864, 532992, 533120, 10034176, 10038272, 10322944, 10609664, 2146435072, 0, 0, 0, 0, 0
.long 656384, 3555328, 532736, 532864, 532992, 533120, 10035200, 10324992, 10323968, 10610688, 2146435072, 0, 0, 0, 0, 0
.long 656512, 3551232, 533248, 533376, 533504, 533632, 10611712, 10896384, 11183104, 11467776, 2146435072, 0, 0, 0, 0, 0
.long 656512, 3552256, 533248, 533376, 533504, 533632, 10898432, 10897408, 11184128, 11468800, 2146435072, 0, 0, 0, 0, 0
.long 656512, 3553280, 533248, 533376, 533504, 533632, 10894336, 11181056, 11185152, 11469824, 2146435072, 0, 0, 0, 0, 0
.long 656512, 3554304, 533248, 533376, 533504, 533632, 10895360, 11182080, 11471872, 11470848, 2146435072, 0, 0, 0, 0, 0
.long 696320, 2839552, 573440, 573568, 573696, 573824, 9261056, 9265152, 9549824, 9836544, 2146435072, 0, 0, 0, 0, 0
.long 696320, 2840576, 573440, 573568, 573696, 573824, 9262080, 9551872, 9550848, 9837568, 2146435072, 0, 0, 0, 0, 0
.long 696320, 2841600, 573440, 573568, 573696, 573824, 9263104, 9547776, 9834496, 9838592, 2146435072, 0, 0, 0, 0, 0
.long 696320, 2842624, 573440, 573568, 573696, 573824, 9264128, 9548800, 9835520, 10125312, 2146435072, 0, 0, 0, 0, 0
.long 696448, 2843648, 573952, 574080, 574208, 574336, 10121216, 10407936, 10412032, 10696704, 2146435072, 0, 0, 0, 0, 0
.long 696448, 2946048, 573952, 574080, 574208, 574336, 10122240, 10408960, 10698752, 10697728, 2146435072, 0, 0, 0, 0, 0
.long 696448, 2941952, 573952, 574080, 574208, 574336, 10123264, 10409984, 10694656, 10981376, 2146435072, 0, 0, 0, 0, 0
.long 696448, 2942976, 573952, 574080, 574208, 574336, 10124288, 10411008, 10695680, 10982400, 2146435072, 0, 0, 0, 0, 0
.long 696576, 2944000, 574464, 574592, 614400, 614528, 10983424, 11268096, 9383936, 9388032, 2146435072, 0, 0, 0, 0, 0
.long 696576, 2945024, 574464, 574592, 614400, 614528, 10984448, 11269120, 9384960, 9674752, 2146435072, 0, 0, 0, 0, 0
.long 696576, 3044352, 574464, 574592, 614400, 614528, 10985472, 11270144, 9385984, 9670656, 2146435072, 0, 0, 0, 0, 0
.long 696576, 3045376, 574464, 574592, 614400, 614528, 11272192, 11271168, 9387008, 9671680, 2146435072, 0, 0, 0, 0, 0
.long 696704, 3046400, 614656, 614784, 614912, 615040, 9672704, 9959424, 10244096, 10530816, 2146435072, 0, 0, 0, 0, 0
.long 696704, 3047424, 614656, 614784, 614912, 615040, 9673728, 9960448, 10245120, 10531840, 2146435072, 0, 0, 0, 0, 0
.long 696704, 3048448, 614656, 614784, 614912, 615040, 9957376, 9961472, 10246144, 10532864, 2146435072, 0, 0, 0, 0, 0
.long 696704, 3150848, 614656, 614784, 614912, 615040, 9958400, 10248192, 10247168, 10533888, 2146435072, 0, 0, 0, 0, 0
.long 696832, 3146752, 615168, 615296, 615424, 615552, 10534912, 10819584, 11106304, 11390976, 2146435072, 0, 0, 0, 0, 0
.long 696832, 3147776, 615168, 615296, 615424, 615552, 10821632, 10820608, 11107328, 11392000, 2146435072, 0, 0, 0, 0, 0
.long 696832, 3148800, 615168, 615296, 615424, 615552, 10817536, 11104256, 11108352, 11393024, 2146435072, 0, 0, 0, 0, 0
.long 696832, 3149824, 615168, 615296, 615424, 615552, 10818560, 11105280, 11395072, 11394048, 2146435072, 0, 0, 0, 0, 0
.long 696960, 3249152, 655360, 655488, 655616, 655744, 9465856, 9469952, 9754624, 10041344, 2146435072, 0, 0, 0, 0, 0
.long 696960, 3250176, 655360, 655488, 655616, 655744, 9466880, 9756672, 9755648, 10042368, 2146435072, 0, 0, 0, 0, 0
.long 696960, 3251200, 655360, 655488, 655616, 655744, 9467904, 9752576, 10039296, 10043392, 2146435072, 0, 0, 0, 0, 0
.long 696960, 3252224, 655360, 655488, 655616, 655744, 9468928, 9753600, 10040320, 10330112, 2146435072, 0, 0, 0, 0, 0
.long 697088, 3253248, 655872, 656000, 656128, 656256, 10326016, 10612736, 10616832, 10901504, 2146435072, 0, 0, 0, 0, 0
.long 697088, 3355648, 655872, 656000, 656128, 656256, 10327040, 10613760, 10903552, 10902528, 2146435072, 0, 0, 0, 0, 0
.long 697088, 3351552, 655872, 656000, 656128, 656256, 10328064, 10614784, 10899456, 11186176, 2146435072, 0, 0, 0, 0, 0
.long 697088, 3352576, 655872, 656000, 656128, 656256, 10329088, 10615808, 10900480, 11187200, 2146435072, 0, 0, 0, 0, 0
.long 697216, 3353600, 656384, 656512, 696320, 696448, 11188224, 11472896, 9332736, 9336832, 2146435072, 0, 0, 0, 0, 0
.long 697216, 3354624, 656384, 656512, 696320, 696448, 11189248, 11473920, 9333760, 9623552, 2146435072, 0, 0, 0, 0, 0
.long 697216, 3453952, 656384, 656512, 696320, 696448, 11190272, 11474944, 9334784, 9619456, 2146435072, 0, 0, 0, 0, 0
.long 697216, 3454976, 656384, 656512, 696320, 696448, 11476992, 11475968, 9335808, 9620480, 2146435072, 0, 0, 0, 0, 0
.long 697344, 3456000, 696576, 696704, 696832, 696960, 9621504, 9908224, 10192896, 10479616, 2146435072, 0, 0, 0, 0, 0
.long 697344, 3457024, 696576, 696704, 696832, 696960, 9622528, 9909248, 10193920, 10480640, 2146435072, 0, 0, 0, 0, 0
.long 697344, 3458048, 696576, 696704, 696832, 696960, 9906176, 9910272, 10194944, 10481664, 2146435072, 0, 0, 0, 0, 0
.long 697344, 3560448, 696576, 696704, 696832, 696960, 9907200, 10196992, 10195968, 10482688, 2146435072, 0, 0, 0, 0, 0
.long 697472, 3556352, 697088, 697216, 697344, 697472, 10483712, 10768384, 11055104, 11339776, 2146435072, 0, 0, 0, 0, 0
.long 697472, 3557376, 697088, 697216, 697344, 697472, 10770432, 10769408, 11056128, 11340800, 2146435072, 0, 0, 0, 0, 0
.long 697472, 3558400, 697088, 697216, 697344, 697472, 10766336, 11053056, 11057152, 11341824, 2146435072, 0, 0, 0, 0, 0
.long 697472, 3559424, 697088, 697216, 697344, 697472, 10767360, 11054080, 11343872, 11342848, 2146435072, 0, 0, 0, 0, 0
.long 737280, 2844672, 737280, 737408, 737536, 737664, 9266176, 9270272, 9554944, 9841664, 2146435072, 0, 0, 0, 0, 0
.long 737280, 2845696, 737280, 737408, 737536, 737664, 9267200, 9556992, 9555968, 9842688, 2146435072, 0, 0, 0, 0, 0
.long 737280, 2846720, 737280, 737408, 737536, 737664, 9268224, 9552896, 9839616, 9843712, 2146435072, 0, 0, 0, 0, 0
.long 737280, 2847744, 737280, 737408, 737536, 737664, 9269248, 9553920, 9840640, 10130432, 2146435072, 0, 0, 0, 0, 0
.long 737408, 2848768, 737792, 737920, 738048, 738176, 10126336, 10413056, 10417152, 10701824, 2146435072, 0, 0, 0, 0, 0
.long 737408, 2951168, 737792, 737920, 738048, 738176, 10127360, 10414080, 10703872, 10702848, 2146435072, 0, 0, 0, 0, 0
.long 737408, 2947072, 737792, 737920, 738048, 738176, 10128384, 10415104, 10699776, 10986496, 2146435072, 0, 0, 0, 0, 0
.long 737408, 2948096, 737792, 737920, 738048, 738176, 10129408, 10416128, 10700800, 10987520, 2146435072, 0, 0, 0, 0, 0
.long 737536, 2949120, 738304, 738432, 778240, 778368, 10988544, 11273216, 9389056, 9393152, 2146435072, 0, 0, 0, 0, 0
.long 737536, 2950144, 738304, 738432, 778240, 778368, 10989568, 11274240, 9390080, 9679872, 2146435072, 0, 0, 0, 0, 0
.long 737536, 3049472, 738304, 738432, 778240, 778368, 10990592, 11275264, 9391104, 9675776, 2146435072, 0, 0, 0, 0, 0
.long 737536, 3050496, 738304, 738432, 778240, 778368, 11277312, 11276288, 9392128, 9676800, 2146435072, 0, 0, 0, 0, 0
.long 737664, 3051520, 778496, 778624, 778752, 778880, 9677824, 9964544, 10249216, 10535936, 2146435072, 0, 0, 0, 0, 0
.long 737664, 3052544, 778496, 778624, 778752, 778880, 9678848, 9965568, 10250240, 10536960, 2146435072, 0, 0, 0, 0, 0
.long 737664, 3053568, 778496, 778624, 778752, 778880, 9962496, 9966592, 10251264, 10537984, 2146435072, 0, 0, 0, 0, 0
.long 737664, 3155968, 778496, 778624, 778752, 778880, 9963520, 10253312, 10252288, 10539008, 2146435072, 0, 0, 0, 0, 0
.long 737792, 3151872, 779008, 779136, 779264, 779392, 10540032, 10824704, 11111424, 11396096, 2146435072, 0, 0, 0, 0, 0
.long 737792, 3152896, 779008, 779136, 779264, 779392, 10826752, 10825728, 11112448, 11397120, 2146435072, 0, 0, 0, 0, 0
.long 737792, 3153920, 779008, 779136, 779264, 779392, 10822656, 11109376, 11113472, 11398144, 2146435072, 0, 0, 0, 0, 0
.long 737792, 3154944, 779008, 779136, 779264, 779392, 10823680, 11110400, 11400192, 11399168, 2146435072, 0, 0, 0, 0, 0
.long 737920, 3254272, 819200, 819328, 819456, 819584, 9470976, 9475072, 9759744, 10046464, 2146435072, 0, 0, 0, 0, 0
.long 737920, 3255296, 819200, 819328, 819456, 819584, 9472000, 9761792, 9760768, 10047488, 2146435072, 0, 0, 0, 0, 0
.long 737920, 3256320, 819200, 819328, 819456, 819584, 9473024, 9757696, 10044416, 10048512, 2146435072, 0, 0, 0, 0, 0
.long 737920, 3257344, 819200, 819328, 819456, 819584, 9474048, 9758720, 10045440, 10335232, 2146435072, 0, 0, 0, 0, 0
.long 738048, 3258368, 819712, 819840, 819968, 820096, 10331136, 10617856, 10621952, 10906624, 2146435072, 0, 0, 0, 0, 0
.long 738048, 3360768, 819712, 819840, 819968, 820096, 10332160, 10618880, 10908672, 10907648, 2146435072, 0, 0, 0, 0, 0
.long 738048, 3356672, 819712, 819840, 819968, 820096, 10333184, 10619904, 10904576, 11191296, 2146435072, 0, 0, 0, 0, 0
.long 738048, 3357696, 819712, 819840, 819968, 820096, 10334208, 10620928, 10905600, 11192320, 2146435072, 0, 0, 0, 0, 0
.long 738176, 3358720, 820224, 820352, 860160, 860288, 11193344, 11478016, 9271296, 9275392, 2146435072, 0, 0, 0, 0, 0
.long 738176, 3359744, 820224, 820352, 860160, 860288, 11194368, 11479040, 9272320, 9562112, 2146435072, 0, 0, 0, 0, 0
.long 738176, 3459072, 820224, 820352, 860160, 860288, 11195392, 11480064, 9273344, 9558016, 2146435072, 0, 0, 0, 0, 0
.long 738176, 3460096, 820224, 820352, 860160, 860288, 11482112, 11481088, 9274368, 9559040, 2146435072, 0, 0, 0, 0, 0
.long 738304, 3461120, 860416, 860544, 860672, 860800, 9560064, 9846784, 10131456, 10418176, 2146435072, 0, 0, 0, 0, 0
.long 738304, 3462144, 860416, 860544, 860672, 860800, 9561088, 9847808, 10132480, 10419200, 2146435072, 0, 0, 0, 0, 0
.long 738304, 3463168, 860416, 860544, 860672, 860800, 9844736, 9848832, 10133504, 10420224, 2146435072, 0, 0, 0, 0, 0
.long 738304, 3565568, 860416, 860544, 860672, 860800, 9845760, 10135552, 10134528, 10421248, 2146435072, 0, 0, 0, 0, 0
.long 738432, 3561472, 860928, 861056, 861184, 861312, 10422272, 10706944, 10993664, 11278336, 2146435072, 0, 0, 0, 0, 0
.long 738432, 3562496, 860928, 861056, 861184, 861312, 10708992, 10707968, 10994688, 11279360, 2146435072, 0, 0, 0, 0, 0
.long 738432, 3563520, 860928, 861056, 861184, 861312, 10704896, 10991616, 10995712, 11280384, 2146435072, 0, 0, 0, 0, 0
.long 738432, 3564544, 860928, 861056, 861184, 861312, 10705920, 10992640, 11282432, 11281408, 2146435072, 0, 0, 0, 0, 0
.long 778240, 2849792, 901120, 901248, 901376, 901504, 9394176, 9398272, 9682944, 9969664, 2146435072, 0, 0, 0, 0, 0
.long 778240, 2850816, 901120, 901248, 901376, 901504, 9395200, 9684992, 9683968, 9970688, 2146435072, 0, 0, 0, 0, 0
.long 778240, 2851840, 901120, 901248, 901376, 901504, 9396224, 9680896, 9967616, 9971712, 2146435072, 0, 0, 0, 0, 0
.long 778240, 2852864, 901120, 901248, 901376, 901504, 9397248, 9681920, 9968640, 10258432, 2146435072, 0, 0, 0, 0, 0
.long 778368, 2853888, 901632, 901760, 901888, 902016, 10254336, 10541056, 10545152, 10829824, 2146435072, 0, 0, 0, 0, 0
.long 778368, 2956288, 901632, 901760, 901888, 902016, 10255360, 10542080, 10831872, 10830848, 2146435072, 0, 0, 0, 0, 0
.long 778368, 2952192, 901632, 901760, 901888, 902016, 10256384, 10543104, 10827776, 11114496, 2146435072, 0, 0, 0, 0, 0
.long 778368, 2953216, 901632, 901760, 901888, 902016, 10257408, 10544128, 10828800, 11115520, 2146435072, 0, 0, 0, 0, 0
.long 778496, 2954240, 902144, 902272, 942080, 942208, 11116544, 11401216, 9476096, 9480192, 2146435072, 0, 0, 0, 0, 0
.long 778496, 2955264, 902144, 902272, 942080, 942208, 11117568, 11402240, 9477120, 9766912, 2146435072, 0, 0, 0, 0, 0
.long 778496, 3054592, 902144, 902272, 942080, 942208, 11118592, 11403264, 9478144, 9762816, 2146435072, 0, 0, 0, 0, 0
.long 778496, 3055616, 902144, 902272, 942080, 942208, 11405312, 11404288, 9479168, 9763840, 2146435072, 0, 0, 0, 0, 0
.long 778624, 3056640, 942336, 942464, 942592, 942720, 9764864, 10051584, 10336256, 10622976, 2146435072, 0, 0, 0, 0, 0
.long 778624, 3057664, 942336, 942464, 942592, 942720, 9765888, 10052608, 10337280, 10624000, 2146435072, 0, 0, 0, 0, 0
.long 778624, 3058688, 942336, 942464, 942592, 942720, 10049536, 10053632, 10338304, 10625024, 2146435072, 0, 0, 0, 0, 0
.long 778624, 3161088, 942336, 942464, 942592, 942720, 10050560, 10340352, 10339328, 10626048, 2146435072, 0, 0, 0, 0, 0
.long 778752, 3156992, 942848, 942976, 943104, 943232, 10627072, 10911744, 11198464, 11483136, 2146435072, 0, 0, 0, 0, 0
.long 778752, 3158016, 942848, 942976, 943104, 943232, 10913792, 10912768, 11199488, 11484160, 2146435072, 0, 0, 0, 0, 0
.long 778752, 3159040, 942848, 942976, 943104, 943232, 10909696, 11196416, 11200512, 11485184, 2146435072, 0, 0, 0, 0, 0
.long 778752, 3160064, 942848, 942976, 943104, 943232, 10910720, 11197440, 11487232, 11486208, 2146435072, 0, 0, 0, 0, 0
.long 778880, 3259392, 983040, 983168, 983296, 983424, 9276416, 9280512, 9565184, 9851904, 2146435072, 0, 0, 0, 0, 0
.long 778880, 3260416, 983040, 983168, 983296, 983424, 9277440, 9567232, 9566208, 9852928, 2146435072, 0, 0, 0, 0, 0
.long 778880, 3261440, 983040, 983168, 983296, 983424, 9278464, 9563136, 9849856, 9853952, 2146435072, 0, 0, 0, 0, 0
.long 778880, 3262464, 983040, 983168, 983296, 983424, 9279488, 9564160, 9850880, 10140672, 2146435072, 0, 0, 0, 0, 0
.long 779008, 3263488, 983552, 983680, 983808, 983936, 10136576, 10423296, 10427392, 10712064, 2146435072, 0, 0, 0, 0, 0
.long 779008, 3365888, 983552, 983680, 983808, 983936, 10137600, 10424320, 10714112, 10713088, 2146435072, 0, 0, 0, 0, 0
.long 779008, 3361792, 983552, 983680, 983808, 983936, 10138624, 10425344, 10710016, 10996736, 2146435072, 0, 0, 0, 0, 0
.long 779008, 3362816, 983552, 983680, 983808, 983936, 10139648, 10426368, 10711040, 10997760, 2146435072, 0, 0, 0, 0, 0
.long 779136, 3363840, 984064, 984192, 1024000, 1024128, 10998784, 11283456, 9399296, 9403392, 2146435072, 0, 0, 0, 0, 0
.long 779136, 3364864, 984064, 984192, 1024000, 1024128, 10999808, 11284480, 9400320, 9690112, 2146435072, 0, 0, 0, 0, 0
.long 779136, 3464192, 984064, 984192, 1024000, 1024128, 11000832, 11285504, 9401344, 9686016, 2146435072, 0, 0, 0, 0, 0
.long 779136, 3465216, 984064, 984192, 1024000, 1024128, 11287552, 11286528, 9402368, 9687040, 2146435072, 0, 0, 0, 0, 0
.long 779264, 3466240, 1024256, 1024384, 1024512, 1024640, 9688064, 9974784, 10259456, 10546176, 2146435072, 0, 0, 0, 0, 0
.long 779264, 3467264, 1024256, 1024384, 1024512, 1024640, 9689088, 9975808, 10260480, 10547200, 2146435072, 0, 0, 0, 0, 0
.long 779264, 3468288, 1024256, 1024384, 1024512, 1024640, 9972736, 9976832, 10261504, 10548224, 2146435072, 0, 0, 0, 0, 0
.long 779264, 3570688, 1024256, 1024384, 1024512, 1024640, 9973760, 10263552, 10262528, 10549248, 2146435072, 0, 0, 0, 0, 0
.long 779392, 3566592, 1024768, 1024896, 1025024, 1025152, 10550272, 10834944, 11121664, 11406336, 2146435072, 0, 0, 0, 0, 0
.long 779392, 3567616, 1024768, 1024896, 1025024, 1025152, 10836992, 10835968, 11122688, 11407360, 2146435072, 0, 0, 0, 0, 0
.long 779392, 3568640, 1024768, 1024896, 1025024, 1025152, 10832896, 11119616, 11123712, 11408384, 2146435072, 0, 0, 0, 0, 0
.long 779392, 3569664, 1024768, 1024896, 1025024, 1025152, 10833920, 11120640, 11410432, 11409408, 2146435072, 0, 0, 0, 0, 0
.long 1966592, 10172416, 1064960, 1065088, 1065216, 1065344, 9481216, 9485312, 9769984, 10056704, 2146435072, 0, 0, 0, 0, 0
.long 1966592, 10173440, 1064960, 1065088, 1065216, 1065344, 9482240, 9772032, 9771008, 10057728, 2146435072, 0, 0, 0, 0, 0
.long 1966592, 10174464, 1064960, 1065088, 1065216, 1065344, 9483264, 9767936, 10054656, 10058752, 2146435072, 0, 0, 0, 0, 0
.long 1966592, 10175488, 1064960, 1065088, 1065216, 1065344, 9484288, 9768960, 10055680, 10345472, 2146435072, 0, 0, 0, 0, 0
.long 1966720, 10459136, 1065472, 1065600, 1065728, 1065856, 10341376, 10628096, 10632192, 10916864, 2146435072, 0, 0, 0, 0, 0
.long 1966720, 10460160, 1065472, 1065600, 1065728, 1065856, 10342400, 10629120, 10918912, 10917888, 2146435072, 0, 0, 0, 0, 0
.long 1966720, 10461184, 1065472, 1065600, 1065728, 1065856, 10343424, 10630144, 10914816, 11201536, 2146435072, 0, 0, 0, 0, 0
.long 1966720, 10462208, 1065472, 1065600, 1065728, 1065856, 10344448, 10631168, 10915840, 11202560, 2146435072, 0, 0, 0, 0, 0
.long 1966848, 10463232, 1065984, 1066112, 1105920, 1106048, 11203584, 11488256, 9281536, 9285632, 2146435072, 0, 0, 0, 0, 0
.long 1966848, 10749952, 1065984, 1066112, 1105920, 1106048, 11204608, 11489280, 9282560, 9572352, 2146435072, 0, 0, 0, 0, 0
.long 1966848, 10745856, 1065984, 1066112, 1105920, 1106048, 11205632, 11490304, 9283584, 9568256, 2146435072, 0, 0, 0, 0, 0
.long 1966848, 10746880, 1065984, 1066112, 1105920, 1106048, 11492352, 11491328, 9284608, 9569280, 2146435072, 0, 0, 0, 0, 0
.long 1966976, 10747904, 1106176, 1106304, 1106432, 1106560, 9570304, 9857024, 10141696, 10428416, 2146435072, 0, 0, 0, 0, 0
.long 1966976, 10748928, 1106176, 1106304, 1106432, 1106560, 9571328, 9858048, 10142720, 10429440, 2146435072, 0, 0, 0, 0, 0
.long 1966976, 11032576, 1106176, 1106304, 1106432, 1106560, 9854976, 9859072, 10143744, 10430464, 2146435072, 0, 0, 0, 0, 0
.long 1966976, 11033600, 1106176, 1106304, 1106432, 1106560, 9856000, 10145792, 10144768, 10431488, 2146435072, 0, 0, 0, 0, 0
.long 1967104, 11034624, 1106688, 1106816, 1106944, 1107072, 10432512, 10717184, 11003904, 11288576, 2146435072, 0, 0, 0, 0, 0
.long 1967104, 11035648, 1106688, 1106816, 1106944, 1107072, 10719232, 10718208, 11004928, 11289600, 2146435072, 0, 0, 0, 0, 0
.long 1967104, 11036672, 1106688, 1106816, 1106944, 1107072, 10715136, 11001856, 11005952, 11290624, 2146435072, 0, 0, 0, 0, 0
.long 1967104, 11323392, 1106688, 1106816, 1106944, 1107072, 10716160, 11002880, 11292672, 11291648, 2146435072, 0, 0, 0, 0, 0
.long 1967232, 11319296, 1146880, 1147008, 1147136, 1147264, 9404416, 9408512, 9693184, 9979904, 2146435072, 0, 0, 0, 0, 0
.long 1967232, 11320320, 1146880, 1147008, 1147136, 1147264, 9405440, 9695232, 9694208, 9980928, 2146435072, 0, 0, 0, 0, 0
.long 1967232, 11321344, 1146880, 1147008, 1147136, 1147264, 9406464, 9691136, 9977856, 9981952, 2146435072, 0, 0, 0, 0, 0
.long 1967232, 11322368, 1146880, 1147008, 1147136, 1147264, 9407488, 9692160, 9978880, 10268672, 2146435072, 0, 0, 0, 0, 0
.long 2007040, 9435136, 1147392, 1147520, 1147648, 1147776, 10264576, 10551296, 10555392, 10840064, 2146435072, 0, 0, 0, 0, 0
.long 2007040, 9436160, 1147392, 1147520, 1147648, 1147776, 10265600, 10552320, 10842112, 10841088, 2146435072, 0, 0, 0, 0, 0
.long 2007040, 9437184, 1147392, 1147520, 1147648, 1147776, 10266624, 10553344, 10838016, 11124736, 2146435072, 0, 0, 0, 0, 0
.long 2007040, 9438208, 1147392, 1147520, 1147648, 1147776, 10267648, 10554368, 10839040, 11125760, 2146435072, 0, 0, 0, 0, 0
.long 2007168, 9439232, 1147904, 1148032, 1187840, 1187968, 11126784, 11411456, 9486336, 9490432, 2146435072, 0, 0, 0, 0, 0
.long 2007168, 9725952, 1147904, 1148032, 1187840, 1187968, 11127808, 11412480, 9487360, 9777152, 2146435072, 0, 0, 0, 0, 0
.long 2007168, 9721856, 1147904, 1148032, 1187840, 1187968, 11128832, 11413504, 9488384, 9773056, 2146435072, 0, 0, 0, 0, 0
.long 2007168, 9722880, 1147904, 1148032, 1187840, 1187968, 11415552, 11414528, 9489408, 9774080, 2146435072, 0, 0, 0, 0, 0
.long 2007296, 9723904, 1188096, 1188224, 1188352, 1188480, 9775104, 10061824, 10346496, 10633216, 2146435072, 0, 0, 0, 0, 0
.long 2007296, 9724928, 1188096, 1188224, 1188352, 1188480, 9776128, 10062848, 10347520, 10634240, 2146435072, 0, 0, 0, 0, 0
.long 2007296, 10008576, 1188096, 1188224, 1188352, 1188480, 10059776, 10063872, 10348544, 10635264, 2146435072, 0, 0, 0, 0, 0
.long 2007296, 10009600, 1188096, 1188224, 1188352, 1188480, 10060800, 10350592, 10349568, 10636288, 2146435072, 0, 0, 0, 0, 0
.long 2007424, 10010624, 1188608, 1188736, 1188864, 1188992, 10637312, 10921984, 11208704, 11493376, 2146435072, 0, 0, 0, 0, 0
.long 2007424, 10011648, 1188608, 1188736, 1188864, 1188992, 10924032, 10923008, 11209728, 11494400, 2146435072, 0, 0, 0, 0, 0
.long 2007424, 10012672, 1188608, 1188736, 1188864, 1188992, 10919936, 11206656, 11210752, 11495424, 2146435072, 0, 0, 0, 0, 0
.long 2007424, 10299392, 1188608, 1188736, 1188864, 1188992, 10920960, 11207680, 11497472, 11496448, 2146435072, 0, 0, 0, 0, 0
.long 2007552, 10295296, 1228800, 1228928, 1229056, 1229184, 9337856, 9341952, 9626624, 9913344, 2146435072, 0, 0, 0, 0, 0
.long 2007552, 10296320, 1228800, 1228928, 1229056, 1229184, 9338880, 9628672, 9627648, 9914368, 2146435072, 0, 0, 0, 0, 0
.long 2007552, 10297344, 1228800, 1228928, 1229056, 1229184, 9339904, 9624576, 9911296, 9915392, 2146435072, 0, 0, 0, 0, 0
.long 2007552, 10298368, 1228800, 1228928, 1229056, 1229184, 9340928, 9625600, 9912320, 10202112, 2146435072, 0, 0, 0, 0, 0
.long 2007680, 10582016, 1229312, 1229440, 1229568, 1229696, 10198016, 10484736, 10488832, 10773504, 2146435072, 0, 0, 0, 0, 0
.long 2007680, 10583040, 1229312, 1229440, 1229568, 1229696, 10199040, 10485760, 10775552, 10774528, 2146435072, 0, 0, 0, 0, 0
.long 2007680, 10584064, 1229312, 1229440, 1229568, 1229696, 10200064, 10486784, 10771456, 11058176, 2146435072, 0, 0, 0, 0, 0
.long 2007680, 10585088, 1229312, 1229440, 1229568, 1229696, 10201088, 10487808, 10772480, 11059200, 2146435072, 0, 0, 0, 0, 0
.long 2007808, 10586112, 1229824, 1229952, 1269760, 1269888, 11060224, 11344896, 9286656, 9290752, 2146435072, 0, 0, 0, 0, 0
.long 2007808, 10872832, 1229824, 1229952, 1269760, 1269888, 11061248, 11345920, 9287680, 9577472, 2146435072, 0, 0, 0, 0, 0
.long 2007808, 10868736, 1229824, 1229952, 1269760, 1269888, 11062272, 11346944, 9288704, 9573376, 2146435072, 0, 0, 0, 0, 0
.long 2007808, 10869760, 1229824, 1229952, 1269760, 1269888, 11348992, 11347968, 9289728, 9574400, 2146435072, 0, 0, 0, 0, 0
.long 2007936, 10870784, 1270016, 1270144, 1270272, 1270400, 9575424, 9862144, 10146816, 10433536, 2146435072, 0, 0, 0, 0, 0
.long 2007936, 10871808, 1270016, 1270144, 1270272, 1270400, 9576448, 9863168, 10147840, 10434560, 2146435072, 0, 0, 0, 0, 0
.long 2007936, 11155456, 1270016, 1270144, 1270272, 1270400, 9860096, 9864192, 10148864, 10435584, 2146435072, 0, 0, 0, 0, 0
.long 2007936, 11156480, 1270016, 1270144, 1270272, 1270400, 9861120, 10150912, 10149888, 10436608, 2146435072, 0, 0, 0, 0, 0
.long 2008064, 11157504, 1270528, 1270656, 1270784, 1270912, 10437632, 10722304, 11009024, 11293696, 2146435072, 0, 0, 0, 0, 0
.long 2008064, 11158528, 1270528, 1270656, 1270784, 1270912, 10724352, 10723328, 11010048, 11294720, 2146435072, 0, 0, 0, 0, 0
.long 2008064, 11159552, 1270528, 1270656, 1270784, 1270912, 10720256, 11006976, 11011072, 11295744, 2146435072, 0, 0, 0, 0, 0
.long 2008064, 11446272, 1270528, 1270656, 1270784, 1270912, 10721280, 11008000, 11297792, 11296768, 2146435072, 0, 0, 0, 0, 0
.long 2008192, 11442176, 1310720, 1310848, 1310976, 1311104, 9409536, 9413632, 9698304, 9985024, 2146435072, 0, 0, 0, 0, 0
.long 2008192, 11443200, 1310720, 1310848, 1310976, 1311104, 9410560, 9700352, 9699328, 9986048, 2146435072, 0, 0, 0, 0, 0
.long 2008192, 11444224, 1310720, 1310848, 1310976, 1311104, 9411584, 9696256, 9982976, 9987072, 2146435072, 0, 0, 0, 0, 0
.long 2008192, 11445248, 1310720, 1310848, 1310976, 1311104, 9412608, 9697280, 9984000, 10273792, 2146435072, 0, 0, 0, 0, 0
.long 2048000, 9517056, 1311232, 1311360, 1311488, 1311616, 10269696, 10556416, 10560512, 10845184, 2146435072, 0, 0, 0, 0, 0
.long 2048000, 9518080, 1311232, 1311360, 1311488, 1311616, 10270720, 10557440, 10847232, 10846208, 2146435072, 0, 0, 0, 0, 0
.long 2048000, 9519104, 1311232, 1311360, 1311488, 1311616, 10271744, 10558464, 10843136, 11129856, 2146435072, 0, 0, 0, 0, 0
.long 2048000, 9520128, 1311232, 1311360, 1311488, 1311616, 10272768, 10559488, 10844160, 11130880, 2146435072, 0, 0, 0, 0, 0
.long 2048128, 9521152, 1311744, 1311872, 1351680, 1351808, 11131904, 11416576, 9491456, 9495552, 2146435072, 0, 0, 0, 0, 0
.long 2048128, 9807872, 1311744, 1311872, 1351680, 1351808, 11132928, 11417600, 9492480, 9782272, 2146435072, 0, 0, 0, 0, 0
.long 2048128, 9803776, 1311744, 1311872, 1351680, 1351808, 11133952, 11418624, 9493504, 9778176, 2146435072, 0, 0, 0, 0, 0
.long 2048128, 9804800, 1311744, 1311872, 1351680, 1351808, 11420672, 11419648, 9494528, 9779200, 2146435072, 0, 0, 0, 0, 0
.long 2048256, 9805824, 1351936, 1352064, 1352192, 1352320, 9780224, 10066944, 10351616, 10638336, 2146435072, 0, 0, 0, 0, 0
.long 2048256, 9806848, 1351936, 1352064, 1352192, 1352320, 9781248, 10067968, 10352640, 10639360, 2146435072, 0, 0, 0, 0, 0
.long 2048256, 10090496, 1351936, 1352064, 1352192, 1352320, 10064896, 10068992, 10353664, 10640384, 2146435072, 0, 0, 0, 0, 0
.long 2048256, 10091520, 1351936, 1352064, 1352192, 1352320, 10065920, 10355712, 10354688, 10641408, 2146435072, 0, 0, 0, 0, 0
.long 2048384, 10092544, 1352448, 1352576, 1352704, 1352832, 10642432, 10927104, 11213824, 11498496, 2146435072, 0, 0, 0, 0, 0
.long 2048384, 10093568, 1352448, 1352576, 1352704, 1352832, 10929152, 10928128, 11214848, 11499520, 2146435072, 0, 0, 0, 0, 0
.long 2048384, 10094592, 1352448, 1352576, 1352704, 1352832, 10925056, 11211776, 11215872, 11500544, 2146435072, 0, 0, 0, 0, 0
.long 2048384, 10381312, 1352448, 1352576, 1352704, 1352832, 10926080, 11212800, 11502592, 11501568, 2146435072, 0, 0, 0, 0, 0
.long 2048512, 10377216, 1392640, 1392768, 1392896, 1393024, 9291776, 9295872, 9580544, 9867264, 2146435072, 0, 0, 0, 0, 0
.long 2048512, 10378240, 1392640, 1392768, 1392896, 1393024, 9292800, 9582592, 9581568, 9868288, 2146435072, 0, 0, 0, 0, 0
.long 2048512, 10379264, 1392640, 1392768, 1392896, 1393024, 9293824, 9578496, 9865216, 9869312, 2146435072, 0, 0, 0, 0, 0
.long 2048512, 10380288, 1392640, 1392768, 1392896, 1393024, 9294848, 9579520, 9866240, 10156032, 2146435072, 0, 0, 0, 0, 0
.long 2048640, 10663936, 1393152, 1393280, 1393408, 1393536, 10151936, 10438656, 10442752, 10727424, 2146435072, 0, 0, 0, 0, 0
.long 2048640, 10664960, 1393152, 1393280, 1393408, 1393536, 10152960, 10439680, 10729472, 10728448, 2146435072, 0, 0, 0, 0, 0
.long 2048640, 10665984, 1393152, 1393280, 1393408, 1393536, 10153984, 10440704, 10725376, 11012096, 2146435072, 0, 0, 0, 0, 0
.long 2048640, 10667008, 1393152, 1393280, 1393408, 1393536, 10155008, 10441728, 10726400, 11013120, 2146435072, 0, 0, 0, 0, 0
.long 2048768, 10668032, 1393664, 1393792, 1433600, 1433728, 11014144, 11298816, 9414656, 9418752, 2146435072, 0, 0, 0, 0, 0
.long 2048768, 10954752, 1393664, 1393792, 1433600, 1433728, 11015168, 11299840, 9415680, 9705472, 2146435072, 0, 0, 0, 0, 0
.long 2048768, 10950656, 1393664, 1393792, 1433600, 1433728, 11016192, 11300864, 9416704, 9701376, 2146435072, 0, 0, 0, 0, 0
.long 2048768, 10951680, 1393664, 1393792, 1433600, 1433728, 11302912, 11301888, 9417728, 9702400, 2146435072, 0, 0, 0, 0, 0
.long 2048896, 10952704, 1433856, 1433984, 1434112, 1434240, 9703424, 9990144, 10274816, 10561536, 2146435072, 0, 0, 0, 0, 0
.long 2048896, 10953728, 1433856, 1433984, 1434112, 1434240, 9704448, 9991168, 10275840, 10562560, 2146435072, 0, 0, 0, 0, 0
.long 2048896, 11237376, 1433856, 1433984, 1434112, 1434240, 9988096, 9992192, 10276864, 10563584, 2146435072, 0, 0, 0, 0, 0
.long 2048896, 11238400, 1433856, 1433984, 1434112, 1434240, 9989120, 10278912, 10277888, 10564608, 2146435072, 0, 0, 0, 0, 0
.long 2049024, 11239424, 1434368, 1434496, 1434624, 1434752, 10565632, 10850304, 11137024, 11421696, 2146435072, 0, 0, 0, 0, 0
.long 2049024, 11240448, 1434368, 1434496, 1434624, 1434752, 10852352, 10851328, 11138048, 11422720, 2146435072, 0, 0, 0, 0, 0
.long 2049024, 11241472, 1434368, 1434496, 1434624, 1434752, 10848256, 11134976, 11139072, 11423744, 2146435072, 0, 0, 0, 0, 0
.long 2049024, 11528192, 1434368, 1434496, 1434624, 1434752, 10849280, 11136000, 11425792, 11424768, 2146435072, 0, 0, 0, 0, 0
.long 2049152, 11524096, 1474560, 1474688, 1474816, 1474944, 9496576, 9500672, 9785344, 10072064, 2146435072, 0, 0, 0, 0, 0
.long 2049152, 11525120, 1474560, 1474688, 1474816, 1474944, 9497600, 9787392, 9786368, 10073088, 2146435072, 0, 0, 0, 0, 0
.long 2049152, 11526144, 1474560, 1474688, 1474816, 1474944, 9498624, 9783296, 10070016, 10074112, 2146435072, 0, 0, 0, 0, 0
.long 2049152, 11527168, 1474560, 1474688, 1474816, 1474944, 9499648, 9784320, 10071040, 10360832, 2146435072, 0, 0, 0, 0, 0
.long 2088960, 9317376, 1475072, 1475200, 1475328, 1475456, 10356736, 10643456, 10647552, 10932224, 2146435072, 0, 0, 0, 0, 0
.long 2088960, 9318400, 1475072, 1475200, 1475328, 1475456, 10357760, 10644480, 10934272, 10933248, 2146435072, 0, 0, 0, 0, 0
.long 2088960, 9319424, 1475072, 1475200, 1475328, 1475456, 10358784, 10645504, 10930176, 11216896, 2146435072, 0, 0, 0, 0, 0
.long 2088960, 9320448, 1475072, 1475200, 1475328, 1475456, 10359808, 10646528, 10931200, 11217920, 2146435072, 0, 0, 0, 0, 0
.long 2089088, 9321472, 1475584, 1475712, 1515520, 1515648, 11218944, 11503616, 9342976, 9347072, 2146435072, 0, 0, 0, 0, 0
.long 2089088, 9608192, 1475584, 1475712, 1515520, 1515648, 11219968, 11504640, 9344000, 9633792, 2146435072, 0, 0, 0, 0, 0
.long 2089088, 9604096, 1475584, 1475712, 1515520, 1515648, 11220992, 11505664, 9345024, 9629696, 2146435072, 0, 0, 0, 0, 0
.long 2089088, 9605120, 1475584, 1475712, 1515520, 1515648, 11507712, 11506688, 9346048, 9630720, 2146435072, 0, 0, 0, 0, 0
.long 2089216, 9606144, 1515776, 1515904, 1516032, 1516160, 9631744, 9918464, 10203136, 10489856, 2146435072, 0, 0, 0, 0, 0
.long 2089216, 9607168, 1515776, 1515904, 1516032, 1516160, 9632768, 9919488, 10204160, 10490880, 2146435072, 0, 0, 0, 0, 0
.long 2089216, 9890816, 1515776, 1515904, 1516032, 1516160, 9916416, 9920512, 10205184, 10491904, 2146435072, 0, 0, 0, 0, 0
.long 2089216, 9891840, 1515776, 1515904, 1516032, 1516160, 9917440, 10207232, 10206208, 10492928, 2146435072, 0, 0, 0, 0, 0
.long 2089344, 9892864, 1516288, 1516416, 1516544, 1516672, 10493952, 10778624, 11065344, 11350016, 2146435072, 0, 0, 0, 0, 0
.long 2089344, 9893888, 1516288, 1516416, 1516544, 1516672, 10780672, 10779648, 11066368, 11351040, 2146435072, 0, 0, 0, 0, 0
.long 2089344, 9894912, 1516288, 1516416, 1516544, 1516672, 10776576, 11063296, 11067392, 11352064, 2146435072, 0, 0, 0, 0, 0
.long 2089344, 10181632, 1516288, 1516416, 1516544, 1516672, 10777600, 11064320, 11354112, 11353088, 2146435072, 0, 0, 0, 0, 0
.long 2089472, 10177536, 1556480, 1556608, 1556736, 1556864, 9296896, 9300992, 9585664, 9872384, 2146435072, 0, 0, 0, 0, 0
.long 2089472, 10178560, 1556480, 1556608, 1556736, 1556864, 9297920, 9587712, 9586688, 9873408, 2146435072, 0, 0, 0, 0, 0
.long 2089472, 10179584, 1556480, 1556608, 1556736, 1556864, 9298944, 9583616, 9870336, 9874432, 2146435072, 0, 0, 0, 0, 0
.long 2089472, 10180608, 1556480, 1556608, 1556736, 1556864, 9299968, 9584640, 9871360, 10161152, 2146435072, 0, 0, 0, 0, 0
.long 2089600, 10464256, 1556992, 1557120, 1557248, 1557376, 10157056, 10443776, 10447872, 10732544, 2146435072, 0, 0, 0, 0, 0
.long 2089600, 10465280, 1556992, 1557120, 1557248, 1557376, 10158080, 10444800, 10734592, 10733568, 2146435072, 0, 0, 0, 0, 0
.long 2089600, 10466304, 1556992, 1557120, 1557248, 1557376, 10159104, 10445824, 10730496, 11017216, 2146435072, 0, 0, 0, 0, 0
.long 2089600, 10467328, 1556992, 1557120, 1557248, 1557376, 10160128, 10446848, 10731520, 11018240, 2146435072, 0, 0, 0, 0, 0
.long 2089728, 10468352, 1557504, 1557632, 1597440, 1597568, 11019264, 11303936, 9419776, 9423872, 2146435072, 0, 0, 0, 0, 0
.long 2089728, 10755072, 1557504, 1557632, 1597440, 1597568, 11020288, 11304960, 9420800, 9710592, 2146435072, 0, 0, 0, 0, 0
.long 2089728, 10750976, 1557504, 1557632, 1597440, 1597568, 11021312, 11305984, 9421824, 9706496, 2146435072, 0, 0, 0, 0, 0
.long 2089728, 10752000, 1557504, 1557632, 1597440, 1597568, 11308032, 11307008, 9422848, 9707520, 2146435072, 0, 0, 0, 0, 0
.long 2089856, 10753024, 1597696, 1597824, 1597952, 1598080, 9708544, 9995264, 10279936, 10566656, 2146435072, 0, 0, 0, 0, 0
.long 2089856, 10754048, 1597696, 1597824, 1597952, 1598080, 9709568, 9996288, 10280960, 10567680, 2146435072, 0, 0, 0, 0, 0
.long 2089856, 11037696, 1597696, 1597824, 1597952, 1598080, 9993216, 9997312, 10281984, 10568704, 2146435072, 0, 0, 0, 0, 0
.long 2089856, 11038720, 1597696, 1597824, 1597952, 1598080, 9994240, 10284032, 10283008, 10569728, 2146435072, 0, 0, 0, 0, 0
.long 2089984, 11039744, 1598208, 1598336, 1598464, 1598592, 10570752, 10855424, 11142144, 11426816, 2146435072, 0, 0, 0, 0, 0
.long 2089984, 11040768, 1598208, 1598336, 1598464, 1598592, 10857472, 10856448, 11143168, 11427840, 2146435072, 0, 0, 0, 0, 0
.long 2089984, 11041792, 1598208, 1598336, 1598464, 1598592, 10853376, 11140096, 11144192, 11428864, 2146435072, 0, 0, 0, 0, 0
.long 2089984, 11328512, 1598208, 1598336, 1598464, 1598592, 10854400, 11141120, 11430912, 11429888, 2146435072, 0, 0, 0, 0, 0
.long 2090112, 11324416, 1638400, 1638528, 1638656, 1638784, 9501696, 9505792, 9790464, 10077184, 2146435072, 0, 0, 0, 0, 0
.long 2090112, 11325440, 1638400, 1638528, 1638656, 1638784, 9502720, 9792512, 9791488, 10078208, 2146435072, 0, 0, 0, 0, 0
.long 2090112, 11326464, 1638400, 1638528, 1638656, 1638784, 9503744, 9788416, 10075136, 10079232, 2146435072, 0, 0, 0, 0, 0
.long 2090112, 11327488, 1638400, 1638528, 1638656, 1638784, 9504768, 9789440, 10076160, 10365952, 2146435072, 0, 0, 0, 0, 0
.long 2129920, 9440256, 1638912, 1639040, 1639168, 1639296, 10361856, 10648576, 10652672, 10937344, 2146435072, 0, 0, 0, 0, 0
.long 2129920, 9441280, 1638912, 1639040, 1639168, 1639296, 10362880, 10649600, 10939392, 10938368, 2146435072, 0, 0, 0, 0, 0
.long 2129920, 9442304, 1638912, 1639040, 1639168, 1639296, 10363904, 10650624, 10935296, 11222016, 2146435072, 0, 0, 0, 0, 0
.long 2129920, 9443328, 1638912, 1639040, 1639168, 1639296, 10364928, 10651648, 10936320, 11223040, 2146435072, 0, 0, 0, 0, 0
.long 2130048, 9444352, 1639424, 1639552, 1679360, 1679488, 11224064, 11508736, 9302016, 9306112, 2146435072, 0, 0, 0, 0, 0
.long 2130048, 9731072, 1639424, 1639552, 1679360, 1679488, 11225088, 11509760, 9303040, 9592832, 2146435072, 0, 0, 0, 0, 0
.long 2130048, 9726976, 1639424, 1639552, 1679360, 1679488, 11226112, 11510784, 9304064, 9588736, 2146435072, 0, 0, 0, 0, 0
.long 2130048, 9728000, 1639424, 1639552, 1679360, 1679488, 11512832, 11511808, 9305088, 9589760, 2146435072, 0, 0, 0, 0, 0
.long 2130176, 9729024, 1679616, 1679744, 1679872, 1680000, 9590784, 9877504, 10162176, 10448896, 2146435072, 0, 0, 0, 0, 0
.long 2130176, 9730048, 1679616, 1679744, 1679872, 1680000, 9591808, 9878528, 10163200, 10449920, 2146435072, 0, 0, 0, 0, 0
.long 2130176, 10013696, 1679616, 1679744, 1679872, 1680000, 9875456, 9879552, 10164224, 10450944, 2146435072, 0, 0, 0, 0, 0
.long 2130176, 10014720, 1679616, 1679744, 1679872, 1680000, 9876480, 10166272, 10165248, 10451968, 2146435072, 0, 0, 0, 0, 0
.long 2130304, 10015744, 1680128, 1680256, 1680384, 1680512, 10452992, 10737664, 11024384, 11309056, 2146435072, 0, 0, 0, 0, 0
.long 2130304, 10016768, 1680128, 1680256, 1680384, 1680512, 10739712, 10738688, 11025408, 11310080, 2146435072, 0, 0, 0, 0, 0
.long 2130304, 10017792, 1680128, 1680256, 1680384, 1680512, 10735616, 11022336, 11026432, 11311104, 2146435072, 0, 0, 0, 0, 0
.long 2130304, 10304512, 1680128, 1680256, 1680384, 1680512, 10736640, 11023360, 11313152, 11312128, 2146435072, 0, 0, 0, 0, 0
.long 2130432, 10300416, 1720320, 1720448, 1720576, 1720704, 9424896, 9428992, 9713664, 10000384, 2146435072, 0, 0, 0, 0, 0
.long 2130432, 10301440, 1720320, 1720448, 1720576, 1720704, 9425920, 9715712, 9714688, 10001408, 2146435072, 0, 0, 0, 0, 0
.long 2130432, 10302464, 1720320, 1720448, 1720576, 1720704, 9426944, 9711616, 9998336, 10002432, 2146435072, 0, 0, 0, 0, 0
.long 2130432, 10303488, 1720320, 1720448, 1720576, 1720704, 9427968, 9712640, 9999360, 10289152, 2146435072, 0, 0, 0, 0, 0
.long 2130560, 10587136, 1720832, 1720960, 1721088, 1721216, 10285056, 10571776, 10575872, 10860544, 2146435072, 0, 0, 0, 0, 0
.long 2130560, 10588160, 1720832, 1720960, 1721088, 1721216, 10286080, 10572800, 10862592, 10861568, 2146435072, 0, 0, 0, 0, 0
.long 2130560, 10589184, 1720832, 1720960, 1721088, 1721216, 10287104, 10573824, 10858496, 11145216, 2146435072, 0, 0, 0, 0, 0
.long 2130560, 10590208, 1720832, 1720960, 1721088, 1721216, 10288128, 10574848, 10859520, 11146240, 2146435072, 0, 0, 0, 0, 0
.long 2130688, 10591232, 1721344, 1721472, 1761280, 1761408, 11147264, 11431936, 9506816, 9510912, 2146435072, 0, 0, 0, 0, 0
.long 2130688, 10877952, 1721344, 1721472, 1761280, 1761408, 11148288, 11432960, 9507840, 9797632, 2146435072, 0, 0, 0, 0, 0
.long 2130688, 10873856, 1721344, 1721472, 1761280, 1761408, 11149312, 11433984, 9508864, 9793536, 2146435072, 0, 0, 0, 0, 0
.long 2130688, 10874880, 1721344, 1721472, 1761280, 1761408, 11436032, 11435008, 9509888, 9794560, 2146435072, 0, 0, 0, 0, 0
.long 2130816, 10875904, 1761536, 1761664, 1761792, 1761920, 9795584, 10082304, 10366976, 10653696, 2146435072, 0, 0, 0, 0, 0
.long 2130816, 10876928, 1761536, 1761664, 1761792, 1761920, 9796608, 10083328, 10368000, 10654720, 2146435072, 0, 0, 0, 0, 0
.long 2130816, 11160576, 1761536, 1761664, 1761792, 1761920, 10080256, 10084352, 10369024, 10655744, 2146435072, 0, 0, 0, 0, 0
.long 2130816, 11161600, 1761536, 1761664, 1761792, 1761920, 10081280, 10371072, 10370048, 10656768, 2146435072, 0, 0, 0, 0, 0
.long 2130944, 11162624, 1762048, 1762176, 1762304, 1762432, 10657792, 10942464, 11229184, 11513856, 2146435072, 0, 0, 0, 0, 0
.long 2130944, 11163648, 1762048, 1762176, 1762304, 1762432, 10944512, 10943488, 11230208, 11514880, 2146435072, 0, 0, 0, 0, 0
.long 2130944, 11164672, 1762048, 1762176, 1762304, 1762432, 10940416, 11227136, 11231232, 11515904, 2146435072, 0, 0, 0, 0, 0
.long 2130944, 11451392, 1762048, 1762176, 1762304, 1762432, 10941440, 11228160, 11517952, 11516928, 2146435072, 0, 0, 0, 0, 0
.long 2131072, 11447296, 1802240, 1802368, 1802496, 1802624, 9348096, 9352192, 9636864, 9923584, 2146435072, 0, 0, 0, 0, 0
.long 2131072, 11448320, 1802240, 1802368, 1802496, 1802624, 9349120, 9638912, 9637888, 9924608, 2146435072, 0, 0, 0, 0, 0
.long 2131072, 11449344, 1802240, 1802368, 1802496, 1802624, 9350144, 9634816, 9921536, 9925632, 2146435072, 0, 0, 0, 0, 0
.long 2131072, 11450368, 1802240, 1802368, 1802496, 1802624, 9351168, 9635840, 9922560, 10212352, 2146435072, 0, 0, 0, 0, 0
.long 2170880, 9522176, 1802752, 1802880, 1803008, 1803136, 10208256, 10494976, 10499072, 10783744, 2146435072, 0, 0, 0, 0, 0
.long 2170880, 9523200, 1802752, 1802880, 1803008, 1803136, 10209280, 10496000, 10785792, 10784768, 2146435072, 0, 0, 0, 0, 0
.long 2170880, 9524224, 1802752, 1802880, 1803008, 1803136, 10210304, 10497024, 10781696, 11068416, 2146435072, 0, 0, 0, 0, 0
.long 2170880, 9525248, 1802752, 1802880, 1803008, 1803136, 10211328, 10498048, 10782720, 11069440, 2146435072, 0, 0, 0, 0, 0
.long 2171008, 9526272, 1803264, 1803392, 1843200, 1843328, 11070464, 11355136, 9307136, 9311232, 2146435072, 0, 0, 0, 0, 0
.long 2171008, 9812992, 1803264, 1803392, 1843200, 1843328, 11071488, 11356160, 9308160, 9597952, 2146435072, 0, 0, 0, 0, 0
.long 2171008, 9808896, 1803264, 1803392, 1843200, 1843328, 11072512, 11357184, 9309184, 9593856, 2146435072, 0, 0, 0, 0, 0
.long 2171008, 9809920, 1803264, 1803392, 1843200, 1843328, 11359232, 11358208, 9310208, 9594880, 2146435072, 0, 0, 0, 0, 0
.long 2171136, 9810944, 1843456, 1843584, 1843712, 1843840, 9595904, 9882624, 10167296, 10454016, 2146435072, 0, 0, 0, 0, 0
.long 2171136, 9811968, 1843456, 1843584, 1843712, 1843840, 9596928, 9883648, 10168320, 10455040, 2146435072, 0, 0, 0, 0, 0
.long 2171136, 10095616, 1843456, 1843584, 1843712, 1843840, 9880576, 9884672, 10169344, 10456064, 2146435072, 0, 0, 0, 0, 0
.long 2171136, 10096640, 1843456, 1843584, 1843712, 1843840, 9881600, 10171392, 10170368, 10457088, 2146435072, 0, 0, 0, 0, 0
.long 2171264, 10097664, 1843968, 1844096, 1844224, 1844352, 10458112, 10742784, 11029504, 11314176, 2146435072, 0, 0, 0, 0, 0
.long 2171264, 10098688, 1843968, 1844096, 1844224, 1844352, 10744832, 10743808, 11030528, 11315200, 2146435072, 0, 0, 0, 0, 0
.long 2171264, 10099712, 1843968, 1844096, 1844224, 1844352, 10740736, 11027456, 11031552, 11316224, 2146435072, 0, 0, 0, 0, 0
.long 2171264, 10386432, 1843968, 1844096, 1844224, 1844352, 10741760, 11028480, 11318272, 11317248, 2146435072, 0, 0, 0, 0, 0
.long 2171392, 10382336, 1884160, 1884288, 1884416, 1884544, 9430016, 9434112, 9718784, 10005504, 2146435072, 0, 0, 0, 0, 0
.long 2171392, 10383360, 1884160, 1884288, 1884416, 1884544, 9431040, 9720832, 9719808, 10006528, 2146435072, 0, 0, 0, 0, 0
.long 2171392, 10384384, 1884160, 1884288, 1884416, 1884544, 9432064, 9716736, 10003456, 10007552, 2146435072, 0, 0, 0, 0, 0
.long 2171392, 10385408, 1884160, 1884288, 1884416, 1884544, 9433088, 9717760, 10004480, 10294272, 2146435072, 0, 0, 0, 0, 0
.long 2171520, 10669056, 1884672, 1884800, 1884928, 1885056, 10290176, 10576896, 10580992, 10865664, 2146435072, 0, 0, 0, 0, 0
.long 2171520, 10670080, 1884672, 1884800, 1884928, 1885056, 10291200, 10577920, 10867712, 10866688, 2146435072, 0, 0, 0, 0, 0
.long 2171520, 10671104, 1884672, 1884800, 1884928, 1885056, 10292224, 10578944, 10863616, 11150336, 2146435072, 0, 0, 0, 0, 0
.long 2171520, 10672128, 1884672, 1884800, 1884928, 1885056, 10293248, 10579968, 10864640, 11151360, 2146435072, 0, 0, 0, 0, 0
.long 2171648, 10673152, 1885184, 1885312, 1925120, 1925248, 11152384, 11437056, 9511936, 9516032, 2146435072, 0, 0, 0, 0, 0
.long 2171648, 10959872, 1885184, 1885312, 1925120, 1925248, 11153408, 11438080, 9512960, 9802752, 2146435072, 0, 0, 0, 0, 0
.long 2171648, 10955776, 1885184, 1885312, 1925120, 1925248, 11154432, 11439104, 9513984, 9798656, 2146435072, 0, 0, 0, 0, 0
.long 2171648, 10956800, 1885184, 1885312, 1925120, 1925248, 11441152, 11440128, 9515008, 9799680, 2146435072, 0, 0, 0, 0, 0
.long 2171776, 10957824, 1925376, 1925504, 1925632, 1925760, 9800704, 10087424, 10372096, 10658816, 2146435072, 0, 0, 0, 0, 0
.long 2171776, 10958848, 1925376, 1925504, 1925632, 1925760, 9801728, 10088448, 10373120, 10659840, 2146435072, 0, 0, 0, 0, 0
.long 2171776, 11242496, 1925376, 1925504, 1925632, 1925760, 10085376, 10089472, 10374144, 10660864, 2146435072, 0, 0, 0, 0, 0
.long 2171776, 11243520, 1925376, 1925504, 1925632, 1925760, 10086400, 10376192, 10375168, 10661888, 2146435072, 0, 0, 0, 0, 0
.long 2171904, 11244544, 1925888, 1926016, 1926144, 1926272, 10662912, 10947584, 11234304, 11518976, 2146435072, 0, 0, 0, 0, 0
.long 2171904, 11245568, 1925888, 1926016, 1926144, 1926272, 10949632, 10948608, 11235328, 11520000, 2146435072, 0, 0, 0, 0, 0
.long 2171904, 11246592, 1925888, 1926016, 1926144, 1926272, 10945536, 11232256, 11236352, 11521024, 2146435072, 0, 0, 0, 0, 0
.long 2171904, 11533312, 1925888, 1926016, 1926144, 1926272, 10946560, 11233280, 11523072, 11522048, 2146435072, 0, 0, 0, 0, 0
.long 2172032, 11529216, 1966080, 1966208, 1966336, 1966464, 9312256, 9316352, 9601024, 9887744, 2146435072, 0, 0, 0, 0, 0
.long 2172032, 11530240, 1966080, 1966208, 1966336, 1966464, 9313280, 9603072, 9602048, 9888768, 2146435072, 0, 0, 0, 0, 0
.long 2172032, 11531264, 1966080, 1966208, 1966336, 1966464, 9314304, 9598976, 9885696, 9889792, 2146435072, 0, 0, 0, 0, 0
.long 2172032, 11532288, 1966080, 1966208, 1966336, 1966464, 9315328, 9600000, 9886720, 10176512, 2146435072, 0, 0, 0, 0, 0
.section .rodata,"a"
.p2align 6
.amdhsa_kernel sequential_preLN__linear_attn_block__dense_activation_relu__prompt_kernel
  .amdhsa_next_free_vgpr 512
  .amdhsa_next_free_sgpr 76
  .amdhsa_accum_offset 256
  .amdhsa_group_segment_fixed_size 0
  .amdhsa_kernarg_size 72
  .amdhsa_user_sgpr_count 2
  .amdhsa_user_sgpr_kernarg_segment_ptr 1
  .amdhsa_system_sgpr_workgroup_id_x 1
.end_amdhsa_kernel
```
